```python
import torch

def _softmax(x, axis=-1):
    return torch.softmax(x, dim=axis)

def _gelu(x):
    return torch.nn.functional.gelu(x, approximate='tanh')

def _silu(x):
    return torch.nn.functional.silu(x)

def _sigmoid(x):
    return torch.sigmoid(x)

def _layernorm(x, axis=-1, eps=1e-05):
    m = x.mean(dim=axis, keepdim=True)
    v = x.var(dim=axis, keepdim=True, unbiased=False)
    return (x - m) / torch.sqrt(v + eps)

def _scatter_add(tgt, idx, src, axis=0):
    return tgt.clone().index_add_(axis, idx, src)

def _segment_sum(src, seg, n):
    out = torch.zeros((n,) + src.shape[1:], dtype=src.dtype)
    return out.index_add_(0, seg, src)

def _pad(x, pw):
    flat = tuple((v for pair in reversed(pw) for v in pair))
    return torch.nn.functional.pad(x, flat)
kernel_name = 'adaLN_cond__spectral_fnet__geglu_ffn__prompt'

def setup_inputs():

    _w = lambda a: (lambda t: t.to(torch.bfloat16) if t.is_floating_point() else t)(torch.as_tensor(a))

    def _A_setup():
        B, S, D = (1, 2048, 640)
        ns = torch.arange(S)[:, None] * torch.arange(S)[None, :]
        nd = torch.arange(D)[:, None] * torch.arange(D)[None, :]
        Ws_re = torch.cos(-2.0 * torch.pi * ns / S).to(float)
        Ws_im = torch.sin(-2.0 * torch.pi * ns / S).to(float)
        Wd_re = torch.cos(-2.0 * torch.pi * nd / D).to(float)
        Wd_im = torch.sin(-2.0 * torch.pi * nd / D).to(float)
        return {'x': _w((lambda *s: torch.randn(*s, dtype=torch.bfloat16) * 0.05)(B, S, D)), 'dft_seq_re': _w(Ws_re), 'dft_seq_im': _w(Ws_im), 'dft_hid_re': _w(Wd_re), 'dft_hid_im': _w(Wd_im)}
    _A_in = _A_setup()

    def _B_setup():
        B, S, D, F = (1, 2048, 640, 1536)
        return {'x': _w((lambda *s: torch.randn(*s, dtype=torch.bfloat16) * 0.05)(B, S, D)), 'w_gate': _w((lambda *s: torch.randn(*s, dtype=torch.bfloat16) * 0.4)(D, F)), 'w_up': _w((lambda *s: torch.randn(*s, dtype=torch.bfloat16) * 0.4)(D, F)), 'w_down': _w((lambda *s: torch.randn(*s, dtype=torch.bfloat16) * 0.4)(F, D))}
    _B_in = _B_setup()
    return {'A_x': _A_in['x'], 'A_dft_seq_re': _A_in['dft_seq_re'], 'A_dft_seq_im': _A_in['dft_seq_im'], 'A_dft_hid_re': _A_in['dft_hid_re'], 'A_dft_hid_im': _A_in['dft_hid_im'], 'B_x': _B_in['x'], 'B_w_gate': _B_in['w_gate'], 'B_w_up': _B_in['w_up'], 'B_w_down': _B_in['w_down'], 'c': _w((lambda *s: torch.randn(*s, dtype=torch.bfloat16) * 0.4)(1, 640) * 8.0), 'w_mod': _w((lambda *s: torch.randn(*s, dtype=torch.bfloat16) * 0.4)(640, 6 * 640) * 640 ** (-0.5) * 8.0)}

def reference(A_x, A_dft_seq_re, A_dft_seq_im, A_dft_hid_re, A_dft_hid_im, B_x, B_w_gate, B_w_up, B_w_down, c, w_mod):

    def _A_ref(x, dft_seq_re, dft_seq_im, dft_hid_re, dft_hid_im):
        a = torch.einsum('bsd,ed->bse', x, dft_hid_re)
        b = torch.einsum('bsd,ed->bse', x, dft_hid_im)
        y = torch.einsum('ts,bse->bte', dft_seq_re, a) - torch.einsum('ts,bse->bte', dft_seq_im, b)
        return y

    def _B_ref(x, w_gate, w_up, w_down):
        return _gelu(x @ w_gate) * (x @ w_up) @ w_down
    x = A_x
    mod = (_silu(c) @ w_mod).reshape(c.shape[0], 6, 1, -1)
    sa, ca, ga, sb, cb, gb = (mod[:, 0].clone(), mod[:, 1].clone(), mod[:, 2].clone(), mod[:, 3].clone(), mod[:, 4].clone(), mod[:, 5].clone())
    h = _layernorm(x, axis=-1) * (1 + ca) + sa
    x = x + ga * _A_ref(h, A_dft_seq_re, A_dft_seq_im, A_dft_hid_re, A_dft_hid_im)
    h = _layernorm(x, axis=-1) * (1 + cb) + sb
    x = x + gb * _B_ref(h, B_w_gate, B_w_up, B_w_down)
    return x
```

```asm
; @launch grid=(256,1,1) block=(256,1,1) lds=163840
.amdgcn_target "amdgcn-amd-amdhsa--gfx950"
.text
.globl adaLN_cond__spectral_fnet__geglu_ffn__prompt_kernel
.p2align 12
.p2align 8
.type adaLN_cond__spectral_fnet__geglu_ffn__prompt_kernel,@function
adaLN_cond__spectral_fnet__geglu_ffn__prompt_kernel:
    s_cmp_ge_u32 s2, 256
    s_cbranch_scc1 adaLN_cond__spectral_fnet__geglu_ffn__prompt_kernel_end1
    s_load_dwordx2 s[4:5], s[0:1], 0
    s_load_dwordx16 s[36:51], s[0:1], 48
    v_lshrrev_b32 v1, 6, v0
    s_nop 0
    v_readfirstlane_b32 s3, v1
    v_and_b32 v1, 63, v0
    v_and_b32 v2, 15, v0
    v_lshrrev_b32 v3, 4, v1
    s_and_b32 s12, s2, 7
    s_lshl_b32 s12, s12, 1
    s_bfe_u32 s13, s2, 0x10003
    s_add_u32 s12, s12, s13
    s_lshr_b32 s13, s2, 4
    s_cmp_lg_u32 s3, 0
    s_cbranch_scc1 adaLN_cond__spectral_fnet__geglu_ffn__prompt_kernel_w06
    s_getpc_b64 s[52:53]
adaLN_cond__spectral_fnet__geglu_ffn__prompt_kernel_pc7:
    s_sub_u32 s52, s52, adaLN_cond__spectral_fnet__geglu_ffn__prompt_kernel_pc7-adaLN_cond__spectral_fnet__geglu_ffn__prompt_kernel
    s_subb_u32 s53, s53, 0
    s_mov_b32 s24, s52
    s_and_b32 s25, s53, 0xffff
    s_mov_b32 s26, adaLN_cond__spectral_fnet__geglu_ffn__prompt_kernel_tab-adaLN_cond__spectral_fnet__geglu_ffn__prompt_kernel+17408
    s_mov_b32 s27, 0x20000
    s_bfe_u32 s54, s2, 0x30003
    s_lshl_b32 s54, s54, 13
    v_lshlrev_b32 v240, 7, v1
    buffer_load_dword a246, v240, s[24:27], s54 offen
adaLN_cond__spectral_fnet__geglu_ffn__prompt_kernel_w06:
    s_cmp_ge_u32 s2, 128
    s_cbranch_scc1 adaLN_cond__spectral_fnet__geglu_ffn__prompt_kernel_a8
    s_mul_i32 s52, s3, 320
    s_mov_b32 s53, 655360
    v_mul_u32_u24 v24, s53, v3
    v_add_u32 v24, s52, v24
    v_lshl_add_u32 v250, v2, 4, v24
    v_lshl_add_u32 v251, v2, 2, v24
    s_and_b32 s66, s2, 7
    s_lshl_b32 s66, s66, 1
    s_and_b32 s54, s13, 1
    s_add_u32 s66, s66, s54
    s_sub_u32 s54, 32, s66
    s_cmp_eq_u32 s66, 0
    s_cselect_b32 s54, 16, s54
    s_bitcmp1_b32 s13, 2
    s_cselect_b32 s66, s54, s66
    s_bitcmp1_b32 s13, 1
    s_cselect_b32 s54, 32, 0
    s_add_u32 s66, s66, s54
    s_mul_i32 s54, s66, 1280
    s_waitcnt lgkmcnt(0)
    s_mov_b32 s20, s4
    s_and_b32 s21, s5, 0xffff
    s_mov_b32 s22, 2621440
    s_mov_b32 s23, 0x20000
    buffer_load_dwordx4 v[20:23], v250, s[20:23], s54 offen
    buffer_load_dword v52, v251, s[20:23], s54 offen offset:256
    s_add_u32 s54, s54, 81920
    buffer_load_dwordx4 v[24:27], v250, s[20:23], s54 offen
    buffer_load_dword v53, v251, s[20:23], s54 offen offset:256
    s_add_u32 s54, s54, 81920
    buffer_load_dwordx4 v[28:31], v250, s[20:23], s54 offen
    buffer_load_dword v54, v251, s[20:23], s54 offen offset:256
    s_add_u32 s54, s54, 81920
    buffer_load_dwordx4 v[32:35], v250, s[20:23], s54 offen
    buffer_load_dword v55, v251, s[20:23], s54 offen offset:256
    s_add_u32 s54, s54, 81920
    buffer_load_dwordx4 v[36:39], v250, s[20:23], s54 offen
    buffer_load_dword v56, v251, s[20:23], s54 offen offset:256
    s_add_u32 s54, s54, 81920
    buffer_load_dwordx4 v[40:43], v250, s[20:23], s54 offen
    buffer_load_dword v57, v251, s[20:23], s54 offen offset:256
    s_add_u32 s54, s54, 81920
    buffer_load_dwordx4 v[44:47], v250, s[20:23], s54 offen
    buffer_load_dword v58, v251, s[20:23], s54 offen offset:256
    s_add_u32 s54, s54, 81920
    buffer_load_dwordx4 v[48:51], v250, s[20:23], s54 offen
    buffer_load_dword v59, v251, s[20:23], s54 offen offset:256
    s_branch adaLN_cond__spectral_fnet__geglu_ffn__prompt_kernel_e10
adaLN_cond__spectral_fnet__geglu_ffn__prompt_kernel_a8:
    s_cmp_ge_u32 s2, 248
    s_cbranch_scc1 adaLN_cond__spectral_fnet__geglu_ffn__prompt_kernel_b9
    s_sub_u32 s64, s2, 128
    s_and_b32 s65, s64, 1
    s_lshr_b32 s64, s64, 1
    v_and_b32 v250, 7, v0
    v_lshrrev_b32 v251, 3, v0
    s_mov_b32 s52, 76800
    v_lshlrev_b32 v232, 4, v250
    v_mad_u32_u24 v232, v251, s52, v232
    v_mul_u32_u24 v233, 20, v251
    s_mul_i32 s53, s65, 2457600
    s_lshl_b32 s54, s64, 7
    s_add_u32 s53, s53, s54
    s_mul_i32 s54, s65, 640
    s_waitcnt lgkmcnt(0)
    s_mov_b32 s20, s44
    s_and_b32 s21, s45, 0xffff
    s_mov_b32 s22, 4915200
    s_mov_b32 s23, 0x20000
    s_mov_b32 s24, s42
    s_and_b32 s25, s43, 0xffff
    s_mov_b32 s26, 1280
    s_mov_b32 s27, 0x20000
    buffer_load_dwordx4 v[60:63], v233, s[24:27], s54 offen
    buffer_load_dword v64, v233, s[24:27], s54 offen offset:16
    buffer_load_dwordx4 v[20:23], v232, s[20:23], s53 offen
    s_add_u32 s53, s53, 7680
    buffer_load_dwordx4 v[24:27], v232, s[20:23], s53 offen
    s_add_u32 s53, s53, 7680
    buffer_load_dwordx4 v[28:31], v232, s[20:23], s53 offen
    s_add_u32 s53, s53, 7680
    buffer_load_dwordx4 v[32:35], v232, s[20:23], s53 offen
    s_add_u32 s53, s53, 7680
    buffer_load_dwordx4 v[36:39], v232, s[20:23], s53 offen
    s_add_u32 s53, s53, 7680
    buffer_load_dwordx4 v[40:43], v232, s[20:23], s53 offen
    s_add_u32 s53, s53, 7680
    buffer_load_dwordx4 v[44:47], v232, s[20:23], s53 offen
    s_add_u32 s53, s53, 7680
    buffer_load_dwordx4 v[48:51], v232, s[20:23], s53 offen
    s_add_u32 s53, s53, 7680
    buffer_load_dwordx4 v[52:55], v232, s[20:23], s53 offen
    s_add_u32 s53, s53, 7680
    buffer_load_dwordx4 v[56:59], v232, s[20:23], s53 offen
adaLN_cond__spectral_fnet__geglu_ffn__prompt_kernel_b9:
    s_cmp_eq_u32 s3, 0
    s_cbranch_scc1 adaLN_cond__spectral_fnet__geglu_ffn__prompt_kernel_wn11
    s_sub_u32 s74, s2, 128
    s_mul_i32 s74, s74, 3
    s_add_u32 s74, s74, s3
    s_sub_u32 s74, s74, 1
    s_lshr_b32 s52, s74, 3
    s_mul_i32 s52, s52, 40960
    s_and_b32 s53, s74, 7
    s_mul_i32 s53, s53, 160
    s_add_u32 s52, s52, s53
    s_mul_i32 s75, s3, 5120
    s_add_u32 s75, s75, 139264
    s_mov_b32 m0, s75
    s_mov_b32 s54, 429496730
    s_waitcnt lgkmcnt(0)
    s_mov_b32 s24, s40
    s_and_b32 s25, s41, 0xffff
    s_mov_b32 s26, 1966080
    s_mov_b32 s27, 0x20000
    v_add_u32 v234, 0, v1
    v_mul_hi_u32 v235, v234, s54
    v_mul_u32_u24 v235, 1120, v235
    v_lshl_add_u32 v235, v234, 4, v235
    buffer_load_dwordx4 v235, s[24:27], s52 offen lds
    s_add_u32 m0, m0, 1024
    v_add_u32 v234, 64, v1
    v_mul_hi_u32 v235, v234, s54
    v_mul_u32_u24 v235, 1120, v235
    v_lshl_add_u32 v235, v234, 4, v235
    buffer_load_dwordx4 v235, s[24:27], s52 offen lds
    s_add_u32 m0, m0, 1024
    v_add_u32 v234, 128, v1
    v_mul_hi_u32 v235, v234, s54
    v_mul_u32_u24 v235, 1120, v235
    v_lshl_add_u32 v235, v234, 4, v235
    buffer_load_dwordx4 v235, s[24:27], s52 offen lds
    s_add_u32 m0, m0, 1024
    v_add_u32 v234, 192, v1
    v_mul_hi_u32 v235, v234, s54
    v_mul_u32_u24 v235, 1120, v235
    v_lshl_add_u32 v235, v234, 4, v235
    buffer_load_dwordx4 v235, s[24:27], s52 offen lds
    s_add_u32 m0, m0, 1024
    v_add_u32 v234, 256, v1
    v_mul_hi_u32 v235, v234, s54
    v_mul_u32_u24 v235, 1120, v235
    v_lshl_add_u32 v235, v234, 4, v235
    buffer_load_dwordx4 v235, s[24:27], s52 offen lds
adaLN_cond__spectral_fnet__geglu_ffn__prompt_kernel_wn11:
adaLN_cond__spectral_fnet__geglu_ffn__prompt_kernel_e10:
    s_waitcnt lgkmcnt(0)
    s_add_u32 s60, s50, 16777216
    s_addc_u32 s61, s51, 0
    s_load_dword s14, s[60:61], 0
    s_cmp_ge_u32 s3, 2
    s_cselect_b32 s52, -1008, 0
    s_cmp_eq_u32 s12, 0
    s_cselect_b32 s52, s52, s12
    s_lshl_b32 s53, s3, 9
    s_add_u32 s73, s52, s53
    s_cmp_eq_u32 s12, 0
    s_cselect_b32 s54, 1, 0
    s_lshr_b32 s55, s3, 1
    s_and_b32 s52, s54, s55
    s_andn2_b32 s53, s54, s55
    v_and_b32 v233, 1, v2
    v_cvt_f32_u32 v233, v233
    v_mul_f32 v233, 0x3e800000, v233
    s_cmp_eq_u32 s12, 0
    s_cselect_b32 s54, 0, 0xbe800000
    v_add_f32 v235, s54, v233
    v_mov_b32 v238, 0x3e800000
    v_lshlrev_b32 v236, 2, v3
    v_cvt_f32_u32 v236, v236
    s_cmp_lg_u32 s52, 0
    s_cselect_b64 s[68:69], -1, 0
    s_cmp_lg_u32 s53, 0
    s_cselect_b64 s[70:71], -1, 0
    v_cndmask_b32 v233, v233, v238, s[68:69]
    v_cndmask_b32 v235, v235, v238, s[70:71]
    v_lshrrev_b32 v232, 1, v2
    v_lshl_add_u32 v232, v232, 5, s73
    v_cvt_f32_u32 v232, v232
    v_mul_f32 v232, 0x3a000000, v232
    v_cndmask_b32 v234, v232, 0, s[70:71]
    v_cndmask_b32 v232, v232, 0, s[68:69]
    v_mov_b32 v237, v233
    s_cmp_eq_u32 s73, 0
    s_cselect_b32 s54, 1, 99
    v_cmp_eq_u32 vcc, s54, v2
    s_nop 1
    v_cndmask_b32 v232, v232, 0.5, vcc
    v_cndmask_b32 v237, v237, 0, vcc
    v_fma_f32 v237, v232, v236, v237
    v_fma_f32 v239, v234, v236, v235
    v_fmamk_f32 v240, v232, 0.0, v237
    v_fmamk_f32 v241, v234, 0.0, v239
    v_fmamk_f32 v242, v232, 1.0, v237
    v_fmamk_f32 v243, v234, 1.0, v239
    v_fmamk_f32 v244, v232, 2.0, v237
    v_fmamk_f32 v245, v234, 2.0, v239
    v_fmamk_f32 v246, v232, 3.0, v237
    v_fmamk_f32 v247, v234, 3.0, v239
    v_cos_f32 v240, v240
    v_cos_f32 v241, v241
    v_cos_f32 v242, v242
    v_cos_f32 v243, v243
    v_cos_f32 v244, v244
    v_cos_f32 v245, v245
    v_cos_f32 v246, v246
    v_cos_f32 v247, v247
    v_cvt_pk_bf16_f32 v200, v240, v241
    v_cvt_pk_bf16_f32 v201, v242, v243
    v_cvt_pk_bf16_f32 v202, v244, v245
    v_cvt_pk_bf16_f32 v203, v246, v247
    v_fmamk_f32 v240, v232, 16.0, v237
    v_fmamk_f32 v241, v234, 16.0, v239
    v_fmamk_f32 v242, v232, 17.0, v237
    v_fmamk_f32 v243, v234, 17.0, v239
    v_fmamk_f32 v244, v232, 18.0, v237
    v_fmamk_f32 v245, v234, 18.0, v239
    v_fmamk_f32 v246, v232, 19.0, v237
    v_fmamk_f32 v247, v234, 19.0, v239
    v_cos_f32 v240, v240
    v_cos_f32 v241, v241
    v_cos_f32 v242, v242
    v_cos_f32 v243, v243
    v_cos_f32 v244, v244
    v_cos_f32 v245, v245
    v_cos_f32 v246, v246
    v_cos_f32 v247, v247
    v_cvt_pk_bf16_f32 v204, v240, v241
    v_cvt_pk_bf16_f32 v205, v242, v243
    v_cvt_pk_bf16_f32 v206, v244, v245
    v_cvt_pk_bf16_f32 v207, v246, v247
    v_fmamk_f32 v240, v232, 32.0, v237
    v_fmamk_f32 v241, v234, 32.0, v239
    v_fmamk_f32 v242, v232, 33.0, v237
    v_fmamk_f32 v243, v234, 33.0, v239
    v_fmamk_f32 v244, v232, 34.0, v237
    v_fmamk_f32 v245, v234, 34.0, v239
    v_fmamk_f32 v246, v232, 35.0, v237
    v_fmamk_f32 v247, v234, 35.0, v239
    v_cos_f32 v240, v240
    v_cos_f32 v241, v241
    v_cos_f32 v242, v242
    v_cos_f32 v243, v243
    v_cos_f32 v244, v244
    v_cos_f32 v245, v245
    v_cos_f32 v246, v246
    v_cos_f32 v247, v247
    v_cvt_pk_bf16_f32 v208, v240, v241
    v_cvt_pk_bf16_f32 v209, v242, v243
    v_cvt_pk_bf16_f32 v210, v244, v245
    v_cvt_pk_bf16_f32 v211, v246, v247
    v_fmamk_f32 v240, v232, 48.0, v237
    v_fmamk_f32 v241, v234, 48.0, v239
    v_fmamk_f32 v242, v232, 49.0, v237
    v_fmamk_f32 v243, v234, 49.0, v239
    v_fmamk_f32 v244, v232, 50.0, v237
    v_fmamk_f32 v245, v234, 50.0, v239
    v_fmamk_f32 v246, v232, 51.0, v237
    v_fmamk_f32 v247, v234, 51.0, v239
    v_cos_f32 v240, v240
    v_cos_f32 v241, v241
    v_cos_f32 v242, v242
    v_cos_f32 v243, v243
    v_cos_f32 v244, v244
    v_cos_f32 v245, v245
    v_cos_f32 v246, v246
    v_cos_f32 v247, v247
    v_cvt_pk_bf16_f32 v212, v240, v241
    v_cvt_pk_bf16_f32 v213, v242, v243
    v_cvt_pk_bf16_f32 v214, v244, v245
    v_cvt_pk_bf16_f32 v215, v246, v247
    s_mov_b64 exec, 0
    s_cmp_eq_u32 s3, 0
    s_cbranch_scc1 adaLN_cond__spectral_fnet__geglu_ffn__prompt_kernel_hop0
    s_cmp_eq_u32 s3, 1
    s_cbranch_scc1 adaLN_cond__spectral_fnet__geglu_ffn__prompt_kernel_hop1
    s_cmp_eq_u32 s3, 2
    s_cbranch_scc1 adaLN_cond__spectral_fnet__geglu_ffn__prompt_kernel_hop2
    s_cmp_eq_u32 s3, 3
    s_cbranch_scc1 adaLN_cond__spectral_fnet__geglu_ffn__prompt_kernel_hop3
adaLN_cond__spectral_fnet__geglu_ffn__prompt_kernel_back12:
    s_mov_b64 exec, -1
    s_branch adaLN_cond__spectral_fnet__geglu_ffn__prompt_kernel_main13
    .p2align 12
adaLN_cond__spectral_fnet__geglu_ffn__prompt_kernel_main13:
adaLN_cond__spectral_fnet__geglu_ffn__prompt_kernel_hop0:
    s_cbranch_execz adaLN_cond__spectral_fnet__geglu_ffn__prompt_kernel_hop4
    s_mov_b32 s16, s50
    s_and_b32 s17, s51, 0xffff
    s_mov_b32 s18, 18874368
    s_mov_b32 s19, 0x20000
    v_lshlrev_b32 v18, 4, v1
    s_getpc_b64 s[52:53]
adaLN_cond__spectral_fnet__geglu_ffn__prompt_kernel_pc14:
    s_add_u32 s52, s52, adaLN_cond__spectral_fnet__geglu_ffn__prompt_kernel_tab-adaLN_cond__spectral_fnet__geglu_ffn__prompt_kernel_pc14
    s_addc_u32 s53, s53, 0
    s_mov_b32 s24, s52
    s_and_b32 s25, s53, 0xffff
    s_mov_b32 s26, 17408
    s_mov_b32 s27, 0x20000
    s_lshl_b32 s53, s3, 12
    s_add_u32 m0, s53, 20480
    s_nop 0
    buffer_load_dwordx4 v18, s[24:27], s53 offen offset:0 lds
    buffer_load_dwordx4 v18, s[24:27], s53 offen offset:1024 lds
    buffer_load_dwordx4 v18, s[24:27], s53 offen offset:2048 lds
    buffer_load_dwordx4 v18, s[24:27], s53 offen offset:3072 lds
    s_mov_b32 m0, 36864
    s_mov_b32 s53, 16384
    buffer_load_dwordx4 v18, s[24:27], s53 offen lds
    s_cmp_le_u32 s3, 2
    s_cselect_b32 s28, s36, s38
    s_cselect_b32 s29, s37, s39
    s_and_b32 s29, s29, 0xffff
    s_mov_b32 s30, 1966080
    s_mov_b32 s31, 0x20000
    s_cmp_le_u32 s3, 1
    s_cselect_b32 s32, s36, s38
    s_cselect_b32 s33, s37, s39
    s_and_b32 s33, s33, 0xffff
    s_mov_b32 s34, 1966080
    s_mov_b32 s35, 0x20000
    s_sub_u32 s52, s3, 1
    s_lshl_b32 s56, s52, 12
    s_add_u32 s56, s56, 40960
    s_mul_i32 s57, s13, 192
    s_mov_b32 s53, 357913942
    s_lshl_b32 s52, s52, 2
    s_add_u32 s54, s52, 0
    s_cmp_ge_u32 s54, 6
    s_cselect_b32 s55, 6, 0
    s_sub_u32 s54, s54, s55
    s_lshl_b32 s54, s54, 6
    v_add_u32 v240, s54, v1
    v_mul_hi_u32 v241, v240, s53
    v_mul_u32_u24 v242, 12, v241
    v_sub_u32 v242, v240, v242
    v_lshlrev_b32 v242, 4, v242
    v_lshrrev_b32 v243, 3, v241
    v_and_b32 v244, 7, v241
    v_lshl_add_u32 v245, v244, 4, v243
    v_mul_u32_u24 v245, 3072, v245
    v_add_u32 v4, v245, v242
    v_lshrrev_b32 v245, 1, v244
    v_lshl_add_u32 v245, v243, 2, v245
    v_and_b32 v244, 1, v244
    v_lshl_add_u32 v245, v244, 4, v245
    v_mul_u32_u24 v245, 3072, v245
    v_add_u32 v8, v245, v242
    s_add_u32 s54, s52, 1
    s_cmp_ge_u32 s54, 6
    s_cselect_b32 s55, 6, 0
    s_sub_u32 s54, s54, s55
    s_lshl_b32 s54, s54, 6
    v_add_u32 v240, s54, v1
    v_mul_hi_u32 v241, v240, s53
    v_mul_u32_u24 v242, 12, v241
    v_sub_u32 v242, v240, v242
    v_lshlrev_b32 v242, 4, v242
    v_lshrrev_b32 v243, 3, v241
    v_and_b32 v244, 7, v241
    v_lshl_add_u32 v245, v244, 4, v243
    v_mul_u32_u24 v245, 3072, v245
    v_add_u32 v5, v245, v242
    v_lshrrev_b32 v245, 1, v244
    v_lshl_add_u32 v245, v243, 2, v245
    v_and_b32 v244, 1, v244
    v_lshl_add_u32 v245, v244, 4, v245
    v_mul_u32_u24 v245, 3072, v245
    v_add_u32 v9, v245, v242
    s_add_u32 s54, s52, 2
    s_cmp_ge_u32 s54, 6
    s_cselect_b32 s55, 6, 0
    s_sub_u32 s54, s54, s55
    s_lshl_b32 s54, s54, 6
    v_add_u32 v240, s54, v1
    v_mul_hi_u32 v241, v240, s53
    v_mul_u32_u24 v242, 12, v241
    v_sub_u32 v242, v240, v242
    v_lshlrev_b32 v242, 4, v242
    v_lshrrev_b32 v243, 3, v241
    v_and_b32 v244, 7, v241
    v_lshl_add_u32 v245, v244, 4, v243
    v_mul_u32_u24 v245, 3072, v245
    v_add_u32 v6, v245, v242
    v_lshrrev_b32 v245, 1, v244
    v_lshl_add_u32 v245, v243, 2, v245
    v_and_b32 v244, 1, v244
    v_lshl_add_u32 v245, v244, 4, v245
    v_mul_u32_u24 v245, 3072, v245
    v_add_u32 v10, v245, v242
    s_add_u32 s54, s52, 3
    s_cmp_ge_u32 s54, 6
    s_cselect_b32 s55, 6, 0
    s_sub_u32 s54, s54, s55
    s_lshl_b32 s54, s54, 6
    v_add_u32 v240, s54, v1
    v_mul_hi_u32 v241, v240, s53
    v_mul_u32_u24 v242, 12, v241
    v_sub_u32 v242, v240, v242
    v_lshlrev_b32 v242, 4, v242
    v_lshrrev_b32 v243, 3, v241
    v_and_b32 v244, 7, v241
    v_lshl_add_u32 v245, v244, 4, v243
    v_mul_u32_u24 v245, 3072, v245
    v_add_u32 v7, v245, v242
    v_lshrrev_b32 v245, 1, v244
    v_lshl_add_u32 v245, v243, 2, v245
    v_and_b32 v244, 1, v244
    v_lshl_add_u32 v245, v244, 4, v245
    v_mul_u32_u24 v245, 3072, v245
    v_add_u32 v11, v245, v242
    s_cmp_lg_u32 s3, 0
    s_cbranch_scc1 adaLN_cond__spectral_fnet__geglu_ffn__prompt_kernel_w015
    v_lshlrev_b32 v252, 7, v1
    s_mul_i32 s52, s2, 7680
    s_mov_b32 s32, s38
    s_and_b32 s33, s39, 0xffff
    buffer_load_dword a246, v252, s[28:31], s52 offen
    buffer_load_dword a246, v252, s[32:35], s52 offen
adaLN_cond__spectral_fnet__geglu_ffn__prompt_kernel_w015:
    s_waitcnt lgkmcnt(0)
    s_mul_i32 s14, s14, 0x9E3779B1
    s_add_u32 s14, s14, 0x7F4A7C15
    s_getreg_b32 s52, hwreg(HW_REG_XCC_ID, 0, 4)
    s_add_u32 s52, s52, 1
    s_xor_b32 s59, s14, s52
    s_cmp_ge_u32 s2, 128
    s_cbranch_scc1 adaLN_cond__spectral_fnet__geglu_ffn__prompt_kernel_mod2
    s_mov_b32 s62, 0x05040100
    s_mov_b32 s63, 0x07060302
    v_lshlrev_b32 v234, 3, v3
    v_cvt_f32_u32 v234, v234
    s_bfe_u32 s67, s2, 0x10003
    s_lshl_b32 s52, s67, 3
    v_lshrrev_b32 v232, 1, v2
    v_add_u32 v232, s52, v232
    v_and_b32 v233, 1, v2
    s_cmp_eq_u32 s67, 0
    s_cselect_b32 s52, 1, 99
    v_cmp_eq_u32 vcc, s52, v2
    s_nop 1
    v_cndmask_b32 v232, v232, 16, vcc
    v_cndmask_b32 v233, v233, 0, vcc
    v_cvt_f32_u32 v232, v232
    v_cvt_f32_u32 v233, v233
    v_mul_f32 v232, 0x3d000000, v232
    v_mul_f32 v233, 0x3e800000, v233
    v_fma_f32 v233, v232, v234, v233
    v_fmamk_f32 v100, v232, 0.0, v233
    v_fmamk_f32 v101, v232, 1.0, v233
    v_fmamk_f32 v102, v232, 2.0, v233
    v_fmamk_f32 v103, v232, 3.0, v233
    v_fmamk_f32 v104, v232, 4.0, v233
    v_fmamk_f32 v105, v232, 5.0, v233
    v_fmamk_f32 v106, v232, 6.0, v233
    v_fmamk_f32 v107, v232, 7.0, v233
    v_cos_f32 v100, v100
    v_cos_f32 v101, v101
    v_cos_f32 v102, v102
    v_cos_f32 v103, v103
    v_cos_f32 v104, v104
    v_cos_f32 v105, v105
    v_cos_f32 v106, v106
    v_cos_f32 v107, v107
    s_mul_i32 s52, s3, 320
    s_mov_b32 s53, 327680
    v_mul_u32_u24 v232, s53, v3
    v_add_u32 v232, s52, v232
    v_lshl_add_u32 v250, v2, 4, v232
    v_lshl_add_u32 v251, v2, 2, v232
    s_mul_i32 s64, s66, 2560
    s_mul_i32 s52, s67, 1310720
    s_add_u32 s64, s64, s52
    s_add_u32 s65, s64, 163840
    v_mov_b32 v235, 0x3f803f80
    v_mov_b32 v116, 0
    v_mov_b32 v117, 0
    v_mov_b32 v118, 0
    v_mov_b32 v119, 0
    v_mov_b32 v120, 0
    v_mov_b32 v121, 0
    v_mov_b32 v122, 0
    v_mov_b32 v123, 0
    v_mov_b32 v124, 0
    v_mov_b32 v125, 0
    v_mov_b32 v126, 0
    v_mov_b32 v127, 0
    v_mov_b32 v128, 0
    v_mov_b32 v129, 0
    v_mov_b32 v130, 0
    v_mov_b32 v131, 0
    s_lshl_b32 s52, s3, 8
    v_lshrrev_b32 v236, 3, v2
    v_lshlrev_b32 v236, 7, v236
    v_bfe_u32 v237, v2, 2, 1
    v_lshl_add_u32 v236, v237, 4, v236
    v_lshl_add_u32 v236, v3, 5, v236
    v_add_u32 v236, s52, v236
    v_and_b32 v237, 7, v2
    v_lshlrev_b32 v237, 2, v237
    v_lshl_add_u32 v237, v3, 5, v237
    s_waitcnt vmcnt(14)
    v_dot2c_f32_bf16 v116, v20, v235
    v_dot2c_f32_bf16 v124, v20, v20
    v_dot2c_f32_bf16 v116, v21, v235
    v_dot2c_f32_bf16 v124, v21, v21
    v_dot2c_f32_bf16 v116, v22, v235
    v_dot2c_f32_bf16 v124, v22, v22
    v_dot2c_f32_bf16 v116, v23, v235
    v_dot2c_f32_bf16 v124, v23, v23
    s_waitcnt vmcnt(6)
    v_dot2c_f32_bf16 v116, v52, v235
    v_dot2c_f32_bf16 v124, v52, v52
    v_dot2c_f32_bf16 v117, v24, v235
    v_dot2c_f32_bf16 v125, v24, v24
    v_dot2c_f32_bf16 v117, v25, v235
    v_dot2c_f32_bf16 v125, v25, v25
    v_dot2c_f32_bf16 v117, v26, v235
    v_dot2c_f32_bf16 v125, v26, v26
    v_dot2c_f32_bf16 v117, v27, v235
    v_dot2c_f32_bf16 v125, v27, v27
    v_dot2c_f32_bf16 v117, v53, v235
    v_dot2c_f32_bf16 v125, v53, v53
    v_dot2c_f32_bf16 v118, v28, v235
    v_dot2c_f32_bf16 v126, v28, v28
    v_dot2c_f32_bf16 v118, v29, v235
    v_dot2c_f32_bf16 v126, v29, v29
    v_dot2c_f32_bf16 v118, v30, v235
    v_dot2c_f32_bf16 v126, v30, v30
    v_dot2c_f32_bf16 v118, v31, v235
    v_dot2c_f32_bf16 v126, v31, v31
    v_dot2c_f32_bf16 v118, v54, v235
    v_dot2c_f32_bf16 v126, v54, v54
    v_dot2c_f32_bf16 v119, v32, v235
    v_dot2c_f32_bf16 v127, v32, v32
    v_dot2c_f32_bf16 v119, v33, v235
    v_dot2c_f32_bf16 v127, v33, v33
    v_dot2c_f32_bf16 v119, v34, v235
    v_dot2c_f32_bf16 v127, v34, v34
    v_dot2c_f32_bf16 v119, v35, v235
    v_dot2c_f32_bf16 v127, v35, v35
    v_dot2c_f32_bf16 v119, v55, v235
    v_dot2c_f32_bf16 v127, v55, v55
    v_dot2c_f32_bf16 v120, v36, v235
    v_dot2c_f32_bf16 v128, v36, v36
    v_dot2c_f32_bf16 v120, v37, v235
    v_dot2c_f32_bf16 v128, v37, v37
    v_dot2c_f32_bf16 v120, v38, v235
    v_dot2c_f32_bf16 v128, v38, v38
    v_dot2c_f32_bf16 v120, v39, v235
    v_dot2c_f32_bf16 v128, v39, v39
    s_waitcnt vmcnt(5)
    v_dot2c_f32_bf16 v120, v56, v235
    v_dot2c_f32_bf16 v128, v56, v56
    v_dot2c_f32_bf16 v121, v40, v235
    v_dot2c_f32_bf16 v129, v40, v40
    v_dot2c_f32_bf16 v121, v41, v235
    v_dot2c_f32_bf16 v129, v41, v41
    v_dot2c_f32_bf16 v121, v42, v235
    v_dot2c_f32_bf16 v129, v42, v42
    v_dot2c_f32_bf16 v121, v43, v235
    v_dot2c_f32_bf16 v129, v43, v43
    v_dot2c_f32_bf16 v121, v57, v235
    v_dot2c_f32_bf16 v129, v57, v57
    v_dot2c_f32_bf16 v122, v44, v235
    v_dot2c_f32_bf16 v130, v44, v44
    v_dot2c_f32_bf16 v122, v45, v235
    v_dot2c_f32_bf16 v130, v45, v45
    v_dot2c_f32_bf16 v122, v46, v235
    v_dot2c_f32_bf16 v130, v46, v46
    v_dot2c_f32_bf16 v122, v47, v235
    v_dot2c_f32_bf16 v130, v47, v47
    v_dot2c_f32_bf16 v122, v58, v235
    v_dot2c_f32_bf16 v130, v58, v58
    v_dot2c_f32_bf16 v123, v48, v235
    v_dot2c_f32_bf16 v131, v48, v48
    v_dot2c_f32_bf16 v123, v49, v235
    v_dot2c_f32_bf16 v131, v49, v49
    v_dot2c_f32_bf16 v123, v50, v235
    v_dot2c_f32_bf16 v131, v50, v50
    v_dot2c_f32_bf16 v123, v51, v235
    v_dot2c_f32_bf16 v131, v51, v51
    v_dot2c_f32_bf16 v123, v59, v235
    v_dot2c_f32_bf16 v131, v59, v59
    v_add_f32_dpp v116, v116, v116 row_ror:8 row_mask:0xf bank_mask:0x3
    v_add_f32_dpp v117, v117, v117 row_ror:8 row_mask:0xf bank_mask:0x3
    v_add_f32_dpp v118, v118, v118 row_ror:8 row_mask:0xf bank_mask:0x3
    v_add_f32_dpp v119, v119, v119 row_ror:8 row_mask:0xf bank_mask:0x3
    v_add_f32_dpp v120, v120, v120 row_ror:8 row_mask:0xf bank_mask:0x3
    v_add_f32_dpp v121, v121, v121 row_ror:8 row_mask:0xf bank_mask:0x3
    v_add_f32_dpp v122, v122, v122 row_ror:8 row_mask:0xf bank_mask:0x3
    v_add_f32_dpp v123, v123, v123 row_ror:8 row_mask:0xf bank_mask:0x3
    v_add_f32_dpp v116, v124, v124 row_ror:8 row_mask:0xf bank_mask:0xc
    v_add_f32_dpp v117, v125, v125 row_ror:8 row_mask:0xf bank_mask:0xc
    v_add_f32_dpp v118, v126, v126 row_ror:8 row_mask:0xf bank_mask:0xc
    v_add_f32_dpp v119, v127, v127 row_ror:8 row_mask:0xf bank_mask:0xc
    v_add_f32_dpp v120, v128, v128 row_ror:8 row_mask:0xf bank_mask:0xc
    v_add_f32_dpp v121, v129, v129 row_ror:8 row_mask:0xf bank_mask:0xc
    v_add_f32_dpp v122, v130, v130 row_ror:8 row_mask:0xf bank_mask:0xc
    v_add_f32_dpp v123, v131, v131 row_ror:8 row_mask:0xf bank_mask:0xc
    v_add_f32_dpp v116, v116, v116 row_shl:4 row_mask:0xf bank_mask:0x5
    v_add_f32_dpp v117, v117, v117 row_shl:4 row_mask:0xf bank_mask:0x5
    v_add_f32_dpp v118, v118, v118 row_shl:4 row_mask:0xf bank_mask:0x5
    v_add_f32_dpp v119, v119, v119 row_shl:4 row_mask:0xf bank_mask:0x5
    v_add_f32_dpp v116, v120, v120 row_shr:4 row_mask:0xf bank_mask:0xa
    v_add_f32_dpp v117, v121, v121 row_shr:4 row_mask:0xf bank_mask:0xa
    v_add_f32_dpp v118, v122, v122 row_shr:4 row_mask:0xf bank_mask:0xa
    v_add_f32_dpp v119, v123, v123 row_shr:4 row_mask:0xf bank_mask:0xa
    v_add_f32_dpp v116, v116, v116 quad_perm:[1,0,3,2] row_mask:0xf bank_mask:0xf
    v_add_f32_dpp v117, v117, v117 quad_perm:[1,0,3,2] row_mask:0xf bank_mask:0xf
    v_add_f32_dpp v118, v118, v118 quad_perm:[1,0,3,2] row_mask:0xf bank_mask:0xf
    v_add_f32_dpp v119, v119, v119 quad_perm:[1,0,3,2] row_mask:0xf bank_mask:0xf
    v_add_f32_dpp v116, v116, v116 quad_perm:[2,3,0,1] row_mask:0xf bank_mask:0xf
    v_add_f32_dpp v117, v117, v117 quad_perm:[2,3,0,1] row_mask:0xf bank_mask:0xf
    v_add_f32_dpp v118, v118, v118 quad_perm:[2,3,0,1] row_mask:0xf bank_mask:0xf
    v_add_f32_dpp v119, v119, v119 quad_perm:[2,3,0,1] row_mask:0xf bank_mask:0xf
    ds_write_b128 v236, v[116:119]
    v_perm_b32 v60, v24, v20, s62
    v_perm_b32 v61, v32, v28, s62
    v_perm_b32 v62, v40, v36, s62
    v_perm_b32 v63, v48, v44, s62
    v_perm_b32 v64, v24, v20, s63
    v_perm_b32 v65, v32, v28, s63
    v_perm_b32 v66, v40, v36, s63
    v_perm_b32 v67, v48, v44, s63
    v_perm_b32 v68, v25, v21, s62
    v_perm_b32 v69, v33, v29, s62
    v_perm_b32 v70, v41, v37, s62
    v_perm_b32 v71, v49, v45, s62
    s_waitcnt lgkmcnt(0)
    s_barrier
    ds_read2_b32 v[120:121], v237 offset0:0 offset1:32
    ds_read2_b32 v[122:123], v237 offset0:64 offset1:96
    ds_read2_b32 v[124:125], v237 offset0:128 offset1:160
    ds_read2_b32 v[126:127], v237 offset0:192 offset1:224
    v_perm_b32 v72, v25, v21, s63
    v_perm_b32 v73, v33, v29, s63
    v_perm_b32 v74, v41, v37, s63
    v_perm_b32 v75, v49, v45, s63
    v_perm_b32 v76, v26, v22, s62
    v_perm_b32 v77, v34, v30, s62
    v_perm_b32 v78, v42, v38, s62
    v_perm_b32 v79, v50, v46, s62
    v_perm_b32 v80, v26, v22, s63
    v_perm_b32 v81, v34, v30, s63
    v_perm_b32 v82, v42, v38, s63
    v_perm_b32 v83, v50, v46, s63
    v_perm_b32 v84, v27, v23, s62
    v_perm_b32 v85, v35, v31, s62
    v_perm_b32 v86, v43, v39, s62
    v_perm_b32 v87, v51, v47, s62
    v_perm_b32 v88, v27, v23, s63
    v_perm_b32 v89, v35, v31, s63
    v_perm_b32 v90, v43, v39, s63
    v_perm_b32 v91, v51, v47, s63
    v_perm_b32 v92, v53, v52, s62
    v_perm_b32 v93, v55, v54, s62
    v_perm_b32 v94, v57, v56, s62
    v_perm_b32 v95, v59, v58, s62
    v_perm_b32 v96, v53, v52, s63
    v_perm_b32 v97, v55, v54, s63
    v_perm_b32 v98, v57, v56, s63
    v_perm_b32 v99, v59, v58, s63
    s_waitcnt lgkmcnt(2)
    v_add_f32 v116, v120, v122
    v_add_f32 v117, v121, v123
    s_waitcnt lgkmcnt(0)
    v_add_f32 v118, v124, v126
    v_add_f32 v119, v125, v127
    v_add_f32 v116, v116, v118
    v_add_f32 v117, v117, v119
    v_mul_f32 v116, 0xbacccccd, v116
    v_mul_f32 v117, 0x3acccccd, v117
    v_fma_f32 v117, -v116, v116, v117
    v_max_f32 v117, 0, v117
    v_add_f32 v117, 0x3727c5ac, v117
    v_rsq_f32 v117, v117
    v_mov_b32_dpp v120, v116 row_newbcast:0 row_mask:0xf bank_mask:0xf
    v_mov_b32_dpp v121, v116 row_newbcast:1 row_mask:0xf bank_mask:0xf
    v_mov_b32_dpp v122, v116 row_newbcast:2 row_mask:0xf bank_mask:0xf
    v_mov_b32_dpp v123, v116 row_newbcast:3 row_mask:0xf bank_mask:0xf
    v_mov_b32_dpp v124, v116 row_newbcast:4 row_mask:0xf bank_mask:0xf
    v_mov_b32_dpp v125, v116 row_newbcast:5 row_mask:0xf bank_mask:0xf
    v_mov_b32_dpp v126, v116 row_newbcast:6 row_mask:0xf bank_mask:0xf
    v_mov_b32_dpp v127, v116 row_newbcast:7 row_mask:0xf bank_mask:0xf
    v_mul_f32_dpp v100, v117, v100 row_newbcast:0 row_mask:0xf bank_mask:0xf
    v_mul_f32_dpp v101, v117, v101 row_newbcast:1 row_mask:0xf bank_mask:0xf
    v_mul_f32_dpp v102, v117, v102 row_newbcast:2 row_mask:0xf bank_mask:0xf
    v_mul_f32_dpp v103, v117, v103 row_newbcast:3 row_mask:0xf bank_mask:0xf
    v_mul_f32_dpp v104, v117, v104 row_newbcast:4 row_mask:0xf bank_mask:0xf
    v_mul_f32_dpp v105, v117, v105 row_newbcast:5 row_mask:0xf bank_mask:0xf
    v_mul_f32_dpp v106, v117, v106 row_newbcast:6 row_mask:0xf bank_mask:0xf
    v_mul_f32_dpp v107, v117, v107 row_newbcast:7 row_mask:0xf bank_mask:0xf
    v_cvt_pk_bf16_f32 v140, v120, v121
    v_cvt_pk_bf16_f32 v141, v122, v123
    v_cvt_pk_bf16_f32 v142, v124, v125
    v_cvt_pk_bf16_f32 v143, v126, v127
    v_cvt_pk_bf16_f32 v132, v100, v101
    v_cvt_pk_bf16_f32 v133, v102, v103
    v_cvt_pk_bf16_f32 v134, v104, v105
    v_cvt_pk_bf16_f32 v135, v106, v107
    s_nop 1
    v_mfma_f32_16x16x32_bf16 v[144:147], v[132:135], v[140:143], 0
    v_mfma_f32_16x16x32_bf16 v[152:155], v[132:135], v[60:63], v[144:147]
    v_mfma_f32_16x16x32_bf16 v[156:159], v[132:135], v[64:67], v[144:147]
    v_mfma_f32_16x16x32_bf16 v[160:163], v[132:135], v[68:71], v[144:147]
    v_mfma_f32_16x16x32_bf16 v[164:167], v[132:135], v[72:75], v[144:147]
    v_mfma_f32_16x16x32_bf16 v[168:171], v[132:135], v[76:79], v[144:147]
    v_mfma_f32_16x16x32_bf16 v[172:175], v[132:135], v[80:83], v[144:147]
    v_mfma_f32_16x16x32_bf16 v[176:179], v[132:135], v[84:87], v[144:147]
    v_mfma_f32_16x16x32_bf16 v[180:183], v[132:135], v[88:91], v[144:147]
    v_mfma_f32_16x16x32_bf16 v[184:187], v[132:135], v[92:95], v[144:147]
    v_mfma_f32_16x16x32_bf16 v[188:191], v[132:135], v[96:99], v[144:147]
    v_cvt_pk_bf16_f32 v20, v152, v156
    s_nop 0
    v_cvt_pk_bf16_f32 v21, v160, v164
    s_nop 0
    v_cvt_pk_bf16_f32 v22, v168, v172
    s_nop 0
    v_cvt_pk_bf16_f32 v23, v176, v180
    s_nop 0
    v_cvt_pk_bf16_f32 v52, v184, v188
    buffer_store_dwordx4 v[20:23], v250, s[16:19], s64 offen offset:0 sc1
    buffer_store_dword v52, v251, s[16:19], s64 offen offset:256 sc1
    v_cvt_pk_bf16_f32 v24, v153, v157
    v_cvt_pk_bf16_f32 v25, v161, v165
    v_cvt_pk_bf16_f32 v26, v169, v173
    v_cvt_pk_bf16_f32 v27, v177, v181
    v_cvt_pk_bf16_f32 v53, v185, v189
    buffer_store_dwordx4 v[24:27], v250, s[16:19], s64 offen offset:1280 sc1
    buffer_store_dword v53, v251, s[16:19], s64 offen offset:1536 sc1
    v_cvt_pk_bf16_f32 v28, v154, v158
    v_cvt_pk_bf16_f32 v29, v162, v166
    v_cvt_pk_bf16_f32 v30, v170, v174
    v_cvt_pk_bf16_f32 v31, v178, v182
    v_cvt_pk_bf16_f32 v54, v186, v190
    buffer_store_dwordx4 v[28:31], v250, s[16:19], s65 offen offset:0 sc1
    buffer_store_dword v54, v251, s[16:19], s65 offen offset:256 sc1
    v_cvt_pk_bf16_f32 v32, v155, v159
    v_cvt_pk_bf16_f32 v33, v163, v167
    v_cvt_pk_bf16_f32 v34, v171, v175
    v_cvt_pk_bf16_f32 v35, v179, v183
    v_cvt_pk_bf16_f32 v55, v187, v191
    buffer_store_dwordx4 v[32:35], v250, s[16:19], s65 offen offset:1280 sc1
    buffer_store_dword v55, v251, s[16:19], s65 offen offset:1536 sc1
    s_branch adaLN_cond__spectral_fnet__geglu_ffn__prompt_kernel_join5
adaLN_cond__spectral_fnet__geglu_ffn__prompt_kernel_none4:
    s_branch adaLN_cond__spectral_fnet__geglu_ffn__prompt_kernel_shuf3
adaLN_cond__spectral_fnet__geglu_ffn__prompt_kernel_mod2:
    s_cmp_ge_u32 s2, 248
    s_cbranch_scc1 adaLN_cond__spectral_fnet__geglu_ffn__prompt_kernel_none4
    s_mov_b32 s62, 0x05040100
    s_mov_b32 s63, 0x07060302
    s_waitcnt vmcnt(16)
    v_lshlrev_b32 v68, 16, v60
    v_and_b32 v69, 0xffff0000, v60
    v_lshlrev_b32 v70, 16, v61
    v_and_b32 v71, 0xffff0000, v61
    v_lshlrev_b32 v72, 16, v62
    v_and_b32 v73, 0xffff0000, v62
    v_lshlrev_b32 v74, 16, v63
    v_and_b32 v75, 0xffff0000, v63
    s_waitcnt vmcnt(15)
    v_lshlrev_b32 v76, 16, v64
    v_and_b32 v77, 0xffff0000, v64
    v_mul_f32 v96, 0xbfb8aa3b, v68
    v_mul_f32 v97, 0xbfb8aa3b, v69
    v_mul_f32 v98, 0xbfb8aa3b, v70
    v_mul_f32 v99, 0xbfb8aa3b, v71
    v_mul_f32 v100, 0xbfb8aa3b, v72
    v_mul_f32 v101, 0xbfb8aa3b, v73
    v_mul_f32 v102, 0xbfb8aa3b, v74
    v_mul_f32 v103, 0xbfb8aa3b, v75
    v_mul_f32 v104, 0xbfb8aa3b, v76
    v_mul_f32 v105, 0xbfb8aa3b, v77
    v_exp_f32 v96, v96
    v_exp_f32 v97, v97
    v_exp_f32 v98, v98
    v_exp_f32 v99, v99
    v_exp_f32 v100, v100
    v_exp_f32 v101, v101
    v_exp_f32 v102, v102
    v_exp_f32 v103, v103
    v_exp_f32 v104, v104
    v_exp_f32 v105, v105
    v_add_f32 v96, 1.0, v96
    v_add_f32 v97, 1.0, v97
    v_add_f32 v98, 1.0, v98
    v_add_f32 v99, 1.0, v99
    v_add_f32 v100, 1.0, v100
    v_add_f32 v101, 1.0, v101
    v_add_f32 v102, 1.0, v102
    v_add_f32 v103, 1.0, v103
    v_add_f32 v104, 1.0, v104
    v_add_f32 v105, 1.0, v105
    v_rcp_f32 v120, v96
    v_rcp_f32 v121, v97
    v_rcp_f32 v122, v98
    v_rcp_f32 v123, v99
    v_rcp_f32 v124, v100
    v_rcp_f32 v125, v101
    v_rcp_f32 v126, v102
    v_rcp_f32 v127, v103
    v_rcp_f32 v128, v104
    v_rcp_f32 v129, v105
    v_mul_f32 v108, v68, v120
    v_mul_f32 v109, v69, v121
    v_mul_f32 v110, v70, v122
    v_mul_f32 v111, v71, v123
    v_mul_f32 v112, v72, v124
    v_mul_f32 v113, v73, v125
    v_mul_f32 v114, v74, v126
    v_mul_f32 v115, v75, v127
    v_mul_f32 v116, v76, v128
    v_mul_f32 v117, v77, v129
    v_fma_f32 v96, -v108, v96, v68
    v_fma_f32 v97, -v109, v97, v69
    v_fma_f32 v98, -v110, v98, v70
    v_fma_f32 v99, -v111, v99, v71
    v_fma_f32 v100, -v112, v100, v72
    v_fma_f32 v101, -v113, v101, v73
    v_fma_f32 v102, -v114, v102, v74
    v_fma_f32 v103, -v115, v103, v75
    v_fma_f32 v104, -v116, v104, v76
    v_fma_f32 v105, -v117, v105, v77
    v_fma_f32 v96, v96, v120, v108
    v_fma_f32 v97, v97, v121, v109
    v_fma_f32 v98, v98, v122, v110
    v_fma_f32 v99, v99, v123, v111
    v_fma_f32 v100, v100, v124, v112
    v_fma_f32 v101, v101, v125, v113
    v_fma_f32 v102, v102, v126, v114
    v_fma_f32 v103, v103, v127, v115
    v_fma_f32 v104, v104, v128, v116
    v_fma_f32 v105, v105, v129, v117
    v_cmp_o_f32 vcc, v96, v96
    s_nop 1
    v_cndmask_b32 v68, v108, v96, vcc
    v_cmp_o_f32 vcc, v97, v97
    s_nop 1
    v_cndmask_b32 v69, v109, v97, vcc
    v_cmp_o_f32 vcc, v98, v98
    s_nop 1
    v_cndmask_b32 v70, v110, v98, vcc
    v_cmp_o_f32 vcc, v99, v99
    s_nop 1
    v_cndmask_b32 v71, v111, v99, vcc
    v_cmp_o_f32 vcc, v100, v100
    s_nop 1
    v_cndmask_b32 v72, v112, v100, vcc
    v_cmp_o_f32 vcc, v101, v101
    s_nop 1
    v_cndmask_b32 v73, v113, v101, vcc
    v_cmp_o_f32 vcc, v102, v102
    s_nop 1
    v_cndmask_b32 v74, v114, v102, vcc
    v_cmp_o_f32 vcc, v103, v103
    s_nop 1
    v_cndmask_b32 v75, v115, v103, vcc
    v_cmp_o_f32 vcc, v104, v104
    s_nop 1
    v_cndmask_b32 v76, v116, v104, vcc
    v_cmp_o_f32 vcc, v105, v105
    s_nop 1
    v_cndmask_b32 v77, v117, v105, vcc
    v_cvt_pk_bf16_f32 v80, v68, v69
    v_cvt_pk_bf16_f32 v81, v70, v71
    v_cvt_pk_bf16_f32 v82, v72, v73
    v_cvt_pk_bf16_f32 v83, v74, v75
    v_cvt_pk_bf16_f32 v84, v76, v77
    v_mov_b32 v88, 0
    v_mov_b32 v89, 0
    v_mov_b32 v90, 0
    v_mov_b32 v91, 0
    v_mov_b32 v92, 0
    v_mov_b32 v93, 0
    v_mov_b32 v94, 0
    v_mov_b32 v95, 0
    s_mul_i32 s66, s64, 26
    s_lshr_b32 s66, s66, 8
    s_mul_i32 s52, s66, 10
    s_sub_u32 s52, s64, s52
    s_lshl_b32 s52, s52, 6
    v_add_u32 v140, s52, v1
    s_mul_i32 s53, s66, 640
    s_add_u32 s54, s53, 768
    s_cmp_lt_u32 s66, 2
    s_cselect_b32 s53, s53, s54
    s_cmp_eq_u32 s66, 5
    s_cselect_b32 s53, 1280, s53
    v_add_lshl_u32 v143, v140, s53, 2
    s_mul_i32 s67, s65, 16384
    s_add_u32 s67, s67, 6291456
    v_lshrrev_b32 v141, 4, v0
    v_lshlrev_b32 v141, 8, v141
    v_lshl_add_u32 v141, v250, 5, v141
    v_lshlrev_b32 v142, 2, v1
    s_waitcnt vmcnt(13)
    v_perm_b32 v96, v24, v20, s62
    v_perm_b32 v97, v24, v20, s63
    v_perm_b32 v98, v25, v21, s62
    v_perm_b32 v99, v25, v21, s63
    v_perm_b32 v100, v26, v22, s62
    v_perm_b32 v101, v26, v22, s63
    v_perm_b32 v102, v27, v23, s62
    v_perm_b32 v103, v27, v23, s63
    v_dot2c_f32_bf16 v88, v96, v80
    v_dot2c_f32_bf16 v89, v97, v80
    v_dot2c_f32_bf16 v90, v98, v80
    v_dot2c_f32_bf16 v91, v99, v80
    v_dot2c_f32_bf16 v92, v100, v80
    v_dot2c_f32_bf16 v93, v101, v80
    v_dot2c_f32_bf16 v94, v102, v80
    v_dot2c_f32_bf16 v95, v103, v80
    s_waitcnt vmcnt(11)
    v_perm_b32 v96, v32, v28, s62
    v_perm_b32 v97, v32, v28, s63
    v_perm_b32 v98, v33, v29, s62
    v_perm_b32 v99, v33, v29, s63
    v_perm_b32 v100, v34, v30, s62
    v_perm_b32 v101, v34, v30, s63
    v_perm_b32 v102, v35, v31, s62
    v_perm_b32 v103, v35, v31, s63
    v_dot2c_f32_bf16 v88, v96, v81
    v_dot2c_f32_bf16 v89, v97, v81
    v_dot2c_f32_bf16 v90, v98, v81
    v_dot2c_f32_bf16 v91, v99, v81
    v_dot2c_f32_bf16 v92, v100, v81
    v_dot2c_f32_bf16 v93, v101, v81
    v_dot2c_f32_bf16 v94, v102, v81
    v_dot2c_f32_bf16 v95, v103, v81
    s_waitcnt vmcnt(9)
    v_perm_b32 v96, v40, v36, s62
    v_perm_b32 v97, v40, v36, s63
    v_perm_b32 v98, v41, v37, s62
    v_perm_b32 v99, v41, v37, s63
    v_perm_b32 v100, v42, v38, s62
    v_perm_b32 v101, v42, v38, s63
    v_perm_b32 v102, v43, v39, s62
    v_perm_b32 v103, v43, v39, s63
    v_dot2c_f32_bf16 v88, v96, v82
    v_dot2c_f32_bf16 v89, v97, v82
    v_dot2c_f32_bf16 v90, v98, v82
    v_dot2c_f32_bf16 v91, v99, v82
    v_dot2c_f32_bf16 v92, v100, v82
    v_dot2c_f32_bf16 v93, v101, v82
    v_dot2c_f32_bf16 v94, v102, v82
    v_dot2c_f32_bf16 v95, v103, v82
    s_waitcnt vmcnt(6)
    v_perm_b32 v96, v48, v44, s62
    v_perm_b32 v97, v48, v44, s63
    v_perm_b32 v98, v49, v45, s62
    v_perm_b32 v99, v49, v45, s63
    v_perm_b32 v100, v50, v46, s62
    v_perm_b32 v101, v50, v46, s63
    v_perm_b32 v102, v51, v47, s62
    v_perm_b32 v103, v51, v47, s63
    v_dot2c_f32_bf16 v88, v96, v83
    v_dot2c_f32_bf16 v89, v97, v83
    v_dot2c_f32_bf16 v90, v98, v83
    v_dot2c_f32_bf16 v91, v99, v83
    v_dot2c_f32_bf16 v92, v100, v83
    v_dot2c_f32_bf16 v93, v101, v83
    v_dot2c_f32_bf16 v94, v102, v83
    v_dot2c_f32_bf16 v95, v103, v83
    s_waitcnt vmcnt(5)
    v_perm_b32 v96, v56, v52, s62
    v_perm_b32 v97, v56, v52, s63
    v_perm_b32 v98, v57, v53, s62
    v_perm_b32 v99, v57, v53, s63
    v_perm_b32 v100, v58, v54, s62
    v_perm_b32 v101, v58, v54, s63
    v_perm_b32 v102, v59, v55, s62
    v_perm_b32 v103, v59, v55, s63
    v_dot2c_f32_bf16 v88, v96, v84
    v_dot2c_f32_bf16 v89, v97, v84
    v_dot2c_f32_bf16 v90, v98, v84
    v_dot2c_f32_bf16 v91, v99, v84
    v_dot2c_f32_bf16 v92, v100, v84
    v_dot2c_f32_bf16 v93, v101, v84
    v_dot2c_f32_bf16 v94, v102, v84
    v_dot2c_f32_bf16 v95, v103, v84
    v_add_f32_dpp v88, v88, v88 row_ror:8 row_mask:0xf bank_mask:0xf
    v_add_f32_dpp v89, v89, v89 row_ror:8 row_mask:0xf bank_mask:0xf
    v_add_f32_dpp v90, v90, v90 row_ror:8 row_mask:0xf bank_mask:0xf
    v_add_f32_dpp v91, v91, v91 row_ror:8 row_mask:0xf bank_mask:0xf
    v_add_f32_dpp v92, v92, v92 row_ror:8 row_mask:0xf bank_mask:0xf
    v_add_f32_dpp v93, v93, v93 row_ror:8 row_mask:0xf bank_mask:0xf
    v_add_f32_dpp v94, v94, v94 row_ror:8 row_mask:0xf bank_mask:0xf
adaLN_cond__spectral_fnet__geglu_ffn__prompt_kernel_hop1:
    s_cbranch_execz adaLN_cond__spectral_fnet__geglu_ffn__prompt_kernel_hop5
    v_add_f32_dpp v95, v95, v95 row_ror:8 row_mask:0xf bank_mask:0xf
    ds_write_b128 v141, v[88:91]
    ds_write_b128 v141, v[92:95] offset:16
    s_waitcnt lgkmcnt(0)
    s_barrier
    s_cmp_lg_u32 s3, 0
    s_cbranch_scc1 adaLN_cond__spectral_fnet__geglu_ffn__prompt_kernel_w016
    ds_read2st64_b32 v[20:21], v142 offset0:0 offset1:1
    ds_read2st64_b32 v[22:23], v142 offset0:2 offset1:3
    ds_read2st64_b32 v[24:25], v142 offset0:4 offset1:5
    ds_read2st64_b32 v[26:27], v142 offset0:6 offset1:7
    ds_read2st64_b32 v[28:29], v142 offset0:8 offset1:9
    ds_read2st64_b32 v[30:31], v142 offset0:10 offset1:11
    ds_read2st64_b32 v[32:33], v142 offset0:12 offset1:13
    ds_read2st64_b32 v[34:35], v142 offset0:14 offset1:15
    s_waitcnt lgkmcnt(7)
    v_add_f32 v20, v20, v21
    s_waitcnt lgkmcnt(6)
    v_add_f32 v22, v22, v23
    s_waitcnt lgkmcnt(5)
    v_add_f32 v24, v24, v25
    s_waitcnt lgkmcnt(4)
    v_add_f32 v26, v26, v27
    s_waitcnt lgkmcnt(3)
    v_add_f32 v28, v28, v29
    s_waitcnt lgkmcnt(2)
    v_add_f32 v30, v30, v31
    s_waitcnt lgkmcnt(1)
    v_add_f32 v32, v32, v33
    s_waitcnt lgkmcnt(0)
    v_add_f32 v34, v34, v35
    v_add_f32 v20, v20, v22
    v_add_f32 v24, v24, v26
    v_add_f32 v28, v28, v30
    v_add_f32 v32, v32, v34
    v_add_f32 v20, v20, v24
    v_add_f32 v28, v28, v32
    v_add_f32 v20, v20, v28
    buffer_store_dword v20, v143, s[16:19], s67 offen sc1
adaLN_cond__spectral_fnet__geglu_ffn__prompt_kernel_w016:
adaLN_cond__spectral_fnet__geglu_ffn__prompt_kernel_shuf3:
adaLN_cond__spectral_fnet__geglu_ffn__prompt_kernel_join5:
    v_lshrrev_b32 v240, 2, v2
    v_lshl_add_u32 v240, v3, 3, v240
    v_mul_u32_u24 v240, 192, v240
    s_mul_i32 s52, s3, 48
    s_add_u32 s52, s52, 40960
    v_add_u32 v240, s52, v240
    v_and_b32 v241, 3, v2
    v_lshl_add_u32 v12, v241, 3, v240
    v_and_b32 v241, 1, v2
    v_lshl_add_u32 v13, v241, 3, v240
    v_bfe_u32 v241, v2, 1, 1
    v_mul_u32_u24 v241, 6144, v241
    v_add3_u32 v13, v13, v241, 32
    v_add_u32 v14, 49152, v12
    v_add_u32 v15, 49152, v13
    v_add_u32 v16, 98304, v12
    v_add_u32 v17, 98304, v13
    s_lshl_b32 s68, s12, 8
    s_add_u32 s68, s68, 16809984
    s_lshl_b32 s69, s13, 7
    s_add_u32 s52, s69, s12
    s_sub_u32 s53, s69, 1008
    s_cmp_lt_u32 s13, 8
    s_cselect_b32 s53, s69, s53
    s_cmp_eq_u32 s12, 0
    s_cselect_b32 s69, s53, s52
    s_lshl_b32 s70, s3, 5
    s_add_u32 s70, s70, s69
    s_sub_u32 s71, 2048, s70
    s_cmp_eq_u32 s70, 0
    s_cselect_b32 s71, 1024, s71
    s_mul_i32 s72, s3, 2560
    s_add_u32 s72, s72, 10240
    s_mov_b32 s20, s4
    s_and_b32 s21, s5, 0xffff
    s_mov_b32 s22, 2621440
    s_mov_b32 s23, 0x20000
    s_add_u32 s52, s69, 0
    s_sub_u32 s53, 2048, s52
    s_cmp_eq_u32 s52, 0
    s_cselect_b32 s53, 1024, s53
    s_mul_i32 s4, s52, 1280
    s_mul_i32 s5, s53, 1280
    s_add_u32 s52, s69, 32
    s_sub_u32 s53, 2048, s52
    s_mul_i32 s6, s52, 1280
    s_mul_i32 s7, s53, 1280
    s_add_u32 s52, s69, 64
    s_sub_u32 s53, 2048, s52
    s_mul_i32 s8, s52, 1280
    s_mul_i32 s9, s53, 1280
    s_add_u32 s52, s69, 96
    s_sub_u32 s53, 2048, s52
    s_mul_i32 s10, s52, 1280
    s_mul_i32 s11, s53, 1280
    s_mov_b32 s24, s46
    s_and_b32 s25, s47, 0xffff
    s_mov_b32 s26, 2621440
    s_mov_b32 s27, 0x20000
    s_mov_b32 s54, 858993460
    v_add_u32 v232, 0, v1
    v_mul_hi_u32 v233, v232, s54
    v_mul_u32_u24 v233, 1200, v233
    v_lshl_add_u32 v192, v232, 4, v233
    v_add_u32 v232, 64, v1
    v_mul_hi_u32 v233, v232, s54
    v_mul_u32_u24 v233, 1200, v233
    v_lshl_add_u32 v193, v232, 4, v233
    v_add_u32 v232, 128, v1
    v_mul_hi_u32 v233, v232, s54
    v_mul_u32_u24 v233, 1200, v233
    v_lshl_add_u32 v194, v232, 4, v233
    v_add_u32 v232, 192, v1
    v_mul_hi_u32 v233, v232, s54
    v_mul_u32_u24 v233, 1200, v233
    v_lshl_add_u32 v195, v232, 4, v233
    v_add_u32 v232, 256, v1
    v_mul_hi_u32 v233, v232, s54
    v_mul_u32_u24 v233, 1200, v233
    v_lshl_add_u32 v196, v232, 4, v233
    s_mov_b32 s54, 429496730
    v_mul_hi_u32 v233, v1, s54
    v_mul_u32_u24 v234, 10, v233
    v_sub_u32 v234, v1, v234
    v_lshrrev_b32 v235, 1, v233
    v_and_b32 v233, 1, v233
    v_mul_u32_u24 v235, 2560, v235
    v_lshl_add_u32 v235, v233, 14, v235
    v_lshl_add_u32 v197, v234, 4, v235
    v_lshrrev_b32 v253, 2, v1
    v_lshlrev_b32 v253, 13, v253
    v_and_b32 v232, 3, v1
    v_lshl_add_u32 v253, v232, 4, v253
    s_lshl_b32 s62, s2, 5
    s_add_u32 s62, s62, 17301504
    s_lshl_b32 s63, s12, 13
    s_add_u32 s63, s63, 17301504
    s_lshr_b32 s52, s12, 3
    s_lshl_b32 s52, s52, 3
    v_and_b32 v232, 7, v1
    v_lshrrev_b32 v233, 3, v1
    v_lshl_add_u32 v232, v233, 4, v232
    v_add_lshl_u32 v198, v232, s52, 5
    v_min_u32 v232, 39, v1
    v_add_u32 v232, 128, v232
    v_lshlrev_b32 v199, 5, v232
    v_add_u32 v232, 168, v1
    v_lshlrev_b32 v254, 5, v232
    s_and_b32 s52, s2, 15
    v_lshl_add_u32 v232, v2, 4, s52
    v_add_u32 v233, 232, v2
    v_cmp_gt_u32 vcc, 16, v1
    s_nop 1
    v_cndmask_b32 v232, v233, v232, vcc
    v_lshlrev_b32 v255, 5, v232
    s_cmp_eq_u32 s3, 0
    s_cbranch_scc1 adaLN_cond__spectral_fnet__geglu_ffn__prompt_kernel_wn17
    s_add_u32 s58, s57, 0
    s_add_u32 m0, s56, 0
    s_nop 0
    buffer_load_dwordx4 v4, s[28:31], s58 offen lds
    s_add_u32 m0, m0, 1024
    s_nop 0
    buffer_load_dwordx4 v5, s[28:31], s58 offen lds
    s_add_u32 m0, m0, 1024
    s_nop 0
    buffer_load_dwordx4 v6, s[32:35], s58 offen lds
    s_add_u32 m0, m0, 1024
    s_nop 0
    buffer_load_dwordx4 v7, s[32:35], s58 offen lds
    s_add_u32 s58, s57, 12288
    s_add_u32 m0, s56, 12288
    s_nop 0
    buffer_load_dwordx4 v4, s[28:31], s58 offen lds
    s_add_u32 m0, m0, 1024
    s_nop 0
    buffer_load_dwordx4 v5, s[28:31], s58 offen lds
    s_add_u32 m0, m0, 1024
    s_nop 0
    buffer_load_dwordx4 v6, s[32:35], s58 offen lds
    s_add_u32 m0, m0, 1024
    s_nop 0
    buffer_load_dwordx4 v7, s[32:35], s58 offen lds
    s_waitcnt vmcnt(8)
adaLN_cond__spectral_fnet__geglu_ffn__prompt_kernel_wn17:
    s_cmp_lg_u32 s3, 0
    s_cbranch_scc1 adaLN_cond__spectral_fnet__geglu_ffn__prompt_kernel_w018
    s_waitcnt vmcnt(0)
adaLN_cond__spectral_fnet__geglu_ffn__prompt_kernel_w018:
    s_cmp_lg_u32 s3, 0
    s_cbranch_scc1 adaLN_cond__spectral_fnet__geglu_ffn__prompt_kernel_w019
    s_cmp_lt_u32 s2, 128
    s_cbranch_scc1 adaLN_cond__spectral_fnet__geglu_ffn__prompt_kernel_ep20
    v_mov_b32 v240, s14
    v_mov_b32 v241, s59
    v_mov_b32 v242, s14
    v_mov_b32 v243, s14
    s_mov_b32 exec_lo, 0x33333333
    s_mov_b32 exec_hi, 0x33333333
    buffer_store_dwordx4 v[240:243], v253, s[16:19], s62 offen sc1
    s_mov_b64 exec, -1
adaLN_cond__spectral_fnet__geglu_ffn__prompt_kernel_ep20:
adaLN_cond__spectral_fnet__geglu_ffn__prompt_kernel_w019:
    s_barrier
    s_cmp_lg_u32 s3, 0
    s_cbranch_scc1 adaLN_cond__spectral_fnet__geglu_ffn__prompt_kernel_wn21
    s_cmp_ge_u32 s2, 128
    s_cbranch_scc1 adaLN_cond__spectral_fnet__geglu_ffn__prompt_kernel_ep23
    v_mov_b32 v240, s14
    v_mov_b32 v241, s59
    v_mov_b32 v242, s14
    v_mov_b32 v243, s14
    s_mov_b32 exec_lo, 0x33333333
    s_mov_b32 exec_hi, 0x33333333
    buffer_store_dwordx4 v[240:243], v253, s[16:19], s62 offen sc1
    s_mov_b64 exec, -1
adaLN_cond__spectral_fnet__geglu_ffn__prompt_kernel_ep23:
    ds_read_b128 v[104:107], v18 offset:20480
    ds_read_b128 v[108:111], v18 offset:21504
    ds_read_b128 v[120:123], v18 offset:22528
    ds_read_b128 v[124:127], v18 offset:23552
    ds_read_b128 v[128:131], v18 offset:24576
    ds_read_b128 v[132:135], v18 offset:25600
    ds_read_b128 v[136:139], v18 offset:26624
    ds_read_b128 v[140:143], v18 offset:27648
    ds_read_b128 v[144:147], v18 offset:28672
    ds_read_b128 v[148:151], v18 offset:29696
    ds_read_b128 v[152:155], v18 offset:30720
    ds_read_b128 v[156:159], v18 offset:31744
    ds_read_b128 v[160:163], v18 offset:32768
    ds_read_b128 v[164:167], v18 offset:33792
    ds_read_b128 v[168:171], v18 offset:34816
    ds_read_b128 v[172:175], v18 offset:35840
    ds_read_b128 v[176:179], v18 offset:36864
    s_cmp_eq_u32 s70, 0
    s_cselect_b64 vcc, -1, 0
    s_cselect_b32 s52, 0xffff, -1
    s_waitcnt lgkmcnt(15)
    v_xor_b32 v112, 0x80000000, v104
    v_lshlrev_b32 v236, 16, v104
    v_cndmask_b32 v112, v112, v236, vcc
    v_and_b32 v104, s52, v104
    v_xor_b32 v113, 0x80000000, v105
    v_lshlrev_b32 v236, 16, v105
    v_cndmask_b32 v113, v113, v236, vcc
    v_and_b32 v105, s52, v105
    v_xor_b32 v114, 0x80000000, v106
    v_lshlrev_b32 v236, 16, v106
    v_cndmask_b32 v114, v114, v236, vcc
    v_and_b32 v106, s52, v106
    v_xor_b32 v115, 0x80000000, v107
    v_lshlrev_b32 v236, 16, v107
    v_cndmask_b32 v115, v115, v236, vcc
    v_and_b32 v107, s52, v107
    v_xor_b32 v116, 0x80000000, v108
    v_lshlrev_b32 v236, 16, v108
    v_cndmask_b32 v116, v116, v236, vcc
    v_and_b32 v108, s52, v108
    v_xor_b32 v117, 0x80000000, v109
    v_lshlrev_b32 v236, 16, v109
    v_cndmask_b32 v117, v117, v236, vcc
    v_and_b32 v109, s52, v109
    v_xor_b32 v118, 0x80000000, v110
    v_lshlrev_b32 v236, 16, v110
    v_cndmask_b32 v118, v118, v236, vcc
    v_and_b32 v110, s52, v110
    v_xor_b32 v119, 0x80000000, v111
    v_lshlrev_b32 v236, 16, v111
    v_cndmask_b32 v119, v119, v236, vcc
    v_and_b32 v111, s52, v111
    s_mov_b64 s[80:81], s[68:69]
    s_mov_b64 s[82:83], s[70:71]
    s_cmp_ge_u32 s3, 2
    s_cselect_b32 s52, -1008, 0
    s_cmp_eq_u32 s12, 0
    s_cselect_b32 s52, s52, s12
    s_lshl_b32 s53, s3, 9
    s_add_u32 s73, s52, s53
    s_cmp_eq_u32 s12, 0
    s_cselect_b32 s54, 1, 0
    s_lshr_b32 s55, s3, 1
    s_and_b32 s52, s54, s55
    s_andn2_b32 s53, s54, s55
    v_and_b32 v233, 1, v2
    v_cvt_f32_u32 v233, v233
    v_mul_f32 v233, 0x3e800000, v233
    s_cmp_eq_u32 s12, 0
    s_cselect_b32 s54, 0, 0xbe800000
    v_add_f32 v235, s54, v233
    v_mov_b32 v238, 0x3e800000
    v_lshlrev_b32 v236, 2, v3
    v_cvt_f32_u32 v236, v236
    s_cmp_lg_u32 s52, 0
    s_cselect_b64 s[68:69], -1, 0
    s_cmp_lg_u32 s53, 0
    s_cselect_b64 s[70:71], -1, 0
    v_cndmask_b32 v233, v233, v238, s[68:69]
    v_cndmask_b32 v235, v235, v238, s[70:71]
    v_lshrrev_b32 v232, 1, v2
    v_lshl_add_u32 v232, v232, 5, s73
    v_add_u32 v232, 256, v232
    v_cvt_f32_u32 v232, v232
    v_mul_f32 v232, 0x3a000000, v232
    v_cndmask_b32 v234, v232, 0, s[70:71]
    v_cndmask_b32 v232, v232, 0, s[68:69]
    v_mov_b32 v237, v233
    v_fma_f32 v237, v232, v236, v237
    v_fma_f32 v239, v234, v236, v235
    v_fmamk_f32 v240, v232, 0.0, v237
    v_fmamk_f32 v241, v234, 0.0, v239
    v_fmamk_f32 v242, v232, 1.0, v237
    v_fmamk_f32 v243, v234, 1.0, v239
    v_fmamk_f32 v244, v232, 2.0, v237
    v_fmamk_f32 v245, v234, 2.0, v239
    v_fmamk_f32 v246, v232, 3.0, v237
    v_fmamk_f32 v247, v234, 3.0, v239
    v_cos_f32 v240, v240
    v_cos_f32 v241, v241
    v_cos_f32 v242, v242
    v_cos_f32 v243, v243
    v_cos_f32 v244, v244
    v_cos_f32 v245, v245
    v_cos_f32 v246, v246
    v_cos_f32 v247, v247
    v_cvt_pk_bf16_f32 v216, v240, v241
    v_cvt_pk_bf16_f32 v217, v242, v243
    v_cvt_pk_bf16_f32 v218, v244, v245
    v_cvt_pk_bf16_f32 v219, v246, v247
    v_fmamk_f32 v240, v232, 16.0, v237
    v_fmamk_f32 v241, v234, 16.0, v239
    v_fmamk_f32 v242, v232, 17.0, v237
    v_fmamk_f32 v243, v234, 17.0, v239
    v_fmamk_f32 v244, v232, 18.0, v237
    v_fmamk_f32 v245, v234, 18.0, v239
    v_fmamk_f32 v246, v232, 19.0, v237
    v_fmamk_f32 v247, v234, 19.0, v239
    v_cos_f32 v240, v240
    v_cos_f32 v241, v241
    v_cos_f32 v242, v242
    v_cos_f32 v243, v243
    v_cos_f32 v244, v244
    v_cos_f32 v245, v245
    v_cos_f32 v246, v246
    v_cos_f32 v247, v247
    v_cvt_pk_bf16_f32 v220, v240, v241
    v_cvt_pk_bf16_f32 v221, v242, v243
    v_cvt_pk_bf16_f32 v222, v244, v245
    v_cvt_pk_bf16_f32 v223, v246, v247
    v_fmamk_f32 v240, v232, 32.0, v237
    v_fmamk_f32 v241, v234, 32.0, v239
    v_fmamk_f32 v242, v232, 33.0, v237
    v_fmamk_f32 v243, v234, 33.0, v239
    v_fmamk_f32 v244, v232, 34.0, v237
    v_fmamk_f32 v245, v234, 34.0, v239
    v_fmamk_f32 v246, v232, 35.0, v237
    v_fmamk_f32 v247, v234, 35.0, v239
    v_cos_f32 v240, v240
    v_cos_f32 v241, v241
    v_cos_f32 v242, v242
    v_cos_f32 v243, v243
    v_cos_f32 v244, v244
    v_cos_f32 v245, v245
    v_cos_f32 v246, v246
    v_cos_f32 v247, v247
    v_cvt_pk_bf16_f32 v224, v240, v241
    v_cvt_pk_bf16_f32 v225, v242, v243
    v_cvt_pk_bf16_f32 v226, v244, v245
    v_cvt_pk_bf16_f32 v227, v246, v247
    v_fmamk_f32 v240, v232, 48.0, v237
    v_fmamk_f32 v241, v234, 48.0, v239
    v_fmamk_f32 v242, v232, 49.0, v237
    v_fmamk_f32 v243, v234, 49.0, v239
    v_fmamk_f32 v244, v232, 50.0, v237
    v_fmamk_f32 v245, v234, 50.0, v239
    v_fmamk_f32 v246, v232, 51.0, v237
    v_fmamk_f32 v247, v234, 51.0, v239
    v_cos_f32 v240, v240
    v_cos_f32 v241, v241
    v_cos_f32 v242, v242
    v_cos_f32 v243, v243
    v_cos_f32 v244, v244
    v_cos_f32 v245, v245
    v_cos_f32 v246, v246
    v_cos_f32 v247, v247
    v_cvt_pk_bf16_f32 v228, v240, v241
    v_cvt_pk_bf16_f32 v229, v242, v243
    v_cvt_pk_bf16_f32 v230, v244, v245
    v_cvt_pk_bf16_f32 v231, v246, v247
    s_mov_b64 s[68:69], s[80:81]
    s_mov_b64 s[70:71], s[82:83]
    s_cmp_lt_u32 s2, 128
    s_cbranch_scc1 adaLN_cond__spectral_fnet__geglu_ffn__prompt_kernel_sl28
adaLN_cond__spectral_fnet__geglu_ffn__prompt_kernel_sl28:
    s_waitcnt lgkmcnt(0)
    s_barrier
    s_mov_b32 s52, 0
adaLN_cond__spectral_fnet__geglu_ffn__prompt_kernel_p30:
    buffer_load_dword v240, v198, s[16:19], s63 offen sc1
    buffer_load_dword v241, v199, s[16:19], s63 offen sc1
    s_waitcnt vmcnt(0)
    s_add_u32 s52, s52, 1
    s_cmp_gt_u32 s52, 0x400000
    s_cbranch_scc1 adaLN_cond__spectral_fnet__geglu_ffn__prompt_kernel_x31
    v_xor_b32 v240, s14, v240
    v_xor_b32 v241, s14, v241
    v_or_b32 v240, v240, v241
    v_cmp_ne_u32 vcc, 0, v240
    s_nop 0
    s_cbranch_vccnz adaLN_cond__spectral_fnet__geglu_ffn__prompt_kernel_p30
adaLN_cond__spectral_fnet__geglu_ffn__prompt_kernel_x31:
adaLN_cond__spectral_fnet__geglu_ffn__prompt_kernel_ok29:
    s_mul_i32 s53, s12, 163840
    s_mul_i32 s52, s13, 80
    s_add_u32 s53, s53, s52
    s_mov_b32 m0, 0
    s_nop 0
    buffer_load_dwordx4 v192, s[16:19], s53 offen sc1 lds
    s_add_u32 m0, m0, 1024
    s_nop 0
    buffer_load_dwordx4 v193, s[16:19], s53 offen sc1 lds
    s_add_u32 m0, m0, 1024
    s_nop 0
    buffer_load_dwordx4 v194, s[16:19], s53 offen sc1 lds
    s_add_u32 m0, m0, 1024
    s_nop 0
    buffer_load_dwordx4 v195, s[16:19], s53 offen sc1 lds
    s_add_u32 m0, m0, 1024
    s_nop 0
    buffer_load_dwordx4 v196, s[16:19], s53 offen sc1 lds
    s_add_u32 m0, m0, 1024
    s_add_u32 s53, s53, 81920
    buffer_load_dwordx4 v192, s[16:19], s53 offen sc1 lds
    s_add_u32 m0, m0, 1024
    s_nop 0
    buffer_load_dwordx4 v193, s[16:19], s53 offen sc1 lds
    s_add_u32 m0, m0, 1024
    s_nop 0
    buffer_load_dwordx4 v194, s[16:19], s53 offen sc1 lds
    s_add_u32 m0, m0, 1024
    s_nop 0
    buffer_load_dwordx4 v195, s[16:19], s53 offen sc1 lds
    s_add_u32 m0, m0, 1024
    s_nop 0
    buffer_load_dwordx4 v196, s[16:19], s53 offen sc1 lds
    s_add_u32 m0, m0, 1024
    s_mov_b32 m0, 37888
    s_mul_i32 s53, s13, 160
    s_add_u32 s53, s53, 6291456
    s_mov_b32 exec_hi, 0xff
    buffer_load_dwordx4 v197, s[16:19], s53 offen sc1 lds
    s_mov_b32 exec_hi, -1
    s_barrier
    v_lshlrev_b32 v246, 2, v2
    v_mov_b32 v180, 0
    v_mov_b32 v181, 0
    v_mov_b32 v182, 0
    v_mov_b32 v183, 0
    v_mov_b32 v184, 0
    v_mov_b32 v185, 0
    v_mov_b32 v186, 0
    v_mov_b32 v187, 0
    v_mov_b32 v188, 0
    v_mov_b32 v189, 0
    v_mov_b32 v190, 0
    v_mov_b32 v191, 0
    v_mov_b32 v192, 0
    v_mov_b32 v193, 0
    v_mov_b32 v194, 0
    v_mov_b32 v195, 0
    v_mov_b32 v196, 0
    v_mov_b32 v197, 0
    v_mov_b32 v198, 0
    v_mov_b32 v199, 0
    v_lshlrev_b32 v236, 1, v2
    v_lshl_add_u32 v250, v3, 8, v236
    v_lshl_add_u32 v251, v3, 6, v236
    v_add_u32 v250, s72, v250
    v_add_u32 v251, s72, v251
    ds_read_u16_d16_hi v180, v250 offset:0
    ds_read_u16_d16_hi v181, v250 offset:32
    ds_read_u16_d16_hi v182, v250 offset:64
    ds_read_u16_d16_hi v183, v250 offset:96
    ds_read_u16_d16_hi v184, v250 offset:128
    ds_read_u16_d16_hi v185, v250 offset:160
    ds_read_u16_d16_hi v186, v250 offset:192
    ds_read_u16_d16_hi v187, v250 offset:224
    ds_read_u16_d16_hi v188, v251 offset:1024
    ds_read_u16_d16_hi v189, v251 offset:1056
    ds_read_u16_d16_hi v190, v250 offset:1280
    ds_read_u16_d16_hi v191, v250 offset:1312
    ds_read_u16_d16_hi v192, v250 offset:1344
    ds_read_u16_d16_hi v193, v250 offset:1376
    ds_read_u16_d16_hi v194, v250 offset:1408
    ds_read_u16_d16_hi v195, v250 offset:1440
    ds_read_u16_d16_hi v196, v250 offset:1472
    ds_read_u16_d16_hi v197, v250 offset:1504
    ds_read_u16_d16_hi v198, v251 offset:2304
    ds_read_u16_d16_hi v199, v251 offset:2336
    ds_read_b64_tr_b16 a[0:1], v12 offset:0
    ds_read_b64_tr_b16 a[2:3], v12 offset:768
    ds_read_b64_tr_b16 a[4:5], v12 offset:6144
    ds_read_b64_tr_b16 a[6:7], v12 offset:6912
    ds_read_b64_tr_b16 a[8:9], v13 offset:0
    ds_read_b64_tr_b16 a[10:11], v13 offset:768
    ds_read_b64_tr_b16 a[12:13], v12 offset:12288
    ds_read_b64_tr_b16 a[14:15], v12 offset:13056
    ds_read_b64_tr_b16 a[16:17], v12 offset:18432
    ds_read_b64_tr_b16 a[18:19], v12 offset:19200
    ds_read_b64_tr_b16 a[20:21], v13 offset:12288
    ds_read_b64_tr_b16 a[22:23], v13 offset:13056
    v_lshrrev_b32 v236, 2, v2
    v_lshl_add_u32 v236, v3, 3, v236
    v_mul_u32_u24 v236, 80, v236
    v_and_b32 v237, 3, v2
    v_lshl_add_u32 v248, v237, 3, v236
    s_mul_i32 s52, s3, 2560
    v_mul_u32_u24 v249, 320, v3
    v_lshl_add_u32 v249, v2, 2, v249
    v_add_u32 v249, s52, v249
    v_add_u32 v246, 37888, v246
    s_lshl_b32 s62, s12, 4
    s_add_u32 s62, s62, s13
    s_mul_i32 s62, s62, 10240
    s_add_u32 s62, s62, 3145728
    s_mov_b32 s54, 107374183
    s_bfe_u32 s55, s13, 0x10001
    s_mul_i32 s55, s55, 7
    v_add_u32 v232, 0, v1
    v_mul_hi_u32 v233, v232, s54
    v_mul_u32_u24 v234, 40, v233
    v_sub_u32 v232, v232, v234
    v_xor_b32 v233, s55, v233
    v_mul_u32_u24 v233, 10240, v233
    v_add_lshl_u32 v240, v232, v233, 4
    v_add_u32 v232, 64, v1
    v_mul_hi_u32 v233, v232, s54
    v_mul_u32_u24 v234, 40, v233
    v_sub_u32 v232, v232, v234
    v_xor_b32 v233, s55, v233
    v_mul_u32_u24 v233, 10240, v233
    v_add_lshl_u32 v241, v232, v233, 4
    v_add_u32 v232, 128, v1
    v_mul_hi_u32 v233, v232, s54
    v_mul_u32_u24 v234, 40, v233
    v_sub_u32 v232, v232, v234
    v_xor_b32 v233, s55, v233
    v_mul_u32_u24 v233, 10240, v233
    v_add_lshl_u32 v242, v232, v233, 4
    v_add_u32 v232, 192, v1
    v_mul_hi_u32 v233, v232, s54
    v_mul_u32_u24 v234, 40, v233
    v_sub_u32 v232, v232, v234
    v_xor_b32 v233, s55, v233
    v_mul_u32_u24 v233, 10240, v233
    v_add_lshl_u32 v243, v232, v233, 4
    v_add_u32 v232, 256, v1
    v_mul_hi_u32 v233, v232, s54
    v_mul_u32_u24 v234, 40, v233
    v_sub_u32 v232, v232, v234
    v_xor_b32 v233, s55, v233
    v_mul_u32_u24 v233, 10240, v233
    v_add_lshl_u32 v244, v232, v233, 4
    s_lshr_b32 s52, s13, 2
    s_lshl_b32 s52, s52, 5
    s_add_u32 s64, s52, s12
    s_add_u32 s65, s64, 1024
    s_add_u32 s52, s52, 16
    s_cmp_eq_u32 s12, 0
    s_cselect_b32 s65, s52, s65
    s_sub_u32 s52, 1152, s64
    s_sub_u32 s53, 1152, s65
    s_cmp_lg_u32 s55, 0
    s_cselect_b32 s53, s53, s65
    s_cselect_b32 s65, 163840, 0
    s_cselect_b32 s52, s52, s64
    s_cselect_b32 s55, s64, 1
    s_cmp_eq_u32 s55, 0
    s_cselect_b32 s55, 40, 0
    v_add_u32 v239, s65, v240
    v_lshlrev_b32 v232, 4, v1
    v_cmp_gt_u32 vcc, s55, v1
    s_nop 1
    v_cndmask_b32 v239, v239, v232, vcc
    s_and_b32 s55, s13, 1
    s_mul_i32 s55, s55, 640
    s_mul_i32 s64, s52, 1280
    s_add_u32 s64, s64, s55
    s_sub_u32 s63, s64, s65
    s_mul_i32 s65, s53, 1280
    s_add_u32 s65, s65, s55
    v_lshlrev_b32 v245, 2, v1
    s_waitcnt vmcnt(0)
    s_waitcnt lgkmcnt(0)
    s_barrier
    ds_read_b64_tr_b16 v[20:21], v248 offset:0
    ds_read_b64_tr_b16 v[22:23], v248 offset:320
    ds_read_b64_tr_b16 v[24:25], v248 offset:32
    ds_read_b64_tr_b16 v[26:27], v248 offset:352
    ds_read_b64_tr_b16 v[28:29], v248 offset:48
    ds_read_b64_tr_b16 v[30:31], v248 offset:368
    ds_read_b64_tr_b16 v[32:33], v248 offset:2560
    ds_read_b64_tr_b16 v[34:35], v248 offset:2880
    ds_read_b64_tr_b16 v[36:37], v248 offset:2592
    ds_read_b64_tr_b16 v[38:39], v248 offset:2912
    ds_read_b64_tr_b16 v[40:41], v248 offset:2608
    ds_read_b64_tr_b16 v[42:43], v248 offset:2928
    s_cmp_eq_u32 s73, 0
    s_cselect_b32 s52, 16, 0
    v_cmp_gt_u32 s[54:55], s52, v1
    v_mov_b32 v238, 0x45000000
    s_waitcnt lgkmcnt(10)
    v_mfma_f32_16x16x32_bf16 v[68:71], v[200:203], v[20:23], 0
    ds_read_b64_tr_b16 v[44:45], v248 offset:5120
    ds_read_b64_tr_b16 v[46:47], v248 offset:5440
    v_mfma_f32_16x16x32_bf16 v[80:83], v[216:219], v[20:23], 0
    ds_read_b64_tr_b16 v[48:49], v248 offset:5152
    ds_read_b64_tr_b16 v[50:51], v248 offset:5472
    s_waitcnt lgkmcnt(12)
    v_mfma_f32_16x16x32_bf16 v[72:75], v[200:203], v[24:27], 0
    ds_read_b64_tr_b16 v[52:53], v248 offset:5168
    ds_read_b64_tr_b16 v[54:55], v248 offset:5488
    v_mfma_f32_16x16x32_bf16 v[84:87], v[216:219], v[24:27], 0
    ds_read2_b32 v[92:93], v246 offset0:0 offset1:40
    ds_read2_b32 v[98:99], v246 offset0:80 offset1:120
    s_waitcnt lgkmcnt(14)
    v_mfma_f32_16x16x32_bf16 v[76:79], v[200:203], v[28:31], 0
    ds_read2_b32 v[94:95], v246 offset0:16 offset1:56
    ds_read2_b32 v[100:101], v246 offset0:96 offset1:136
    v_mfma_f32_16x16x32_bf16 v[88:91], v[216:219], v[28:31], 0
    ds_read2_b32 v[96:97], v246 offset0:24 offset1:64
    ds_read2_b32 v[102:103], v246 offset0:104 offset1:144
    s_waitcnt lgkmcnt(15)
    v_mfma_f32_16x16x32_bf16 v[68:71], v[204:207], v[32:35], v[68:71]
    ds_read_b64_tr_b16 v[56:57], v248 offset:7680
    ds_read_b64_tr_b16 v[58:59], v248 offset:8000
    v_mfma_f32_16x16x32_bf16 v[80:83], v[220:223], v[32:35], v[80:83]
    ds_read_b64_tr_b16 v[60:61], v248 offset:7712
    ds_read_b64_tr_b16 v[62:63], v248 offset:8032
    s_waitcnt lgkmcnt(15)
    v_mfma_f32_16x16x32_bf16 v[72:75], v[204:207], v[36:39], v[72:75]
    ds_read_b64_tr_b16 v[64:65], v248 offset:7728
    ds_read_b64_tr_b16 v[66:67], v248 offset:8048
    v_mfma_f32_16x16x32_bf16 v[84:87], v[220:223], v[36:39], v[84:87]
    s_waitcnt lgkmcnt(11)
    v_add_f32 v92, v92, v93
    s_waitcnt lgkmcnt(10)
    v_add_f32 v98, v98, v99
    v_mfma_f32_16x16x32_bf16 v[76:79], v[204:207], v[40:43], v[76:79]
    s_waitcnt lgkmcnt(9)
    v_add_f32 v94, v94, v95
    s_waitcnt lgkmcnt(8)
    v_add_f32 v100, v100, v101
    v_mfma_f32_16x16x32_bf16 v[88:91], v[220:223], v[40:43], v[88:91]
    s_waitcnt lgkmcnt(7)
    v_add_f32 v96, v96, v97
    s_waitcnt lgkmcnt(6)
    v_add_f32 v102, v102, v103
    v_mfma_f32_16x16x32_bf16 v[68:71], v[208:211], v[44:47], v[68:71]
    v_cvt_pk_bf16_f32 v92, v92, v98
    v_cvt_pk_bf16_f32 v94, v94, v100
    v_mfma_f32_16x16x32_bf16 v[80:83], v[224:227], v[44:47], v[80:83]
    v_cvt_pk_bf16_f32 v96, v96, v102
    v_and_b32 v98, 0xffff0000, v92
    v_mfma_f32_16x16x32_bf16 v[72:75], v[208:211], v[48:51], v[72:75]
    v_and_b32 v100, 0xffff0000, v94
    v_and_b32 v102, 0xffff0000, v96
    v_mfma_f32_16x16x32_bf16 v[84:87], v[224:227], v[48:51], v[84:87]
    v_add_f32 v98, 1.0, v98
    v_add_f32 v100, 1.0, v100
    v_mfma_f32_16x16x32_bf16 v[76:79], v[208:211], v[52:55], v[76:79]
    v_add_f32 v102, 1.0, v102
    v_cvt_pk_bf16_f32 v98, v98, v98
    v_mfma_f32_16x16x32_bf16 v[88:91], v[224:227], v[52:55], v[88:91]
    v_cvt_pk_bf16_f32 v100, v100, v100
    v_cvt_pk_bf16_f32 v102, v102, v102
    s_waitcnt lgkmcnt(4)
    v_mfma_f32_16x16x32_bf16 v[68:71], v[212:215], v[56:59], v[68:71]
adaLN_cond__spectral_fnet__geglu_ffn__prompt_kernel_hop2:
    s_cbranch_execz adaLN_cond__spectral_fnet__geglu_ffn__prompt_kernel_hop6
    v_and_b32 v98, 0xffff0000, v98
    v_and_b32 v100, 0xffff0000, v100
    v_mfma_f32_16x16x32_bf16 v[80:83], v[228:231], v[56:59], v[80:83]
    v_and_b32 v102, 0xffff0000, v102
    s_waitcnt lgkmcnt(2)
    v_mfma_f32_16x16x32_bf16 v[72:75], v[212:215], v[60:63], v[72:75]
    v_mfma_f32_16x16x32_bf16 v[84:87], v[228:231], v[60:63], v[84:87]
    s_waitcnt lgkmcnt(0)
    v_mfma_f32_16x16x32_bf16 v[76:79], v[212:215], v[64:67], v[76:79]
    v_mfma_f32_16x16x32_bf16 v[88:91], v[228:231], v[64:67], v[88:91]
    v_lshlrev_b32 v92, 16, v92
    v_cndmask_b32 v92, 0, v92, s[54:55]
    v_lshlrev_b32 v94, 16, v94
    v_cndmask_b32 v94, 0, v94, s[54:55]
    v_lshlrev_b32 v96, 16, v96
    v_cndmask_b32 v96, 0, v96, s[54:55]
    v_pk_mul_f32 v[68:69], v[68:69], v[98:99] op_sel_hi:[1,0]
    v_pk_mul_f32 v[70:71], v[70:71], v[98:99] op_sel_hi:[1,0]
    v_fmac_f32 v68, v238, v92
    v_cvt_pk_bf16_f32 v68, v68, v69
    ds_write_b32 v249, v68 offset:10240
    v_cvt_pk_bf16_f32 v70, v70, v71
    ds_write_b32 v249, v70 offset:10400
    v_pk_mul_f32 v[80:81], v[80:81], v[98:99] op_sel_hi:[1,0]
    v_pk_mul_f32 v[82:83], v[82:83], v[98:99] op_sel_hi:[1,0]
    v_cvt_pk_bf16_f32 v80, v80, v81
    ds_write_b32 v249, v80 offset:11520
    v_cvt_pk_bf16_f32 v82, v82, v83
    ds_write_b32 v249, v82 offset:11680
    v_pk_mul_f32 v[72:73], v[72:73], v[100:101] op_sel_hi:[1,0]
    v_pk_mul_f32 v[74:75], v[74:75], v[100:101] op_sel_hi:[1,0]
    v_fmac_f32 v72, v238, v94
    v_cvt_pk_bf16_f32 v72, v72, v73
    ds_write_b32 v249, v72 offset:10304
    v_cvt_pk_bf16_f32 v74, v74, v75
    ds_write_b32 v249, v74 offset:10464
    v_pk_mul_f32 v[84:85], v[84:85], v[100:101] op_sel_hi:[1,0]
    v_pk_mul_f32 v[86:87], v[86:87], v[100:101] op_sel_hi:[1,0]
    v_cvt_pk_bf16_f32 v84, v84, v85
    ds_write_b32 v249, v84 offset:11584
    v_cvt_pk_bf16_f32 v86, v86, v87
    ds_write_b32 v249, v86 offset:11744
    v_pk_mul_f32 v[76:77], v[76:77], v[102:103] op_sel_hi:[1,0]
    v_pk_mul_f32 v[78:79], v[78:79], v[102:103] op_sel_hi:[1,0]
    v_fmac_f32 v76, v238, v96
    v_cvt_pk_bf16_f32 v76, v76, v77
    ds_write_b32 v249, v76 offset:10336
    v_cvt_pk_bf16_f32 v78, v78, v79
    ds_write_b32 v249, v78 offset:10496
    v_pk_mul_f32 v[88:89], v[88:89], v[102:103] op_sel_hi:[1,0]
    v_pk_mul_f32 v[90:91], v[90:91], v[102:103] op_sel_hi:[1,0]
    v_cvt_pk_bf16_f32 v88, v88, v89
    ds_write_b32 v249, v88 offset:11616
    v_cvt_pk_bf16_f32 v90, v90, v91
    ds_write_b32 v249, v90 offset:11776
    ds_read_b64_tr_b16 a[24:25], v12 offset:24576
    ds_read_b64_tr_b16 a[26:27], v12 offset:25344
    ds_read_b64_tr_b16 a[28:29], v12 offset:30720
    ds_read_b64_tr_b16 a[30:31], v12 offset:31488
    ds_read_b64_tr_b16 a[32:33], v13 offset:24576
    ds_read_b64_tr_b16 a[34:35], v13 offset:25344
    ds_read_b64_tr_b16 a[36:37], v12 offset:36864
    ds_read_b64_tr_b16 a[38:39], v12 offset:37632
    ds_read_b64_tr_b16 a[40:41], v12 offset:43008
    ds_read_b64_tr_b16 a[42:43], v12 offset:43776
    ds_read_b64_tr_b16 a[44:45], v13 offset:36864
    ds_read_b64_tr_b16 a[46:47], v13 offset:37632
    ds_read_b64_tr_b16 a[48:49], v14 offset:0
    ds_read_b64_tr_b16 a[50:51], v14 offset:768
    ds_read_b64_tr_b16 a[52:53], v14 offset:6144
    ds_read_b64_tr_b16 a[54:55], v14 offset:6912
    ds_read_b64_tr_b16 a[56:57], v15 offset:0
    ds_read_b64_tr_b16 a[58:59], v15 offset:768
    ds_read_b64_tr_b16 a[60:61], v14 offset:12288
    ds_read_b64_tr_b16 a[62:63], v14 offset:13056
    ds_read_b64_tr_b16 a[64:65], v14 offset:18432
    ds_read_b64_tr_b16 a[66:67], v14 offset:19200
    ds_read_b64_tr_b16 a[68:69], v15 offset:12288
    ds_read_b64_tr_b16 a[70:71], v15 offset:13056
    s_waitcnt lgkmcnt(15)
    s_barrier
    v_mov_b32 v233, 38528
    ds_read_b32 v247, v233
    ds_read_b128 v[20:23], v18 offset:10240
    ds_read_b32 v52, v245 offset:11264
    ds_read_b128 v[24:27], v18 offset:11520
    ds_read_b32 v53, v245 offset:12544
    ds_read_b128 v[28:31], v18 offset:12800
    ds_read_b32 v54, v245 offset:13824
    ds_read_b128 v[32:35], v18 offset:14080
    ds_read_b32 v55, v245 offset:15104
    ds_read_b128 v[36:39], v18 offset:15360
    ds_read_b32 v56, v245 offset:16384
    ds_read_b128 v[40:43], v18 offset:16640
    ds_read_b32 v57, v245 offset:17664
    ds_read_b128 v[44:47], v18 offset:17920
    ds_read_b32 v58, v245 offset:18944
    ds_read_b128 v[48:51], v18 offset:19200
    ds_read_b32 v59, v245 offset:20224
    s_waitcnt lgkmcnt(15)
    buffer_store_dwordx4 v[20:23], v18, s[24:27], s4 offen
    s_waitcnt lgkmcnt(14)
    buffer_store_dword v52, v245, s[24:27], s4 offen offset:1024
    s_waitcnt lgkmcnt(13)
    buffer_store_dwordx4 v[24:27], v18, s[24:27], s5 offen
    s_waitcnt lgkmcnt(12)
    buffer_store_dword v53, v245, s[24:27], s5 offen offset:1024
    s_waitcnt lgkmcnt(11)
    buffer_store_dwordx4 v[28:31], v18, s[24:27], s6 offen
    s_waitcnt lgkmcnt(10)
    buffer_store_dword v54, v245, s[24:27], s6 offen offset:1024
    s_waitcnt lgkmcnt(9)
    buffer_store_dwordx4 v[32:35], v18, s[24:27], s7 offen
    s_waitcnt lgkmcnt(8)
    buffer_store_dword v55, v245, s[24:27], s7 offen offset:1024
    s_waitcnt lgkmcnt(7)
    buffer_store_dwordx4 v[36:39], v18, s[24:27], s8 offen
    s_waitcnt lgkmcnt(6)
    buffer_store_dword v56, v245, s[24:27], s8 offen offset:1024
    s_waitcnt lgkmcnt(5)
    buffer_store_dwordx4 v[40:43], v18, s[24:27], s9 offen
    s_waitcnt lgkmcnt(4)
    buffer_store_dword v57, v245, s[24:27], s9 offen offset:1024
    s_waitcnt lgkmcnt(3)
    buffer_store_dwordx4 v[44:47], v18, s[24:27], s10 offen
    s_waitcnt lgkmcnt(2)
    buffer_store_dword v58, v245, s[24:27], s10 offen offset:1024
    s_waitcnt lgkmcnt(1)
    buffer_store_dwordx4 v[48:51], v18, s[24:27], s11 offen
    s_waitcnt lgkmcnt(0)
    buffer_store_dword v59, v245, s[24:27], s11 offen offset:1024
    v_readfirstlane_b32 s15, v247
    s_cmp_lt_u32 s3, 2
    s_cselect_b32 s28, s36, s38
    s_cselect_b32 s29, s37, s39
    s_and_b32 s29, s29, 0xffff
    s_mov_b32 s53, 357913942
    s_and_b32 s52, s3, 1
    s_mul_i32 s52, s52, 192
    s_mul_i32 s56, s3, 3072
    s_add_u32 s56, s56, 40960
    v_add_u32 v232, s52, v1
    v_mul_hi_u32 v233, v232, s53
    v_mul_u32_u24 v234, 12, v233
    v_sub_u32 v234, v232, v234
    v_lshrrev_b32 v235, 3, v233
    v_bfe_u32 v236, v233, 1, 2
    v_lshl_add_u32 v235, v235, 2, v236
    v_and_b32 v236, 1, v233
    v_lshl_add_u32 v235, v236, 4, v235
    v_mul_u32_u24 v235, 3072, v235
    v_lshl_add_u32 v4, v234, 4, v235
    v_add_u32 v232, s52, v1
    v_add_u32 v232, 64, v232
    v_mul_hi_u32 v233, v232, s53
    v_mul_u32_u24 v234, 12, v233
    v_sub_u32 v234, v232, v234
    v_lshrrev_b32 v235, 3, v233
    v_bfe_u32 v236, v233, 1, 2
    v_lshl_add_u32 v235, v235, 2, v236
    v_and_b32 v236, 1, v233
    v_lshl_add_u32 v235, v236, 4, v235
    v_mul_u32_u24 v235, 3072, v235
    v_lshl_add_u32 v5, v234, 4, v235
    v_add_u32 v232, s52, v1
    v_add_u32 v232, 128, v232
    v_mul_hi_u32 v233, v232, s53
    v_mul_u32_u24 v234, 12, v233
    v_sub_u32 v234, v232, v234
    v_lshrrev_b32 v235, 3, v233
    v_bfe_u32 v236, v233, 1, 2
    v_lshl_add_u32 v235, v235, 2, v236
    v_and_b32 v236, 1, v233
    v_lshl_add_u32 v235, v236, 4, v235
    v_mul_u32_u24 v235, 3072, v235
    v_lshl_add_u32 v6, v234, 4, v235
    s_waitcnt vmcnt(0)
    s_add_u32 s53, s68, 0
    s_lshl_b32 s52, s13, 2
    s_add_u32 s52, s52, s53
    v_mov_b32 v252, s14
    v_mov_b32 v253, 0
    s_mov_b64 exec, 1
    s_cmp_eq_u32 s15, 0
    s_cbranch_scc1 adaLN_cond__spectral_fnet__geglu_ffn__prompt_kernel_s39
    buffer_store_dword v252, v253, s[16:19], s52 offen
    s_branch adaLN_cond__spectral_fnet__geglu_ffn__prompt_kernel_e40
adaLN_cond__spectral_fnet__geglu_ffn__prompt_kernel_s39:
    buffer_wbl2 sc1
    s_waitcnt vmcnt(0)
    buffer_store_dword v252, v253, s[16:19], s52 offen sc1
adaLN_cond__spectral_fnet__geglu_ffn__prompt_kernel_e40:
    s_mov_b64 exec, -1
    s_add_u32 s87, s68, 0
    v_lshlrev_b32 v253, 2, v2
    buffer_load_dword v247, v253, s[16:19], s87 offen sc1
    v_lshlrev_b32 v234, 2, v2
    v_lshl_add_u32 v235, v3, 7, v234
    v_lshl_add_u32 v234, v3, 9, v234
    v_add_u32 v236, 20480, v234
    v_add_u32 v237, 22528, v235
    ds_read2_b32 v[60:61], v236 offset0:0 offset1:16
    ds_read2_b32 v[62:63], v236 offset0:32 offset1:48
    ds_read2_b32 v[64:65], v236 offset0:64 offset1:80
    ds_read2_b32 v[66:67], v236 offset0:96 offset1:112
    ds_read2_b32 v[68:69], v237 offset0:0 offset1:16
    v_add_u32 v236, 23040, v234
    v_add_u32 v237, 25088, v235
    ds_read2_b32 v[70:71], v236 offset0:0 offset1:16
    ds_read2_b32 v[72:73], v236 offset0:32 offset1:48
    ds_read2_b32 v[74:75], v236 offset0:64 offset1:80
    ds_read2_b32 v[76:77], v236 offset0:96 offset1:112
    ds_read2_b32 v[78:79], v237 offset0:0 offset1:16
    v_add_u32 v236, 25600, v234
    v_add_u32 v237, 27648, v235
    ds_read2_b32 v[80:81], v236 offset0:0 offset1:16
    ds_read2_b32 v[82:83], v236 offset0:32 offset1:48
    ds_read2_b32 v[84:85], v236 offset0:64 offset1:80
    ds_read2_b32 v[86:87], v236 offset0:96 offset1:112
    ds_read2_b32 v[88:89], v237 offset0:0 offset1:16
    v_add_u32 v236, 28672, v234
    v_add_u32 v237, 30720, v235
    ds_read2_b32 v[200:201], v236 offset0:0 offset1:16
    ds_read2_b32 v[202:203], v236 offset0:32 offset1:48
    ds_read2_b32 v[204:205], v236 offset0:64 offset1:80
    ds_read2_b32 v[206:207], v236 offset0:96 offset1:112
    ds_read2_b32 v[208:209], v237 offset0:0 offset1:16
    v_add_u32 v236, 31232, v234
    v_add_u32 v237, 33280, v235
    ds_read2_b32 v[210:211], v236 offset0:0 offset1:16
    ds_read2_b32 v[212:213], v236 offset0:32 offset1:48
    ds_read2_b32 v[214:215], v236 offset0:64 offset1:80
    ds_read2_b32 v[216:217], v236 offset0:96 offset1:112
    ds_read2_b32 v[218:219], v237 offset0:0 offset1:16
    v_add_u32 v236, 33792, v234
    v_add_u32 v237, 35840, v235
    ds_read2_b32 v[220:221], v236 offset0:0 offset1:16
    ds_read2_b32 v[222:223], v236 offset0:32 offset1:48
    ds_read2_b32 v[224:225], v236 offset0:64 offset1:80
    ds_read2_b32 v[226:227], v236 offset0:96 offset1:112
    ds_read2_b32 v[228:229], v237 offset0:0 offset1:16
    s_waitcnt lgkmcnt(14)
    v_add_f32 v60, v60, v200
    v_add_f32 v61, v61, v201
    s_waitcnt lgkmcnt(13)
    v_add_f32 v62, v62, v202
    v_add_f32 v63, v63, v203
    s_waitcnt lgkmcnt(12)
    v_add_f32 v64, v64, v204
    v_add_f32 v65, v65, v205
    s_waitcnt lgkmcnt(11)
    v_add_f32 v66, v66, v206
    v_add_f32 v67, v67, v207
    s_waitcnt lgkmcnt(10)
    v_add_f32 v68, v68, v208
    v_add_f32 v69, v69, v209
    s_waitcnt lgkmcnt(9)
    v_add_f32 v70, v70, v210
    v_add_f32 v71, v71, v211
    s_waitcnt lgkmcnt(8)
    v_add_f32 v72, v72, v212
    v_add_f32 v73, v73, v213
    s_waitcnt lgkmcnt(7)
    v_add_f32 v74, v74, v214
    v_add_f32 v75, v75, v215
    s_waitcnt lgkmcnt(6)
    v_add_f32 v76, v76, v216
    v_add_f32 v77, v77, v217
    s_waitcnt lgkmcnt(5)
    v_add_f32 v78, v78, v218
    v_add_f32 v79, v79, v219
    s_waitcnt lgkmcnt(4)
    v_add_f32 v80, v80, v220
    v_add_f32 v81, v81, v221
    s_waitcnt lgkmcnt(3)
    v_add_f32 v82, v82, v222
    v_add_f32 v83, v83, v223
    s_waitcnt lgkmcnt(2)
    v_add_f32 v84, v84, v224
    v_add_f32 v85, v85, v225
    s_waitcnt lgkmcnt(1)
    v_add_f32 v86, v86, v226
    v_add_f32 v87, v87, v227
    s_waitcnt lgkmcnt(0)
    v_add_f32 v88, v88, v228
    v_add_f32 v89, v89, v229
    s_waitcnt vmcnt(0)
    v_cmp_ne_u32 vcc, s14, v247
    s_nop 0
    s_cbranch_vccz adaLN_cond__spectral_fnet__geglu_ffn__prompt_kernel_ok41
    s_mov_b32 s52, 0
adaLN_cond__spectral_fnet__geglu_ffn__prompt_kernel_p43:
    buffer_load_dword v247, v253, s[16:19], s87 offen sc1
    s_waitcnt vmcnt(0)
    s_add_u32 s52, s52, 1
    s_cmp_gt_u32 s52, 0x400000
    s_cbranch_scc1 adaLN_cond__spectral_fnet__geglu_ffn__prompt_kernel_x44
    v_cmp_ne_u32 vcc, s14, v247
    s_nop 0
    s_cbranch_vccnz adaLN_cond__spectral_fnet__geglu_ffn__prompt_kernel_p43
adaLN_cond__spectral_fnet__geglu_ffn__prompt_kernel_x44:
adaLN_cond__spectral_fnet__geglu_ffn__prompt_kernel_ok41:
    s_cmp_lg_u32 s15, 0
    s_cbranch_scc1 adaLN_cond__spectral_fnet__geglu_ffn__prompt_kernel_e42
    buffer_inv sc1
    s_waitcnt vmcnt(0)
adaLN_cond__spectral_fnet__geglu_ffn__prompt_kernel_e42:
    s_mov_b32 m0, 0
    s_nop 0
    buffer_load_dwordx4 v239, s[24:27], s63 offen sc1 lds
    s_add_u32 m0, m0, 1024
    s_nop 0
    buffer_load_dwordx4 v241, s[24:27], s64 offen sc1 lds
    s_add_u32 m0, m0, 1024
    s_nop 0
    buffer_load_dwordx4 v242, s[24:27], s64 offen sc1 lds
    s_add_u32 m0, m0, 1024
    s_nop 0
    buffer_load_dwordx4 v243, s[24:27], s64 offen sc1 lds
    s_add_u32 m0, m0, 1024
    s_nop 0
    buffer_load_dwordx4 v244, s[24:27], s64 offen sc1 lds
    s_add_u32 m0, m0, 1024
    s_add_u32 s53, s53, 81920
    buffer_load_dwordx4 v240, s[24:27], s65 offen sc1 lds
    s_add_u32 m0, m0, 1024
    s_nop 0
    buffer_load_dwordx4 v241, s[24:27], s65 offen sc1 lds
    s_add_u32 m0, m0, 1024
    s_nop 0
    buffer_load_dwordx4 v242, s[24:27], s65 offen sc1 lds
    s_add_u32 m0, m0, 1024
    s_nop 0
    buffer_load_dwordx4 v243, s[24:27], s65 offen sc1 lds
    s_add_u32 m0, m0, 1024
    s_nop 0
    buffer_load_dwordx4 v244, s[24:27], s65 offen sc1 lds
    s_add_u32 m0, m0, 1024
    s_barrier
    ds_read_b64_tr_b16 a[96:97], v16 offset:0
    ds_read_b64_tr_b16 a[98:99], v16 offset:768
    ds_read_b64_tr_b16 a[100:101], v16 offset:6144
    ds_read_b64_tr_b16 a[102:103], v16 offset:6912
    ds_read_b64_tr_b16 a[104:105], v17 offset:0
    ds_read_b64_tr_b16 a[106:107], v17 offset:768
    ds_read_b64_tr_b16 a[108:109], v16 offset:12288
    ds_read_b64_tr_b16 a[110:111], v16 offset:13056
    ds_read_b64_tr_b16 a[112:113], v16 offset:18432
    ds_read_b64_tr_b16 a[114:115], v16 offset:19200
    ds_read_b64_tr_b16 a[116:117], v17 offset:12288
    ds_read_b64_tr_b16 a[118:119], v17 offset:13056
    ds_read_b64_tr_b16 a[72:73], v14 offset:24576
    ds_read_b64_tr_b16 a[74:75], v14 offset:25344
    ds_read_b64_tr_b16 a[76:77], v14 offset:30720
    ds_read_b64_tr_b16 a[78:79], v14 offset:31488
    ds_read_b64_tr_b16 a[80:81], v15 offset:24576
    ds_read_b64_tr_b16 a[82:83], v15 offset:25344
    ds_read_b64_tr_b16 a[84:85], v14 offset:36864
    ds_read_b64_tr_b16 a[86:87], v14 offset:37632
    ds_read_b64_tr_b16 a[88:89], v14 offset:43008
    ds_read_b64_tr_b16 a[90:91], v14 offset:43776
    ds_read_b64_tr_b16 a[92:93], v15 offset:36864
    ds_read_b64_tr_b16 a[94:95], v15 offset:37632
    v_cvt_pk_bf16_f32 v232, v60, v61
    v_cvt_pk_bf16_f32 v233, v62, v63
    v_cvt_pk_bf16_f32 v234, v64, v65
    v_cvt_pk_bf16_f32 v235, v66, v67
    v_cvt_pk_bf16_f32 v236, v68, v69
    v_lshlrev_b32 v200, 16, v232
    v_and_b32 v201, 0xffff0000, v232
    v_lshlrev_b32 v202, 16, v233
    v_and_b32 v203, 0xffff0000, v233
    v_lshlrev_b32 v204, 16, v234
    v_and_b32 v205, 0xffff0000, v234
    v_lshlrev_b32 v206, 16, v235
    v_and_b32 v207, 0xffff0000, v235
    v_lshlrev_b32 v208, 16, v236
    v_and_b32 v209, 0xffff0000, v236
    v_cvt_pk_bf16_f32 v232, v70, v71
    v_cvt_pk_bf16_f32 v233, v72, v73
    v_cvt_pk_bf16_f32 v234, v74, v75
    v_cvt_pk_bf16_f32 v235, v76, v77
    v_cvt_pk_bf16_f32 v236, v78, v79
    v_lshlrev_b32 v210, 16, v232
    v_and_b32 v211, 0xffff0000, v232
    v_lshlrev_b32 v212, 16, v233
    v_and_b32 v213, 0xffff0000, v233
    v_lshlrev_b32 v214, 16, v234
    v_and_b32 v215, 0xffff0000, v234
    v_lshlrev_b32 v216, 16, v235
    v_and_b32 v217, 0xffff0000, v235
    v_lshlrev_b32 v218, 16, v236
    v_and_b32 v219, 0xffff0000, v236
    v_cvt_pk_bf16_f32 v232, v80, v81
    v_cvt_pk_bf16_f32 v233, v82, v83
    v_cvt_pk_bf16_f32 v234, v84, v85
    v_cvt_pk_bf16_f32 v235, v86, v87
    v_cvt_pk_bf16_f32 v236, v88, v89
    v_lshlrev_b32 v220, 16, v232
    v_and_b32 v221, 0xffff0000, v232
    v_lshlrev_b32 v222, 16, v233
    v_and_b32 v223, 0xffff0000, v233
    v_lshlrev_b32 v224, 16, v234
    v_and_b32 v225, 0xffff0000, v234
    v_lshlrev_b32 v226, 16, v235
    v_and_b32 v227, 0xffff0000, v235
    v_lshlrev_b32 v228, 16, v236
    v_and_b32 v229, 0xffff0000, v236
    v_add_f32 v220, 1.0, v220
    v_add_f32 v221, 1.0, v221
    v_add_f32 v222, 1.0, v222
    v_add_f32 v223, 1.0, v223
    v_add_f32 v224, 1.0, v224
    v_add_f32 v225, 1.0, v225
    v_add_f32 v226, 1.0, v226
    v_add_f32 v227, 1.0, v227
    v_add_f32 v228, 1.0, v228
    v_add_f32 v229, 1.0, v229
    v_cvt_pk_bf16_f32 v232, v220, v221
    v_cvt_pk_bf16_f32 v233, v222, v223
    v_cvt_pk_bf16_f32 v234, v224, v225
    v_cvt_pk_bf16_f32 v235, v226, v227
    v_cvt_pk_bf16_f32 v236, v228, v229
    v_lshlrev_b32 v220, 16, v232
    v_and_b32 v221, 0xffff0000, v232
    v_lshlrev_b32 v222, 16, v233
    v_and_b32 v223, 0xffff0000, v233
    v_lshlrev_b32 v224, 16, v234
    v_and_b32 v225, 0xffff0000, v234
    v_lshlrev_b32 v226, 16, v235
    v_and_b32 v227, 0xffff0000, v235
    v_lshlrev_b32 v228, 16, v236
    v_and_b32 v229, 0xffff0000, v236
    s_mul_i32 s52, s3, 160
    s_add_u32 s52, s52, 0
    v_mul_u32_u24 v248, 2560, v3
    v_lshl_add_u32 v248, v2, 2, v248
    v_add_u32 v248, s52, v248
    v_add_u32 v249, 1280, v248
    s_lshl_b32 s74, s3, 1
    v_and_b32 v240, 7, v1
    v_xor_b32 v240, s74, v240
    v_lshlrev_b32 v240, 4, v240
    v_lshl_add_u32 v240, v1, 7, v240
    v_xor_b32 v241, 16, v240
    v_bfe_u32 v242, v1, 2, 3
    v_xor_b32 v242, s74, v242
    v_lshlrev_b32 v242, 4, v242
    v_lshrrev_b32 v243, 2, v1
    v_lshl_add_u32 v242, v243, 7, v242
    v_and_b32 v243, 3, v1
    v_lshl_add_u32 v242, v243, 2, v242
    v_xor_b32 v243, 16, v242
    s_lshr_b32 s62, s13, 1
    s_lshl_b32 s54, s12, 3
    s_add_u32 s62, s62, s54
    s_mul_i32 s62, s62, 20480
    s_and_b32 s54, s13, 1
    s_lshl_b32 s54, s54, 7
    s_add_u32 s62, s62, s54
    s_add_u32 s62, s62, 0
    v_lshrrev_b32 v232, 3, v1
    v_xor_b32 v245, v232, v1
    v_and_b32 v245, 7, v245
    v_lshlrev_b32 v245, 4, v245
    v_lshl_add_u32 v245, v232, 8, v245
    s_mul_i32 s75, s13, 3072
    s_mul_i32 s52, s3, 768
    s_add_u32 s75, s75, s52
    s_mul_i32 s66, s12, 393216
    s_mul_i32 s67, s12, 163840
    s_mov_b32 s20, s46
    s_and_b32 s21, s47, 0xffff
    s_mov_b32 s22, 2621440
    s_mov_b32 s23, 0x20000
    s_mul_i32 s76, s12, 163840
    s_mul_i32 s77, s3, 10240
    s_add_u32 s76, s76, s77
    s_add_u32 s76, s76, 0
    s_lshl_b32 s78, s12, 7
    s_lshl_b32 s52, s13, 3
    s_add_u32 s78, s78, s52
    s_add_u32 s78, s78, s74
    s_mul_i32 s78, s78, 1280
    s_add_u32 s78, s78, 3145728
    s_and_b32 s79, s13, 7
    s_mul_i32 s80, s79, 48
    s_mul_i32 s52, s3, 12
    s_add_u32 s80, s80, s52
    s_mul_i32 s80, s80, 5120
    s_add_u32 s88, s80, 7340032
    s_waitcnt vmcnt(0)
    s_waitcnt lgkmcnt(0)
    s_barrier
    ds_read2_b32 v[20:21], v248 offset0:0 offset1:160
    ds_read2_b32 v[22:23], v249 offset0:0 offset1:160
    ds_read2_b32 v[24:25], v248 offset0:16 offset1:176
    ds_read2_b32 v[26:27], v249 offset0:16 offset1:176
    ds_read2_b32 v[28:29], v248 offset0:24 offset1:184
    ds_read2_b32 v[30:31], v249 offset0:24 offset1:184
    s_waitcnt lgkmcnt(4)
    v_mfma_f32_16x16x32_bf16 v[32:35], v[20:23], v[104:107], 0
    v_mfma_f32_16x16x32_bf16 v[36:39], v[20:23], v[108:111], 0
    s_waitcnt lgkmcnt(2)
    v_mfma_f32_16x16x32_bf16 v[40:43], v[24:27], v[104:107], 0
    v_mfma_f32_16x16x32_bf16 v[44:47], v[24:27], v[108:111], 0
    s_waitcnt lgkmcnt(0)
    v_mfma_f32_16x16x32_bf16 v[48:51], v[28:31], v[104:107], 0
    v_mfma_f32_16x16x32_bf16 v[52:55], v[28:31], v[108:111], 0
    v_lshrrev_b32 v253, 2, v1
    v_lshlrev_b32 v253, 13, v253
    v_and_b32 v246, 3, v1
    v_lshl_add_u32 v253, v246, 4, v253
    s_cmp_lt_u32 s2, 128
    s_cbranch_scc1 adaLN_cond__spectral_fnet__geglu_ffn__prompt_kernel_g245
    s_lshl_b32 s52, s2, 5
    s_add_u32 s52, s52, 17825792
    v_mov_b32 v96, s14
    v_mov_b32 v97, s59
    v_mov_b32 v98, s14
    v_mov_b32 v99, s14
    s_mov_b32 exec_lo, 0x33333333
    s_mov_b32 exec_hi, 0x33333333
    buffer_store_dwordx4 v[96:99], v253, s[16:19], s52 offen sc1
    s_mov_b64 exec, -1
adaLN_cond__spectral_fnet__geglu_ffn__prompt_kernel_g245:
    v_pk_mul_f32 v[232:233], v[32:33], v[120:121]
    v_mfma_f32_16x16x32_bf16 v[56:59], v[20:23], v[112:115], 0
    v_pk_mul_f32 v[236:237], v[36:37], v[120:121]
    v_pk_mul_f32 v[234:235], v[34:35], v[122:123]
    v_mfma_f32_16x16x32_bf16 v[60:63], v[20:23], v[116:119], 0
    v_pk_mul_f32 v[238:239], v[38:39], v[122:123]
    v_pk_fma_f32 v[232:233], v[36:37], v[124:125], v[232:233]
    v_mfma_f32_16x16x32_bf16 v[64:67], v[24:27], v[112:115], 0
    v_pk_fma_f32 v[236:237], v[32:33], v[124:125], v[236:237] neg_lo:[1,0,0] neg_hi:[1,0,0]
    v_pk_fma_f32 v[234:235], v[38:39], v[126:127], v[234:235]
    v_mfma_f32_16x16x32_bf16 v[68:71], v[24:27], v[116:119], 0
    v_pk_fma_f32 v[238:239], v[34:35], v[126:127], v[238:239] neg_lo:[1,0,0] neg_hi:[1,0,0]
    v_cvt_pk_bf16_f32 v80, v232, v236
    v_mfma_f32_16x16x32_bf16 v[72:75], v[28:31], v[112:115], 0
    v_cvt_pk_bf16_f32 v81, v233, v237
    v_cvt_pk_bf16_f32 v82, v234, v238
    v_mfma_f32_16x16x32_bf16 v[76:79], v[28:31], v[116:119], 0
    v_cvt_pk_bf16_f32 v83, v235, v239
    v_pk_mul_f32 v[232:233], v[40:41], v[128:129]
    v_pk_mul_f32 v[236:237], v[44:45], v[128:129]
    v_pk_mul_f32 v[234:235], v[42:43], v[130:131]
    v_mfma_f32_16x16x32_bf16 v[20:23], v[144:147], v[80:83], 0
    v_pk_mul_f32 v[238:239], v[46:47], v[130:131]
    v_pk_fma_f32 v[232:233], v[44:45], v[132:133], v[232:233]
    v_pk_fma_f32 v[236:237], v[40:41], v[132:133], v[236:237] neg_lo:[1,0,0] neg_hi:[1,0,0]
    v_mfma_f32_16x16x32_bf16 v[24:27], v[156:159], v[80:83], 0
    v_pk_fma_f32 v[234:235], v[46:47], v[134:135], v[234:235]
    v_pk_fma_f32 v[238:239], v[42:43], v[134:135], v[238:239] neg_lo:[1,0,0] neg_hi:[1,0,0]
    v_cvt_pk_bf16_f32 v84, v232, v236
    v_mfma_f32_16x16x32_bf16 v[28:31], v[168:171], v[80:83], 0
    v_cvt_pk_bf16_f32 v85, v233, v237
    v_cvt_pk_bf16_f32 v86, v234, v238
    v_cvt_pk_bf16_f32 v87, v235, v239
    v_pk_mul_f32 v[232:233], v[48:49], v[136:137]
    v_pk_mul_f32 v[236:237], v[52:53], v[136:137]
    v_pk_mul_f32 v[234:235], v[50:51], v[138:139]
    v_mfma_f32_16x16x32_bf16 v[20:23], v[148:151], v[84:87], v[20:23]
    v_pk_mul_f32 v[238:239], v[54:55], v[138:139]
    v_pk_fma_f32 v[232:233], v[52:53], v[140:141], v[232:233]
    v_pk_fma_f32 v[236:237], v[48:49], v[140:141], v[236:237] neg_lo:[1,0,0] neg_hi:[1,0,0]
    v_mfma_f32_16x16x32_bf16 v[24:27], v[160:163], v[84:87], v[24:27]
    v_pk_fma_f32 v[234:235], v[54:55], v[142:143], v[234:235]
    v_pk_fma_f32 v[238:239], v[50:51], v[142:143], v[238:239] neg_lo:[1,0,0] neg_hi:[1,0,0]
    v_cvt_pk_bf16_f32 v88, v232, v236
    v_mfma_f32_16x16x32_bf16 v[28:31], v[172:175], v[84:87], v[28:31]
    v_cvt_pk_bf16_f32 v89, v233, v237
    v_cvt_pk_bf16_f32 v90, v234, v238
    v_cvt_pk_bf16_f32 v91, v235, v239
    v_pk_mul_f32 v[232:233], v[56:57], v[120:121]
    v_pk_mul_f32 v[236:237], v[60:61], v[120:121]
    v_pk_mul_f32 v[234:235], v[58:59], v[122:123]
    v_mfma_f32_16x16x32_bf16 v[20:23], v[152:155], v[88:91], v[20:23]
    v_pk_mul_f32 v[238:239], v[62:63], v[122:123]
    v_pk_fma_f32 v[232:233], v[60:61], v[124:125], v[232:233]
    v_pk_fma_f32 v[236:237], v[56:57], v[124:125], v[236:237] neg_lo:[1,0,0] neg_hi:[1,0,0]
    v_mfma_f32_16x16x32_bf16 v[24:27], v[164:167], v[88:91], v[24:27]
    v_pk_fma_f32 v[234:235], v[62:63], v[126:127], v[234:235]
    v_pk_fma_f32 v[238:239], v[58:59], v[126:127], v[238:239] neg_lo:[1,0,0] neg_hi:[1,0,0]
    v_cvt_pk_bf16_f32 v92, v232, v236
    v_mfma_f32_16x16x32_bf16 v[28:31], v[176:179], v[88:91], v[28:31]
    v_cvt_pk_bf16_f32 v93, v233, v237
    v_cvt_pk_bf16_f32 v94, v234, v238
    v_cvt_pk_bf16_f32 v95, v235, v239
    v_pk_mul_f32 v[232:233], v[64:65], v[128:129]
    v_pk_mul_f32 v[236:237], v[68:69], v[128:129]
    v_pk_mul_f32 v[234:235], v[66:67], v[130:131]
    v_mfma_f32_16x16x32_bf16 v[32:35], v[144:147], v[92:95], 0
    v_pk_mul_f32 v[238:239], v[70:71], v[130:131]
    v_pk_fma_f32 v[232:233], v[68:69], v[132:133], v[232:233]
    v_pk_fma_f32 v[236:237], v[64:65], v[132:133], v[236:237] neg_lo:[1,0,0] neg_hi:[1,0,0]
    v_mfma_f32_16x16x32_bf16 v[36:39], v[156:159], v[92:95], 0
    v_pk_fma_f32 v[234:235], v[70:71], v[134:135], v[234:235]
    v_pk_fma_f32 v[238:239], v[66:67], v[134:135], v[238:239] neg_lo:[1,0,0] neg_hi:[1,0,0]
    v_cvt_pk_bf16_f32 v96, v232, v236
    v_mfma_f32_16x16x32_bf16 v[40:43], v[168:171], v[92:95], 0
    v_cvt_pk_bf16_f32 v97, v233, v237
    v_cvt_pk_bf16_f32 v98, v234, v238
    v_cvt_pk_bf16_f32 v99, v235, v239
    v_pk_mul_f32 v[232:233], v[72:73], v[136:137]
    v_pk_mul_f32 v[236:237], v[76:77], v[136:137]
    v_pk_mul_f32 v[234:235], v[74:75], v[138:139]
    v_mfma_f32_16x16x32_bf16 v[32:35], v[148:151], v[96:99], v[32:35]
    v_pk_mul_f32 v[238:239], v[78:79], v[138:139]
    v_pk_fma_f32 v[232:233], v[76:77], v[140:141], v[232:233]
    v_pk_fma_f32 v[236:237], v[72:73], v[140:141], v[236:237] neg_lo:[1,0,0] neg_hi:[1,0,0]
    v_mfma_f32_16x16x32_bf16 v[36:39], v[160:163], v[96:99], v[36:39]
    v_pk_fma_f32 v[234:235], v[78:79], v[142:143], v[234:235]
    v_pk_fma_f32 v[238:239], v[74:75], v[142:143], v[238:239] neg_lo:[1,0,0] neg_hi:[1,0,0]
    v_cvt_pk_bf16_f32 v100, v232, v236
    v_mfma_f32_16x16x32_bf16 v[40:43], v[172:175], v[96:99], v[40:43]
    v_cvt_pk_bf16_f32 v101, v233, v237
    v_cvt_pk_bf16_f32 v102, v234, v238
    v_cvt_pk_bf16_f32 v103, v235, v239
    v_pk_fma_f32 v[180:181], v[200:201], v[20:21], v[180:181]
    v_pk_fma_f32 v[182:183], v[202:203], v[22:23], v[182:183]
    v_mfma_f32_16x16x32_bf16 v[32:35], v[152:155], v[100:103], v[32:35]
    v_pk_fma_f32 v[184:185], v[204:205], v[24:25], v[184:185]
    v_pk_fma_f32 v[186:187], v[206:207], v[26:27], v[186:187]
    v_mfma_f32_16x16x32_bf16 v[36:39], v[164:167], v[100:103], v[36:39]
adaLN_cond__spectral_fnet__geglu_ffn__prompt_kernel_hop3:
    s_cbranch_execz adaLN_cond__spectral_fnet__geglu_ffn__prompt_kernel_hop7
    v_pk_fma_f32 v[188:189], v[208:209], v[28:29], v[188:189]
    v_pk_add_f32 v[232:233], v[180:181], v[182:183]
    v_mfma_f32_16x16x32_bf16 v[40:43], v[176:179], v[100:103], v[40:43]
    v_pk_mul_f32 v[234:235], v[180:181], v[180:181]
    v_pk_fma_f32 v[234:235], v[182:183], v[182:183], v[234:235]
    v_pk_add_f32 v[232:233], v[232:233], v[184:185]
    v_pk_fma_f32 v[234:235], v[184:185], v[184:185], v[234:235]
    v_pk_add_f32 v[232:233], v[232:233], v[186:187]
    v_pk_fma_f32 v[234:235], v[186:187], v[186:187], v[234:235]
    v_pk_add_f32 v[232:233], v[232:233], v[188:189]
    v_pk_fma_f32 v[234:235], v[188:189], v[188:189], v[234:235]
    v_add_f32 v230, v232, v233
    v_add_f32 v231, v234, v235
    v_pk_fma_f32 v[190:191], v[200:201], v[32:33], v[190:191]
    v_pk_fma_f32 v[192:193], v[202:203], v[34:35], v[192:193]
    v_pk_fma_f32 v[194:195], v[204:205], v[36:37], v[194:195]
    v_pk_fma_f32 v[196:197], v[206:207], v[38:39], v[196:197]
    v_pk_fma_f32 v[198:199], v[208:209], v[40:41], v[198:199]
    v_pk_add_f32 v[236:237], v[190:191], v[192:193]
    v_pk_mul_f32 v[238:239], v[190:191], v[190:191]
    v_pk_fma_f32 v[238:239], v[192:193], v[192:193], v[238:239]
    v_pk_add_f32 v[236:237], v[236:237], v[194:195]
    v_pk_fma_f32 v[238:239], v[194:195], v[194:195], v[238:239]
    v_pk_add_f32 v[236:237], v[236:237], v[196:197]
    v_pk_fma_f32 v[238:239], v[196:197], v[196:197], v[238:239]
    v_pk_add_f32 v[236:237], v[236:237], v[198:199]
    v_pk_fma_f32 v[238:239], v[198:199], v[198:199], v[238:239]
    v_add_f32 v254, v236, v237
    v_add_f32 v255, v238, v239
    v_permlane16_swap_b32 v230, v231
    s_nop 0
    v_permlane16_swap_b32 v254, v255
    v_add_f32 v232, v230, v231
    v_add_f32 v234, v254, v255
    s_nop 1
    v_permlane32_swap_b32 v232, v234
    v_add_f32 v232, v232, v234
    s_nop 1
    v_add_f32_dpp v232, v232, v232 row_ror:8 row_mask:0xf bank_mask:0xf
    s_nop 1
    v_add_f32_dpp v232, v232, v232 row_ror:4 row_mask:0xf bank_mask:0xf
    s_nop 1
    v_add_f32_dpp v232, v232, v232 row_ror:2 row_mask:0xf bank_mask:0xf
    s_nop 1
    v_add_f32_dpp v232, v232, v232 row_ror:1 row_mask:0xf bank_mask:0xf
    v_mul_f32 v232, 0x3acccccd, v232
    s_nop 0
    v_readlane_b32 s52, v232, 0
    v_readlane_b32 s53, v232, 16
    v_readlane_b32 s54, v232, 32
    v_readlane_b32 s55, v232, 48
    v_mov_b32 v234, s53
    v_mov_b32 v236, s52
    v_mov_b32 v235, s55
    v_mov_b32 v237, s54
    v_fma_f32 v234, -v236, v236, v234
    v_fma_f32 v235, -v237, v237, v235
    v_max_f32 v234, 0, v234
    v_max_f32 v235, 0, v235
    v_add_f32 v234, 0x3727c5ac, v234
    v_add_f32 v235, 0x3727c5ac, v235
    v_rsq_f32 v234, v234
    v_rsq_f32 v235, v235
    v_mul_f32 v236, -v236, v234
    v_mul_f32 v237, -v237, v235
    v_pk_fma_f32 v[48:49], v[180:181], v[234:235], v[236:237] op_sel:[0,0,0] op_sel_hi:[1,0,0]
    v_pk_fma_f32 v[50:51], v[182:183], v[234:235], v[236:237] op_sel:[0,0,0] op_sel_hi:[1,0,0]
    v_pk_fma_f32 v[52:53], v[184:185], v[234:235], v[236:237] op_sel:[0,0,0] op_sel_hi:[1,0,0]
    v_pk_fma_f32 v[54:55], v[186:187], v[234:235], v[236:237] op_sel:[0,0,0] op_sel_hi:[1,0,0]
    v_pk_fma_f32 v[56:57], v[188:189], v[234:235], v[236:237] op_sel:[0,0,0] op_sel_hi:[1,0,0]
    v_pk_fma_f32 v[48:49], v[48:49], v[220:221], v[210:211]
    v_pk_fma_f32 v[50:51], v[50:51], v[222:223], v[212:213]
    v_pk_fma_f32 v[52:53], v[52:53], v[224:225], v[214:215]
    v_pk_fma_f32 v[54:55], v[54:55], v[226:227], v[216:217]
    v_pk_fma_f32 v[56:57], v[56:57], v[228:229], v[218:219]
    v_cvt_pk_bf16_f32 v80, v48, v49
    v_cvt_pk_bf16_f32 v81, v50, v51
    v_cvt_pk_bf16_f32 v82, v52, v53
    v_cvt_pk_bf16_f32 v83, v54, v55
    v_cvt_pk_bf16_f32 v84, v56, v57
    ds_write_b128 v240, v[80:83] offset:10240
    ds_write_b32 v242, v84 offset:18432
    v_pk_fma_f32 v[60:61], v[190:191], v[234:235], v[236:237] op_sel:[0,1,1] op_sel_hi:[1,1,1]
    v_pk_fma_f32 v[62:63], v[192:193], v[234:235], v[236:237] op_sel:[0,1,1] op_sel_hi:[1,1,1]
    v_pk_fma_f32 v[64:65], v[194:195], v[234:235], v[236:237] op_sel:[0,1,1] op_sel_hi:[1,1,1]
    v_pk_fma_f32 v[66:67], v[196:197], v[234:235], v[236:237] op_sel:[0,1,1] op_sel_hi:[1,1,1]
    v_pk_fma_f32 v[68:69], v[198:199], v[234:235], v[236:237] op_sel:[0,1,1] op_sel_hi:[1,1,1]
    v_pk_fma_f32 v[60:61], v[60:61], v[220:221], v[210:211]
    v_pk_fma_f32 v[62:63], v[62:63], v[222:223], v[212:213]
    v_pk_fma_f32 v[64:65], v[64:65], v[224:225], v[214:215]
    v_pk_fma_f32 v[66:67], v[66:67], v[226:227], v[216:217]
    v_pk_fma_f32 v[68:69], v[68:69], v[228:229], v[218:219]
    v_cvt_pk_bf16_f32 v88, v60, v61
    v_cvt_pk_bf16_f32 v89, v62, v63
    v_cvt_pk_bf16_f32 v90, v64, v65
    v_cvt_pk_bf16_f32 v91, v66, v67
    v_cvt_pk_bf16_f32 v92, v68, v69
    ds_write_b128 v241, v[88:91] offset:10240
    ds_write_b32 v243, v92 offset:18432
    s_waitcnt lgkmcnt(0)
    s_barrier
    ds_read_b128 v[136:139], v18 offset:10240
    ds_read_b128 v[140:143], v18 offset:11264
    ds_read_b128 v[144:147], v18 offset:12288
    ds_read_b128 v[148:151], v18 offset:13312
    ds_read_b128 v[152:155], v18 offset:14336
    ds_read_b128 v[156:159], v18 offset:15360
    ds_read_b128 v[160:163], v18 offset:16384
    ds_read_b128 v[164:167], v18 offset:17408
    ds_read_b128 v[168:171], v18 offset:18432
    ds_read_b128 v[172:175], v18 offset:19456
    s_waitcnt lgkmcnt(9)
    buffer_store_dwordx4 v[136:139], v245, s[16:19], s62 offen offset:0
    s_waitcnt lgkmcnt(8)
    buffer_store_dwordx4 v[140:143], v245, s[16:19], s62 offen offset:2048
    s_add_u32 s62, s62, 4096
    s_waitcnt lgkmcnt(7)
    buffer_store_dwordx4 v[144:147], v245, s[16:19], s62 offen offset:0
    s_waitcnt lgkmcnt(6)
    buffer_store_dwordx4 v[148:151], v245, s[16:19], s62 offen offset:2048
    s_add_u32 s62, s62, 4096
    s_waitcnt lgkmcnt(5)
    buffer_store_dwordx4 v[152:155], v245, s[16:19], s62 offen offset:0
    s_waitcnt lgkmcnt(4)
    buffer_store_dwordx4 v[156:159], v245, s[16:19], s62 offen offset:2048
    s_add_u32 s62, s62, 4096
    s_waitcnt lgkmcnt(3)
    buffer_store_dwordx4 v[160:163], v245, s[16:19], s62 offen offset:0
    s_waitcnt lgkmcnt(2)
    buffer_store_dwordx4 v[164:167], v245, s[16:19], s62 offen offset:2048
    s_add_u32 s62, s62, 4096
    s_waitcnt lgkmcnt(1)
    buffer_store_dwordx4 v[168:171], v245, s[16:19], s62 offen offset:0
    s_waitcnt lgkmcnt(0)
    buffer_store_dwordx4 v[172:175], v245, s[16:19], s62 offen offset:2048
    v_add_u32 v250, 10240, v250
    v_add_u32 v251, 10240, v251
    s_add_u32 s72, s72, 10240
    v_cvt_pk_bf16_f32 v20, v180, v181
    v_cvt_pk_bf16_f32 v21, v182, v183
    v_cvt_pk_bf16_f32 v22, v184, v185
    v_cvt_pk_bf16_f32 v23, v186, v187
    v_cvt_pk_bf16_f32 v24, v188, v189
    ds_write_b16 v250, v20 offset:0
    ds_write_b16_d16_hi v250, v20 offset:32
    ds_write_b16 v250, v21 offset:64
    ds_write_b16_d16_hi v250, v21 offset:96
    ds_write_b16 v250, v22 offset:128
    ds_write_b16_d16_hi v250, v22 offset:160
    ds_write_b16 v250, v23 offset:192
    ds_write_b16_d16_hi v250, v23 offset:224
    ds_write_b16 v251, v24 offset:1024
    ds_write_b16_d16_hi v251, v24 offset:1056
    v_cvt_pk_bf16_f32 v28, v190, v191
    v_cvt_pk_bf16_f32 v29, v192, v193
    v_cvt_pk_bf16_f32 v30, v194, v195
    v_cvt_pk_bf16_f32 v31, v196, v197
    v_cvt_pk_bf16_f32 v32, v198, v199
    ds_write_b16 v250, v28 offset:1280
    ds_write_b16_d16_hi v250, v28 offset:1312
    ds_write_b16 v250, v29 offset:1344
    ds_write_b16_d16_hi v250, v29 offset:1376
    ds_write_b16 v250, v30 offset:1408
    ds_write_b16_d16_hi v250, v30 offset:1440
    ds_write_b16 v250, v31 offset:1472
    ds_write_b16_d16_hi v250, v31 offset:1504
    ds_write_b16 v251, v32 offset:2304
    ds_write_b16_d16_hi v251, v32 offset:2336
    v_add_u32 v234, s72, v18
    v_lshlrev_b32 v107, 2, v1
    v_add_u32 v235, s72, v107
    s_waitcnt vmcnt(0)
    s_add_u32 s53, s68, 4096
    s_lshl_b32 s52, s13, 2
    s_add_u32 s52, s52, s53
    v_mov_b32 v252, s14
    v_mov_b32 v253, 0
    s_mov_b64 exec, 1
    s_cmp_eq_u32 s15, 0
    s_cbranch_scc1 adaLN_cond__spectral_fnet__geglu_ffn__prompt_kernel_s46
    buffer_store_dword v252, v253, s[16:19], s52 offen
    s_branch adaLN_cond__spectral_fnet__geglu_ffn__prompt_kernel_e47
adaLN_cond__spectral_fnet__geglu_ffn__prompt_kernel_s46:
    buffer_wbl2 sc1
    s_waitcnt vmcnt(0)
    buffer_store_dword v252, v253, s[16:19], s52 offen sc1
adaLN_cond__spectral_fnet__geglu_ffn__prompt_kernel_e47:
    s_mov_b64 exec, -1
    s_add_u32 s63, s68, 4096
    v_lshlrev_b32 v253, 2, v2
    buffer_load_dword v247, v253, s[16:19], s63 offen sc1
    s_lshl_b32 s87, s12, 13
    s_add_u32 s87, s87, 17829888
    s_add_u32 s86, s87, 2048
    v_lshlrev_b32 v246, 5, v1
    buffer_load_dword v244, v246, s[16:19], s87 offen sc1
    buffer_load_dword v245, v246, s[16:19], s86 offen sc1
    s_waitcnt lgkmcnt(0)
    ds_read_b128 v[96:99], v234 offset:0
    ds_read_b32 v104, v235 offset:1024
    ds_read_b128 v[100:103], v234 offset:1280
    ds_read_b32 v105, v235 offset:2304
    ds_read_b64_tr_b16 a[120:121], v12 offset:0
    ds_read_b64_tr_b16 a[122:123], v12 offset:768
    ds_read_b64_tr_b16 a[124:125], v12 offset:6144
    ds_read_b64_tr_b16 a[126:127], v12 offset:6912
    ds_read_b64_tr_b16 a[128:129], v13 offset:0
    ds_read_b64_tr_b16 a[130:131], v13 offset:768
    ds_read_b64_tr_b16 a[132:133], v12 offset:12288
    ds_read_b64_tr_b16 a[134:135], v12 offset:13056
    ds_read_b64_tr_b16 a[136:137], v12 offset:18432
    ds_read_b64_tr_b16 a[138:139], v12 offset:19200
    ds_read_b64_tr_b16 a[140:141], v13 offset:12288
    ds_read_b64_tr_b16 a[142:143], v13 offset:13056
    ds_read_b64_tr_b16 a[144:145], v12 offset:24576
    ds_read_b64_tr_b16 a[146:147], v12 offset:25344
    ds_read_b64_tr_b16 a[148:149], v12 offset:30720
    ds_read_b64_tr_b16 a[150:151], v12 offset:31488
    ds_read_b64_tr_b16 a[152:153], v13 offset:24576
    ds_read_b64_tr_b16 a[154:155], v13 offset:25344
    ds_read_b64_tr_b16 a[156:157], v12 offset:36864
    ds_read_b64_tr_b16 a[158:159], v12 offset:37632
    ds_read_b64_tr_b16 a[160:161], v12 offset:43008
    ds_read_b64_tr_b16 a[162:163], v12 offset:43776
    ds_read_b64_tr_b16 a[164:165], v13 offset:36864
    ds_read_b64_tr_b16 a[166:167], v13 offset:37632
    s_waitcnt vmcnt(2)
    v_cmp_ne_u32 vcc, s14, v247
    s_nop 0
    s_cbranch_vccz adaLN_cond__spectral_fnet__geglu_ffn__prompt_kernel_ok48
    s_mov_b32 s52, 0
adaLN_cond__spectral_fnet__geglu_ffn__prompt_kernel_p50:
    buffer_load_dword v247, v253, s[16:19], s63 offen sc1
    s_waitcnt vmcnt(0)
    s_add_u32 s52, s52, 1
    s_cmp_gt_u32 s52, 0x400000
    s_cbranch_scc1 adaLN_cond__spectral_fnet__geglu_ffn__prompt_kernel_x51
    v_cmp_ne_u32 vcc, s14, v247
    s_nop 0
    s_cbranch_vccnz adaLN_cond__spectral_fnet__geglu_ffn__prompt_kernel_p50
adaLN_cond__spectral_fnet__geglu_ffn__prompt_kernel_x51:
adaLN_cond__spectral_fnet__geglu_ffn__prompt_kernel_ok48:
    s_cmp_lg_u32 s15, 0
    s_cbranch_scc1 adaLN_cond__spectral_fnet__geglu_ffn__prompt_kernel_e49
    buffer_inv sc1
    s_waitcnt vmcnt(0)
adaLN_cond__spectral_fnet__geglu_ffn__prompt_kernel_e49:
    s_waitcnt vmcnt(1)
    v_xor_b32 v244, s14, v244
    s_waitcnt vmcnt(0)
    v_xor_b32 v245, s14, v245
    v_or_b32 v244, v244, v245
    v_cmp_ne_u32 vcc, 0, v244
    s_nop 0
    s_cbranch_vccz adaLN_cond__spectral_fnet__geglu_ffn__prompt_kernel_ok52
    s_mov_b32 s52, 0
adaLN_cond__spectral_fnet__geglu_ffn__prompt_kernel_p53:
    buffer_load_dword v244, v246, s[16:19], s87 offen sc1
    buffer_load_dword v245, v246, s[16:19], s86 offen sc1
    s_waitcnt vmcnt(0)
    s_add_u32 s52, s52, 1
    s_cmp_gt_u32 s52, 0x400000
    s_cbranch_scc1 adaLN_cond__spectral_fnet__geglu_ffn__prompt_kernel_x54
    v_xor_b32 v244, s14, v244
    v_xor_b32 v245, s14, v245
    v_or_b32 v244, v244, v245
    v_cmp_ne_u32 vcc, 0, v244
    s_nop 0
    s_cbranch_vccnz adaLN_cond__spectral_fnet__geglu_ffn__prompt_kernel_p53
adaLN_cond__spectral_fnet__geglu_ffn__prompt_kernel_x54:
adaLN_cond__spectral_fnet__geglu_ffn__prompt_kernel_ok52:
    s_waitcnt lgkmcnt(15)
    s_waitcnt lgkmcnt(0)
    s_barrier
    s_branch adaLN_cond__spectral_fnet__geglu_ffn__prompt_kernel_x922
adaLN_cond__spectral_fnet__geglu_ffn__prompt_kernel_wn21:
    s_sub_u32 s52, s3, 1
    v_lshlrev_b32 v232, 2, v1
    s_mul_i32 s53, s52, 3
    s_add_u32 s53, s53, 0
    s_lshr_b32 s54, s53, 1
    s_lshl_b32 s54, s54, 5
    s_add_u32 s54, s54, s69
    s_sub_u32 s55, 2048, s54
    s_cmp_eq_u32 s54, 0
    s_cselect_b32 s55, 1024, s55
    s_bitcmp1_b32 s53, 0
    s_cselect_b32 s54, s55, s54
    s_mul_i32 s54, s54, 1280
    s_mul_i32 s53, s53, 1280
    s_add_u32 m0, s53, 10240
    s_nop 0
    buffer_load_dwordx4 v18, s[20:23], s54 offen lds
    buffer_load_dword v232, s[20:23], s54 offen offset:1024 lds
adaLN_cond__spectral_fnet__geglu_ffn__prompt_kernel_xr56:
    s_mul_i32 s53, s52, 3
    s_add_u32 s53, s53, 1
    s_lshr_b32 s54, s53, 1
    s_lshl_b32 s54, s54, 5
    s_add_u32 s54, s54, s69
    s_sub_u32 s55, 2048, s54
    s_cmp_eq_u32 s54, 0
    s_cselect_b32 s55, 1024, s55
    s_bitcmp1_b32 s53, 0
    s_cselect_b32 s54, s55, s54
    s_mul_i32 s54, s54, 1280
    s_mul_i32 s53, s53, 1280
    s_add_u32 m0, s53, 10240
    s_nop 0
    buffer_load_dwordx4 v18, s[20:23], s54 offen lds
    buffer_load_dword v232, s[20:23], s54 offen offset:1024 lds
adaLN_cond__spectral_fnet__geglu_ffn__prompt_kernel_xr57:
    s_mul_i32 s53, s52, 3
    s_add_u32 s53, s53, 2
    s_cmp_eq_u32 s53, 8
    s_cbranch_scc1 adaLN_cond__spectral_fnet__geglu_ffn__prompt_kernel_xr58
    s_lshr_b32 s54, s53, 1
    s_lshl_b32 s54, s54, 5
    s_add_u32 s54, s54, s69
    s_sub_u32 s55, 2048, s54
    s_cmp_eq_u32 s54, 0
    s_cselect_b32 s55, 1024, s55
    s_bitcmp1_b32 s53, 0
    s_cselect_b32 s54, s55, s54
    s_mul_i32 s54, s54, 1280
    s_mul_i32 s53, s53, 1280
    s_add_u32 m0, s53, 10240
    s_nop 0
    buffer_load_dwordx4 v18, s[20:23], s54 offen lds
    buffer_load_dword v232, s[20:23], s54 offen offset:1024 lds
adaLN_cond__spectral_fnet__geglu_ffn__prompt_kernel_xr58:
    s_sub_u32 s52, s3, 1
    s_cmp_lg_u32 s3, 3
    s_cbranch_scc1 adaLN_cond__spectral_fnet__geglu_ffn__prompt_kernel_zt59
    s_lshl_b32 s53, s12, 4
    s_add_u32 s53, s53, s13
    s_mul_i32 s53, s53, 10240
    s_mul_i32 s54, s52, 5120
    s_add_u32 s53, s53, s54
    s_add_u32 s53, s53, 3145728
    s_cmp_eq_u32 s3, 3
    s_cselect_b32 s53, s68, s53
    v_min_u32 v232, 39, v1
    v_lshlrev_b32 v232, 7, v232
    v_and_b32 v233, 15, v1
    v_lshlrev_b32 v233, 11, v233
    v_bfe_u32 v234, v1, 0, 1
    v_mul_u32_u24 v234, 1920, v234
    v_sub_u32 v233, v233, v234
    s_cselect_b64 vcc, -1, 0
    v_cndmask_b32 v232, v232, v233, vcc
    buffer_load_dword a246, v232, s[16:19], s53 offen
adaLN_cond__spectral_fnet__geglu_ffn__prompt_kernel_zt59:
    s_add_u32 s58, s57, 24576
    s_add_u32 m0, s56, 24576
    s_nop 0
    buffer_load_dwordx4 v4, s[28:31], s58 offen lds
    s_add_u32 m0, m0, 1024
    s_nop 0
    buffer_load_dwordx4 v5, s[28:31], s58 offen lds
    s_add_u32 m0, m0, 1024
    s_nop 0
    buffer_load_dwordx4 v6, s[32:35], s58 offen lds
    s_add_u32 m0, m0, 1024
    s_nop 0
    buffer_load_dwordx4 v7, s[32:35], s58 offen lds
    s_add_u32 s58, s57, 36864
    s_add_u32 m0, s56, 36864
    s_nop 0
    buffer_load_dwordx4 v4, s[28:31], s58 offen lds
    s_add_u32 m0, m0, 1024
    s_nop 0
    buffer_load_dwordx4 v5, s[28:31], s58 offen lds
    s_add_u32 m0, m0, 1024
    s_nop 0
    buffer_load_dwordx4 v6, s[32:35], s58 offen lds
    s_add_u32 m0, m0, 1024
    s_nop 0
    buffer_load_dwordx4 v7, s[32:35], s58 offen lds
    ds_read_b128 v[104:107], v18 offset:20480
    ds_read_b128 v[108:111], v18 offset:21504
    ds_read_b128 v[120:123], v18 offset:22528
    ds_read_b128 v[124:127], v18 offset:23552
    ds_read_b128 v[128:131], v18 offset:24576
    ds_read_b128 v[132:135], v18 offset:25600
    ds_read_b128 v[136:139], v18 offset:26624
    ds_read_b128 v[140:143], v18 offset:27648
    ds_read_b128 v[144:147], v18 offset:28672
    ds_read_b128 v[148:151], v18 offset:29696
    ds_read_b128 v[152:155], v18 offset:30720
    ds_read_b128 v[156:159], v18 offset:31744
    ds_read_b128 v[160:163], v18 offset:32768
    ds_read_b128 v[164:167], v18 offset:33792
    ds_read_b128 v[168:171], v18 offset:34816
    ds_read_b128 v[172:175], v18 offset:35840
    ds_read_b128 v[176:179], v18 offset:36864
    s_cmp_eq_u32 s70, 0
    s_cselect_b64 vcc, -1, 0
    s_cselect_b32 s52, 0xffff, -1
    s_waitcnt lgkmcnt(15)
    v_xor_b32 v112, 0x80000000, v104
    v_lshlrev_b32 v236, 16, v104
    v_cndmask_b32 v112, v112, v236, vcc
    v_and_b32 v104, s52, v104
    v_xor_b32 v113, 0x80000000, v105
    v_lshlrev_b32 v236, 16, v105
    v_cndmask_b32 v113, v113, v236, vcc
    v_and_b32 v105, s52, v105
    v_xor_b32 v114, 0x80000000, v106
    v_lshlrev_b32 v236, 16, v106
    v_cndmask_b32 v114, v114, v236, vcc
    v_and_b32 v106, s52, v106
    v_xor_b32 v115, 0x80000000, v107
    v_lshlrev_b32 v236, 16, v107
    v_cndmask_b32 v115, v115, v236, vcc
    v_and_b32 v107, s52, v107
    v_xor_b32 v116, 0x80000000, v108
    v_lshlrev_b32 v236, 16, v108
    v_cndmask_b32 v116, v116, v236, vcc
    v_and_b32 v108, s52, v108
    v_xor_b32 v117, 0x80000000, v109
    v_lshlrev_b32 v236, 16, v109
    v_cndmask_b32 v117, v117, v236, vcc
    v_and_b32 v109, s52, v109
    v_xor_b32 v118, 0x80000000, v110
    v_lshlrev_b32 v236, 16, v110
    v_cndmask_b32 v118, v118, v236, vcc
    v_and_b32 v110, s52, v110
    v_xor_b32 v119, 0x80000000, v111
    v_lshlrev_b32 v236, 16, v111
    v_cndmask_b32 v119, v119, v236, vcc
    v_and_b32 v111, s52, v111
    s_mov_b64 s[80:81], s[68:69]
    s_mov_b64 s[82:83], s[70:71]
    s_cmp_ge_u32 s3, 2
    s_cselect_b32 s52, -1008, 0
    s_cmp_eq_u32 s12, 0
    s_cselect_b32 s52, s52, s12
    s_lshl_b32 s53, s3, 9
    s_add_u32 s73, s52, s53
    s_cmp_eq_u32 s12, 0
    s_cselect_b32 s54, 1, 0
    s_lshr_b32 s55, s3, 1
    s_and_b32 s52, s54, s55
    s_andn2_b32 s53, s54, s55
    v_and_b32 v233, 1, v2
    v_cvt_f32_u32 v233, v233
    v_mul_f32 v233, 0x3e800000, v233
    s_cmp_eq_u32 s12, 0
    s_cselect_b32 s54, 0, 0xbe800000
    v_add_f32 v235, s54, v233
    v_mov_b32 v238, 0x3e800000
    v_lshlrev_b32 v236, 2, v3
    v_cvt_f32_u32 v236, v236
    s_cmp_lg_u32 s52, 0
    s_cselect_b64 s[68:69], -1, 0
    s_cmp_lg_u32 s53, 0
    s_cselect_b64 s[70:71], -1, 0
    v_cndmask_b32 v233, v233, v238, s[68:69]
    v_cndmask_b32 v235, v235, v238, s[70:71]
    v_lshrrev_b32 v232, 1, v2
    v_lshl_add_u32 v232, v232, 5, s73
    v_add_u32 v232, 256, v232
    v_cvt_f32_u32 v232, v232
    v_mul_f32 v232, 0x3a000000, v232
    v_cndmask_b32 v234, v232, 0, s[70:71]
    v_cndmask_b32 v232, v232, 0, s[68:69]
    v_mov_b32 v237, v233
    v_fma_f32 v237, v232, v236, v237
    v_fma_f32 v239, v234, v236, v235
    v_fmamk_f32 v240, v232, 0.0, v237
    v_fmamk_f32 v241, v234, 0.0, v239
    v_fmamk_f32 v242, v232, 1.0, v237
    v_fmamk_f32 v243, v234, 1.0, v239
    v_fmamk_f32 v244, v232, 2.0, v237
    v_fmamk_f32 v245, v234, 2.0, v239
    v_fmamk_f32 v246, v232, 3.0, v237
    v_fmamk_f32 v247, v234, 3.0, v239
    v_cos_f32 v240, v240
    v_cos_f32 v241, v241
    v_cos_f32 v242, v242
    v_cos_f32 v243, v243
    v_cos_f32 v244, v244
    v_cos_f32 v245, v245
    v_cos_f32 v246, v246
    v_cos_f32 v247, v247
    v_cvt_pk_bf16_f32 v216, v240, v241
    v_cvt_pk_bf16_f32 v217, v242, v243
    v_cvt_pk_bf16_f32 v218, v244, v245
    v_cvt_pk_bf16_f32 v219, v246, v247
    v_fmamk_f32 v240, v232, 16.0, v237
    v_fmamk_f32 v241, v234, 16.0, v239
    v_fmamk_f32 v242, v232, 17.0, v237
    v_fmamk_f32 v243, v234, 17.0, v239
    v_fmamk_f32 v244, v232, 18.0, v237
    v_fmamk_f32 v245, v234, 18.0, v239
    v_fmamk_f32 v246, v232, 19.0, v237
    v_fmamk_f32 v247, v234, 19.0, v239
    v_cos_f32 v240, v240
    v_cos_f32 v241, v241
    v_cos_f32 v242, v242
    v_cos_f32 v243, v243
    v_cos_f32 v244, v244
    v_cos_f32 v245, v245
    v_cos_f32 v246, v246
    v_cos_f32 v247, v247
    v_cvt_pk_bf16_f32 v220, v240, v241
    v_cvt_pk_bf16_f32 v221, v242, v243
    v_cvt_pk_bf16_f32 v222, v244, v245
    v_cvt_pk_bf16_f32 v223, v246, v247
    v_fmamk_f32 v240, v232, 32.0, v237
    v_fmamk_f32 v241, v234, 32.0, v239
    v_fmamk_f32 v242, v232, 33.0, v237
    v_fmamk_f32 v243, v234, 33.0, v239
    v_fmamk_f32 v244, v232, 34.0, v237
    v_fmamk_f32 v245, v234, 34.0, v239
    v_fmamk_f32 v246, v232, 35.0, v237
    v_fmamk_f32 v247, v234, 35.0, v239
    v_cos_f32 v240, v240
    v_cos_f32 v241, v241
    v_cos_f32 v242, v242
    v_cos_f32 v243, v243
    v_cos_f32 v244, v244
    v_cos_f32 v245, v245
    v_cos_f32 v246, v246
    v_cos_f32 v247, v247
    v_cvt_pk_bf16_f32 v224, v240, v241
    v_cvt_pk_bf16_f32 v225, v242, v243
    v_cvt_pk_bf16_f32 v226, v244, v245
    v_cvt_pk_bf16_f32 v227, v246, v247
    v_fmamk_f32 v240, v232, 48.0, v237
    v_fmamk_f32 v241, v234, 48.0, v239
    v_fmamk_f32 v242, v232, 49.0, v237
    v_fmamk_f32 v243, v234, 49.0, v239
    v_fmamk_f32 v244, v232, 50.0, v237
    v_fmamk_f32 v245, v234, 50.0, v239
    v_fmamk_f32 v246, v232, 51.0, v237
    v_fmamk_f32 v247, v234, 51.0, v239
    v_cos_f32 v240, v240
    v_cos_f32 v241, v241
    v_cos_f32 v242, v242
    v_cos_f32 v243, v243
    v_cos_f32 v244, v244
    v_cos_f32 v245, v245
    v_cos_f32 v246, v246
    v_cos_f32 v247, v247
    v_cvt_pk_bf16_f32 v228, v240, v241
    v_cvt_pk_bf16_f32 v229, v242, v243
    v_cvt_pk_bf16_f32 v230, v244, v245
    v_cvt_pk_bf16_f32 v231, v246, v247
    s_mov_b64 s[68:69], s[80:81]
    s_mov_b64 s[70:71], s[82:83]
    s_cmp_lt_u32 s2, 128
    s_cbranch_scc1 adaLN_cond__spectral_fnet__geglu_ffn__prompt_kernel_sl60
    v_lshrrev_b32 v232, 2, v2
    v_lshl_add_u32 v232, v3, 3, v232
    v_mul_u32_u24 v232, 160, v232
    v_add_u32 v232, s75, v232
    v_and_b32 v233, 3, v2
    v_lshl_add_u32 v234, v233, 3, v232
    v_lshl_add_u32 v233, v233, 4, v232
    s_and_b32 s52, s74, 7
    s_mul_i32 s52, s52, 48
    s_lshr_b32 s53, s74, 3
    s_add_u32 s52, s52, s53
    s_mul_i32 s52, s52, 5120
    s_add_u32 s84, s52, 7340032
    s_add_u32 s85, s84, 4096
    ds_read_b64_tr_b16 a[216:217], v233 offset:0
    ds_read_b64_tr_b16 a[218:219], v233 offset:640
    ds_read_b64_tr_b16 a[220:221], v233 offset:8
    ds_read_b64_tr_b16 a[222:223], v233 offset:648
    ds_read_b64_tr_b16 a[224:225], v233 offset:64
    ds_read_b64_tr_b16 a[226:227], v233 offset:704
    ds_read_b64_tr_b16 a[228:229], v233 offset:72
    ds_read_b64_tr_b16 a[230:231], v233 offset:712
    ds_read_b64_tr_b16 a[232:233], v234 offset:128
    ds_read_b64_tr_b16 a[234:235], v234 offset:768
    s_waitcnt lgkmcnt(0)
adaLN_cond__spectral_fnet__geglu_ffn__prompt_kernel_sl60:
    s_add_u32 s58, s57, 393216
    s_add_u32 m0, s56, 49152
    s_nop 0
    buffer_load_dwordx4 v4, s[28:31], s58 offen lds
    s_add_u32 m0, m0, 1024
    s_nop 0
    buffer_load_dwordx4 v5, s[28:31], s58 offen lds
    s_add_u32 m0, m0, 1024
    s_nop 0
    buffer_load_dwordx4 v6, s[32:35], s58 offen lds
    s_add_u32 m0, m0, 1024
    s_nop 0
    buffer_load_dwordx4 v7, s[32:35], s58 offen lds
    s_add_u32 s58, s57, 405504
    s_add_u32 m0, s56, 61440
    s_nop 0
    buffer_load_dwordx4 v4, s[28:31], s58 offen lds
    s_add_u32 m0, m0, 1024
    s_nop 0
    buffer_load_dwordx4 v5, s[28:31], s58 offen lds
    s_add_u32 m0, m0, 1024
    s_nop 0
    buffer_load_dwordx4 v6, s[32:35], s58 offen lds
    s_add_u32 m0, m0, 1024
    s_nop 0
    buffer_load_dwordx4 v7, s[32:35], s58 offen lds
    s_waitcnt vmcnt(16)
    s_waitcnt lgkmcnt(0)
    s_barrier
    s_add_u32 s58, s57, 417792
    s_add_u32 m0, s56, 73728
    s_nop 0
    buffer_load_dwordx4 v4, s[28:31], s58 offen lds
    s_add_u32 m0, m0, 1024
    s_nop 0
    buffer_load_dwordx4 v5, s[28:31], s58 offen lds
    s_add_u32 m0, m0, 1024
    s_nop 0
    buffer_load_dwordx4 v6, s[32:35], s58 offen lds
    s_add_u32 m0, m0, 1024
    s_nop 0
    buffer_load_dwordx4 v7, s[32:35], s58 offen lds
    s_add_u32 s58, s57, 430080
    s_add_u32 m0, s56, 86016
    s_nop 0
    buffer_load_dwordx4 v4, s[28:31], s58 offen lds
    s_add_u32 m0, m0, 1024
    s_nop 0
    buffer_load_dwordx4 v5, s[28:31], s58 offen lds
    s_add_u32 m0, m0, 1024
    s_nop 0
    buffer_load_dwordx4 v6, s[32:35], s58 offen lds
    s_add_u32 m0, m0, 1024
    s_nop 0
    buffer_load_dwordx4 v7, s[32:35], s58 offen lds
    s_cmp_lg_u32 s3, 1
    s_cbranch_scc1 adaLN_cond__spectral_fnet__geglu_ffn__prompt_kernel_w164
    s_mov_b32 s52, 0
adaLN_cond__spectral_fnet__geglu_ffn__prompt_kernel_p65:
    buffer_load_dword v240, v254, s[16:19], s63 offen sc1
    buffer_load_dwordx2 v[242:243], v255, s[16:19], s63 offen sc1
    s_waitcnt vmcnt(0)
    s_add_u32 s52, s52, 1
    s_cmp_gt_u32 s52, 0x400000
    s_cbranch_scc1 adaLN_cond__spectral_fnet__geglu_ffn__prompt_kernel_x66
    v_xor_b32 v240, s14, v240
    v_xor_b32 v241, s14, v242
    v_or_b32 v240, v240, v241
    v_cmp_ne_u32 vcc, 0, v240
    s_nop 0
    s_cbranch_vccnz adaLN_cond__spectral_fnet__geglu_ffn__prompt_kernel_p65
adaLN_cond__spectral_fnet__geglu_ffn__prompt_kernel_x66:
    v_cmp_ne_u32 vcc, s59, v243
    s_nop 0
    s_and_b32 s52, vcc_lo, 0xffff
    s_cmp_eq_u32 s52, 0
    s_cselect_b32 s15, 1, 0
    v_mov_b32 v232, s15
    v_mov_b32 v233, 38528
    ds_write_b32 v233, v232
    s_waitcnt lgkmcnt(0)
    s_mov_b32 m0, 20480
    s_mov_b32 s54, 6299648
    buffer_load_dwordx4 v18, s[16:19], s54 offen offset:0 sc1 lds
    buffer_load_dwordx4 v18, s[16:19], s54 offen offset:1024 sc1 lds
    buffer_load_dwordx4 v18, s[16:19], s54 offen offset:2048 sc1 lds
    buffer_load_dwordx4 v18, s[16:19], s54 offen offset:3072 sc1 lds
adaLN_cond__spectral_fnet__geglu_ffn__prompt_kernel_hop4:
    s_cbranch_execz adaLN_cond__spectral_fnet__geglu_ffn__prompt_kernel_hop8
    s_mov_b32 m0, 24576
    s_mov_b32 s54, 6303744
    buffer_load_dwordx4 v18, s[16:19], s54 offen offset:0 sc1 lds
    buffer_load_dwordx4 v18, s[16:19], s54 offen offset:1024 sc1 lds
    buffer_load_dwordx4 v18, s[16:19], s54 offen offset:2048 sc1 lds
    buffer_load_dwordx4 v18, s[16:19], s54 offen offset:3072 sc1 lds
    s_mov_b32 m0, 28672
    s_mov_b32 s54, 6316032
    buffer_load_dwordx4 v18, s[16:19], s54 offen offset:0 sc1 lds
    buffer_load_dwordx4 v18, s[16:19], s54 offen offset:1024 sc1 lds
    buffer_load_dwordx4 v18, s[16:19], s54 offen offset:2048 sc1 lds
    buffer_load_dwordx4 v18, s[16:19], s54 offen offset:3072 sc1 lds
    s_mov_b32 m0, 32768
    s_mov_b32 s54, 6320128
    buffer_load_dwordx4 v18, s[16:19], s54 offen offset:0 sc1 lds
    buffer_load_dwordx4 v18, s[16:19], s54 offen offset:1024 sc1 lds
    buffer_load_dwordx4 v18, s[16:19], s54 offen offset:2048 sc1 lds
    buffer_load_dwordx4 v18, s[16:19], s54 offen offset:3072 sc1 lds
    s_cmp_lg_u32 s2, 0
    s_cbranch_scc1 adaLN_cond__spectral_fnet__geglu_ffn__prompt_kernel_n67
    s_mov_b32 s52, 0
adaLN_cond__spectral_fnet__geglu_ffn__prompt_kernel_p68:
    buffer_load_dword v240, v198, s[16:19], s63 offen sc1
    buffer_load_dword v241, v198, s[16:19], s63 offen offset:256 sc1
    buffer_load_dword v242, v199, s[16:19], s63 offen sc1
    buffer_load_dword v243, v255, s[16:19], s63 offen offset:512 sc1
    s_waitcnt vmcnt(0)
    s_add_u32 s52, s52, 1
    s_cmp_gt_u32 s52, 0x400000
    s_cbranch_scc1 adaLN_cond__spectral_fnet__geglu_ffn__prompt_kernel_x69
    v_xor_b32 v240, s14, v240
    v_xor_b32 v241, s14, v241
    v_xor_b32 v242, s14, v242
    v_xor_b32 v243, s14, v243
    v_cmp_gt_u32 vcc, 16, v1
    s_nop 1
    v_cndmask_b32 v243, v243, 0, vcc
    v_cmp_lt_u32 vcc, 7, v2
    s_nop 1
    v_cndmask_b32 v243, v243, 0, vcc
    v_or3_b32 v240, v240, v241, v242
    v_or_b32 v240, v240, v243
    v_cmp_ne_u32 vcc, 0, v240
    s_nop 0
    s_cbranch_vccnz adaLN_cond__spectral_fnet__geglu_ffn__prompt_kernel_p68
adaLN_cond__spectral_fnet__geglu_ffn__prompt_kernel_x69:
    v_mov_b32 v235, 0
    s_mov_b32 s53, 16777216
    s_mov_b64 exec, 1
    v_mov_b32 v234, s14
    buffer_store_dword v234, v235, s[16:19], s53 offen sc1
    s_mov_b64 exec, -1
adaLN_cond__spectral_fnet__geglu_ffn__prompt_kernel_n67:
adaLN_cond__spectral_fnet__geglu_ffn__prompt_kernel_w164:
    s_barrier
    v_lshlrev_b32 v246, 2, v2
    s_add_u32 s58, s57, 786432
    s_add_u32 m0, s56, 98304
    s_nop 0
    buffer_load_dwordx4 v4, s[28:31], s58 offen lds
    s_add_u32 m0, m0, 1024
    s_nop 0
    buffer_load_dwordx4 v5, s[28:31], s58 offen lds
    s_add_u32 m0, m0, 1024
    s_nop 0
    buffer_load_dwordx4 v6, s[32:35], s58 offen lds
    s_add_u32 m0, m0, 1024
    s_nop 0
    buffer_load_dwordx4 v7, s[32:35], s58 offen lds
    s_add_u32 s58, s57, 798720
    s_add_u32 m0, s56, 110592
    s_nop 0
    buffer_load_dwordx4 v4, s[28:31], s58 offen lds
    s_add_u32 m0, m0, 1024
    s_nop 0
    buffer_load_dwordx4 v5, s[28:31], s58 offen lds
    s_add_u32 m0, m0, 1024
    s_nop 0
    buffer_load_dwordx4 v6, s[32:35], s58 offen lds
    s_add_u32 m0, m0, 1024
    s_nop 0
    buffer_load_dwordx4 v7, s[32:35], s58 offen lds
    v_mov_b32 v180, 0
    v_mov_b32 v181, 0
    v_mov_b32 v182, 0
    v_mov_b32 v183, 0
    v_mov_b32 v184, 0
    v_mov_b32 v185, 0
    v_mov_b32 v186, 0
    v_mov_b32 v187, 0
    v_mov_b32 v188, 0
    v_mov_b32 v189, 0
    v_mov_b32 v190, 0
    v_mov_b32 v191, 0
    v_mov_b32 v192, 0
    v_mov_b32 v193, 0
    v_mov_b32 v194, 0
    v_mov_b32 v195, 0
    v_mov_b32 v196, 0
    v_mov_b32 v197, 0
    v_mov_b32 v198, 0
    v_mov_b32 v199, 0
    v_lshlrev_b32 v236, 1, v2
    v_lshl_add_u32 v250, v3, 8, v236
    v_lshl_add_u32 v251, v3, 6, v236
    v_add_u32 v250, s72, v250
    v_add_u32 v251, s72, v251
    ds_read_u16_d16_hi v180, v250 offset:0
    ds_read_u16_d16_hi v181, v250 offset:32
    ds_read_u16_d16_hi v182, v250 offset:64
    ds_read_u16_d16_hi v183, v250 offset:96
    ds_read_u16_d16_hi v184, v250 offset:128
    ds_read_u16_d16_hi v185, v250 offset:160
    ds_read_u16_d16_hi v186, v250 offset:192
    ds_read_u16_d16_hi v187, v250 offset:224
    ds_read_u16_d16_hi v188, v251 offset:1024
    ds_read_u16_d16_hi v189, v251 offset:1056
    ds_read_u16_d16_hi v190, v250 offset:1280
    ds_read_u16_d16_hi v191, v250 offset:1312
    ds_read_u16_d16_hi v192, v250 offset:1344
    ds_read_u16_d16_hi v193, v250 offset:1376
    ds_read_u16_d16_hi v194, v250 offset:1408
    ds_read_u16_d16_hi v195, v250 offset:1440
    ds_read_u16_d16_hi v196, v250 offset:1472
    ds_read_u16_d16_hi v197, v250 offset:1504
    ds_read_u16_d16_hi v198, v251 offset:2304
    ds_read_u16_d16_hi v199, v251 offset:2336
    ds_read_b64_tr_b16 a[0:1], v12 offset:0
    ds_read_b64_tr_b16 a[2:3], v12 offset:768
    ds_read_b64_tr_b16 a[4:5], v12 offset:6144
    ds_read_b64_tr_b16 a[6:7], v12 offset:6912
    ds_read_b64_tr_b16 a[8:9], v13 offset:0
    ds_read_b64_tr_b16 a[10:11], v13 offset:768
    ds_read_b64_tr_b16 a[12:13], v12 offset:12288
    ds_read_b64_tr_b16 a[14:15], v12 offset:13056
    ds_read_b64_tr_b16 a[16:17], v12 offset:18432
    ds_read_b64_tr_b16 a[18:19], v12 offset:19200
    ds_read_b64_tr_b16 a[20:21], v13 offset:12288
    ds_read_b64_tr_b16 a[22:23], v13 offset:13056
    v_lshrrev_b32 v236, 2, v2
    v_lshl_add_u32 v236, v3, 3, v236
    v_mul_u32_u24 v236, 80, v236
    v_and_b32 v237, 3, v2
    v_lshl_add_u32 v248, v237, 3, v236
    s_mul_i32 s52, s3, 2560
    v_mul_u32_u24 v249, 320, v3
    v_lshl_add_u32 v249, v2, 2, v249
    v_add_u32 v249, s52, v249
    v_add_u32 v246, 37888, v246
    s_lshl_b32 s62, s12, 4
    s_add_u32 s62, s62, s13
    s_mul_i32 s62, s62, 10240
    s_add_u32 s62, s62, 3145728
    s_waitcnt lgkmcnt(0)
    s_waitcnt vmcnt(16)
    s_barrier
    ds_read_b64_tr_b16 v[20:21], v248 offset:0
    ds_read_b64_tr_b16 v[22:23], v248 offset:320
    ds_read_b64_tr_b16 v[24:25], v248 offset:32
    ds_read_b64_tr_b16 v[26:27], v248 offset:352
    ds_read_b64_tr_b16 v[28:29], v248 offset:48
    ds_read_b64_tr_b16 v[30:31], v248 offset:368
    ds_read_b64_tr_b16 v[32:33], v248 offset:2560
    ds_read_b64_tr_b16 v[34:35], v248 offset:2880
    ds_read_b64_tr_b16 v[36:37], v248 offset:2592
    ds_read_b64_tr_b16 v[38:39], v248 offset:2912
    ds_read_b64_tr_b16 v[40:41], v248 offset:2608
    ds_read_b64_tr_b16 v[42:43], v248 offset:2928
    s_cmp_lt_u32 s2, 128
    s_cbranch_scc1 adaLN_cond__spectral_fnet__geglu_ffn__prompt_kernel_sh70
    buffer_store_dwordx4 a[216:219], v18, s[16:19], s84 offen offset:0 sc1
    buffer_store_dwordx4 a[220:223], v18, s[16:19], s84 offen offset:1024 sc1
    buffer_store_dwordx4 a[224:227], v18, s[16:19], s84 offen offset:2048 sc1
    buffer_store_dwordx4 a[228:231], v18, s[16:19], s84 offen offset:3072 sc1
    buffer_store_dwordx4 a[232:235], v18, s[16:19], s85 offen offset:0 sc1
adaLN_cond__spectral_fnet__geglu_ffn__prompt_kernel_sh70:
    s_cmp_eq_u32 s73, 0
    s_cselect_b32 s52, 16, 0
    v_cmp_gt_u32 s[54:55], s52, v1
    v_mov_b32 v238, 0x45000000
    s_waitcnt lgkmcnt(10)
    v_mfma_f32_16x16x32_bf16 v[68:71], v[200:203], v[20:23], 0
    ds_read_b64_tr_b16 v[44:45], v248 offset:5120
    ds_read_b64_tr_b16 v[46:47], v248 offset:5440
    v_mfma_f32_16x16x32_bf16 v[80:83], v[216:219], v[20:23], 0
    ds_read_b64_tr_b16 v[48:49], v248 offset:5152
    ds_read_b64_tr_b16 v[50:51], v248 offset:5472
    s_waitcnt lgkmcnt(12)
    v_mfma_f32_16x16x32_bf16 v[72:75], v[200:203], v[24:27], 0
    ds_read_b64_tr_b16 v[52:53], v248 offset:5168
    ds_read_b64_tr_b16 v[54:55], v248 offset:5488
    v_mfma_f32_16x16x32_bf16 v[84:87], v[216:219], v[24:27], 0
    ds_read2_b32 v[92:93], v246 offset0:0 offset1:40
    ds_read2_b32 v[98:99], v246 offset0:80 offset1:120
    s_waitcnt lgkmcnt(14)
    v_mfma_f32_16x16x32_bf16 v[76:79], v[200:203], v[28:31], 0
    ds_read2_b32 v[94:95], v246 offset0:16 offset1:56
    ds_read2_b32 v[100:101], v246 offset0:96 offset1:136
    v_mfma_f32_16x16x32_bf16 v[88:91], v[216:219], v[28:31], 0
    ds_read2_b32 v[96:97], v246 offset0:24 offset1:64
    ds_read2_b32 v[102:103], v246 offset0:104 offset1:144
    s_waitcnt lgkmcnt(15)
    v_mfma_f32_16x16x32_bf16 v[68:71], v[204:207], v[32:35], v[68:71]
    ds_read_b64_tr_b16 v[56:57], v248 offset:7680
    ds_read_b64_tr_b16 v[58:59], v248 offset:8000
    v_mfma_f32_16x16x32_bf16 v[80:83], v[220:223], v[32:35], v[80:83]
    ds_read_b64_tr_b16 v[60:61], v248 offset:7712
    ds_read_b64_tr_b16 v[62:63], v248 offset:8032
    s_waitcnt lgkmcnt(15)
    v_mfma_f32_16x16x32_bf16 v[72:75], v[204:207], v[36:39], v[72:75]
    ds_read_b64_tr_b16 v[64:65], v248 offset:7728
    ds_read_b64_tr_b16 v[66:67], v248 offset:8048
    v_mfma_f32_16x16x32_bf16 v[84:87], v[220:223], v[36:39], v[84:87]
    s_waitcnt lgkmcnt(11)
    v_add_f32 v92, v92, v93
    s_waitcnt lgkmcnt(10)
    v_add_f32 v98, v98, v99
    v_mfma_f32_16x16x32_bf16 v[76:79], v[204:207], v[40:43], v[76:79]
    s_waitcnt lgkmcnt(9)
    v_add_f32 v94, v94, v95
    s_waitcnt lgkmcnt(8)
    v_add_f32 v100, v100, v101
    v_mfma_f32_16x16x32_bf16 v[88:91], v[220:223], v[40:43], v[88:91]
    s_waitcnt lgkmcnt(7)
    v_add_f32 v96, v96, v97
    s_waitcnt lgkmcnt(6)
    v_add_f32 v102, v102, v103
    v_mfma_f32_16x16x32_bf16 v[68:71], v[208:211], v[44:47], v[68:71]
    v_cvt_pk_bf16_f32 v92, v92, v98
    v_cvt_pk_bf16_f32 v94, v94, v100
    v_mfma_f32_16x16x32_bf16 v[80:83], v[224:227], v[44:47], v[80:83]
    v_cvt_pk_bf16_f32 v96, v96, v102
    v_and_b32 v98, 0xffff0000, v92
    v_mfma_f32_16x16x32_bf16 v[72:75], v[208:211], v[48:51], v[72:75]
    v_and_b32 v100, 0xffff0000, v94
    v_and_b32 v102, 0xffff0000, v96
    v_mfma_f32_16x16x32_bf16 v[84:87], v[224:227], v[48:51], v[84:87]
    v_add_f32 v98, 1.0, v98
    v_add_f32 v100, 1.0, v100
    v_mfma_f32_16x16x32_bf16 v[76:79], v[208:211], v[52:55], v[76:79]
    v_add_f32 v102, 1.0, v102
    v_cvt_pk_bf16_f32 v98, v98, v98
    v_mfma_f32_16x16x32_bf16 v[88:91], v[224:227], v[52:55], v[88:91]
    v_cvt_pk_bf16_f32 v100, v100, v100
    v_cvt_pk_bf16_f32 v102, v102, v102
    s_waitcnt lgkmcnt(4)
    v_mfma_f32_16x16x32_bf16 v[68:71], v[212:215], v[56:59], v[68:71]
    v_and_b32 v98, 0xffff0000, v98
    v_and_b32 v100, 0xffff0000, v100
    v_mfma_f32_16x16x32_bf16 v[80:83], v[228:231], v[56:59], v[80:83]
    v_and_b32 v102, 0xffff0000, v102
    s_waitcnt lgkmcnt(2)
    v_mfma_f32_16x16x32_bf16 v[72:75], v[212:215], v[60:63], v[72:75]
    v_mfma_f32_16x16x32_bf16 v[84:87], v[228:231], v[60:63], v[84:87]
    s_waitcnt lgkmcnt(0)
    v_mfma_f32_16x16x32_bf16 v[76:79], v[212:215], v[64:67], v[76:79]
    v_mfma_f32_16x16x32_bf16 v[88:91], v[228:231], v[64:67], v[88:91]
    v_lshlrev_b32 v92, 16, v92
    v_cndmask_b32 v92, 0, v92, s[54:55]
    v_lshlrev_b32 v94, 16, v94
    v_cndmask_b32 v94, 0, v94, s[54:55]
    v_lshlrev_b32 v96, 16, v96
    v_cndmask_b32 v96, 0, v96, s[54:55]
    v_pk_mul_f32 v[68:69], v[68:69], v[98:99] op_sel_hi:[1,0]
    v_pk_mul_f32 v[70:71], v[70:71], v[98:99] op_sel_hi:[1,0]
    v_fmac_f32 v68, v238, v92
    v_cvt_pk_bf16_f32 v68, v68, v69
    ds_write_b32 v249, v68 offset:10240
    v_cvt_pk_bf16_f32 v70, v70, v71
    ds_write_b32 v249, v70 offset:10400
    v_pk_mul_f32 v[80:81], v[80:81], v[98:99] op_sel_hi:[1,0]
    v_pk_mul_f32 v[82:83], v[82:83], v[98:99] op_sel_hi:[1,0]
    v_cvt_pk_bf16_f32 v80, v80, v81
    ds_write_b32 v249, v80 offset:11520
    v_cvt_pk_bf16_f32 v82, v82, v83
    ds_write_b32 v249, v82 offset:11680
    v_pk_mul_f32 v[72:73], v[72:73], v[100:101] op_sel_hi:[1,0]
    v_pk_mul_f32 v[74:75], v[74:75], v[100:101] op_sel_hi:[1,0]
    v_fmac_f32 v72, v238, v94
    v_cvt_pk_bf16_f32 v72, v72, v73
    ds_write_b32 v249, v72 offset:10304
    v_cvt_pk_bf16_f32 v74, v74, v75
    ds_write_b32 v249, v74 offset:10464
    v_pk_mul_f32 v[84:85], v[84:85], v[100:101] op_sel_hi:[1,0]
    v_pk_mul_f32 v[86:87], v[86:87], v[100:101] op_sel_hi:[1,0]
    v_cvt_pk_bf16_f32 v84, v84, v85
    ds_write_b32 v249, v84 offset:11584
    v_cvt_pk_bf16_f32 v86, v86, v87
    ds_write_b32 v249, v86 offset:11744
    v_pk_mul_f32 v[76:77], v[76:77], v[102:103] op_sel_hi:[1,0]
    v_pk_mul_f32 v[78:79], v[78:79], v[102:103] op_sel_hi:[1,0]
    v_fmac_f32 v76, v238, v96
    v_cvt_pk_bf16_f32 v76, v76, v77
    ds_write_b32 v249, v76 offset:10336
    v_cvt_pk_bf16_f32 v78, v78, v79
    ds_write_b32 v249, v78 offset:10496
    v_pk_mul_f32 v[88:89], v[88:89], v[102:103] op_sel_hi:[1,0]
    v_pk_mul_f32 v[90:91], v[90:91], v[102:103] op_sel_hi:[1,0]
    v_cvt_pk_bf16_f32 v88, v88, v89
    ds_write_b32 v249, v88 offset:11616
    v_cvt_pk_bf16_f32 v90, v90, v91
    ds_write_b32 v249, v90 offset:11776
    s_add_u32 s58, s57, 811008
    s_add_u32 m0, s56, 0
    s_nop 0
    buffer_load_dwordx4 v4, s[28:31], s58 offen lds
    s_add_u32 m0, m0, 1024
    s_nop 0
    buffer_load_dwordx4 v5, s[28:31], s58 offen lds
    s_add_u32 m0, m0, 1024
    s_nop 0
    buffer_load_dwordx4 v6, s[32:35], s58 offen lds
    s_add_u32 m0, m0, 1024
    s_nop 0
    buffer_load_dwordx4 v7, s[32:35], s58 offen lds
    ds_read_b64_tr_b16 a[24:25], v12 offset:24576
    ds_read_b64_tr_b16 a[26:27], v12 offset:25344
    ds_read_b64_tr_b16 a[28:29], v12 offset:30720
    ds_read_b64_tr_b16 a[30:31], v12 offset:31488
    ds_read_b64_tr_b16 a[32:33], v13 offset:24576
    ds_read_b64_tr_b16 a[34:35], v13 offset:25344
    ds_read_b64_tr_b16 a[36:37], v12 offset:36864
    ds_read_b64_tr_b16 a[38:39], v12 offset:37632
    ds_read_b64_tr_b16 a[40:41], v12 offset:43008
    ds_read_b64_tr_b16 a[42:43], v12 offset:43776
    ds_read_b64_tr_b16 a[44:45], v13 offset:36864
    ds_read_b64_tr_b16 a[46:47], v13 offset:37632
    ds_read_b64_tr_b16 a[48:49], v14 offset:0
    ds_read_b64_tr_b16 a[50:51], v14 offset:768
    ds_read_b64_tr_b16 a[52:53], v14 offset:6144
    ds_read_b64_tr_b16 a[54:55], v14 offset:6912
    ds_read_b64_tr_b16 a[56:57], v15 offset:0
    ds_read_b64_tr_b16 a[58:59], v15 offset:768
    ds_read_b64_tr_b16 a[60:61], v14 offset:12288
    ds_read_b64_tr_b16 a[62:63], v14 offset:13056
    ds_read_b64_tr_b16 a[64:65], v14 offset:18432
    ds_read_b64_tr_b16 a[66:67], v14 offset:19200
    ds_read_b64_tr_b16 a[68:69], v15 offset:12288
    ds_read_b64_tr_b16 a[70:71], v15 offset:13056
    s_waitcnt vmcnt(12)
    s_waitcnt lgkmcnt(15)
    s_barrier
    v_mov_b32 v233, 38528
    ds_read_b32 v247, v233
    s_waitcnt lgkmcnt(0)
    v_readfirstlane_b32 s15, v247
    v_lshlrev_b32 v234, 2, v2
    v_lshl_add_u32 v235, v3, 7, v234
    v_lshl_add_u32 v234, v3, 9, v234
    v_add_u32 v236, 20480, v234
    v_add_u32 v237, 22528, v235
    ds_read2_b32 v[60:61], v236 offset0:0 offset1:16
    ds_read2_b32 v[62:63], v236 offset0:32 offset1:48
    ds_read2_b32 v[64:65], v236 offset0:64 offset1:80
    ds_read2_b32 v[66:67], v236 offset0:96 offset1:112
    ds_read2_b32 v[68:69], v237 offset0:0 offset1:16
    v_add_u32 v236, 23040, v234
    v_add_u32 v237, 25088, v235
    ds_read2_b32 v[70:71], v236 offset0:0 offset1:16
    ds_read2_b32 v[72:73], v236 offset0:32 offset1:48
    ds_read2_b32 v[74:75], v236 offset0:64 offset1:80
    ds_read2_b32 v[76:77], v236 offset0:96 offset1:112
    ds_read2_b32 v[78:79], v237 offset0:0 offset1:16
    v_add_u32 v236, 25600, v234
    v_add_u32 v237, 27648, v235
    ds_read2_b32 v[80:81], v236 offset0:0 offset1:16
    ds_read2_b32 v[82:83], v236 offset0:32 offset1:48
    ds_read2_b32 v[84:85], v236 offset0:64 offset1:80
    ds_read2_b32 v[86:87], v236 offset0:96 offset1:112
    ds_read2_b32 v[88:89], v237 offset0:0 offset1:16
    v_add_u32 v236, 28672, v234
    v_add_u32 v237, 30720, v235
    ds_read2_b32 v[200:201], v236 offset0:0 offset1:16
    ds_read2_b32 v[202:203], v236 offset0:32 offset1:48
    ds_read2_b32 v[204:205], v236 offset0:64 offset1:80
    ds_read2_b32 v[206:207], v236 offset0:96 offset1:112
    ds_read2_b32 v[208:209], v237 offset0:0 offset1:16
    v_add_u32 v236, 31232, v234
    v_add_u32 v237, 33280, v235
    ds_read2_b32 v[210:211], v236 offset0:0 offset1:16
    ds_read2_b32 v[212:213], v236 offset0:32 offset1:48
    ds_read2_b32 v[214:215], v236 offset0:64 offset1:80
    ds_read2_b32 v[216:217], v236 offset0:96 offset1:112
    ds_read2_b32 v[218:219], v237 offset0:0 offset1:16
    v_add_u32 v236, 33792, v234
    v_add_u32 v237, 35840, v235
    ds_read2_b32 v[220:221], v236 offset0:0 offset1:16
    ds_read2_b32 v[222:223], v236 offset0:32 offset1:48
    ds_read2_b32 v[224:225], v236 offset0:64 offset1:80
    ds_read2_b32 v[226:227], v236 offset0:96 offset1:112
    ds_read2_b32 v[228:229], v237 offset0:0 offset1:16
    s_waitcnt lgkmcnt(14)
    v_add_f32 v60, v60, v200
    v_add_f32 v61, v61, v201
    s_waitcnt lgkmcnt(13)
    v_add_f32 v62, v62, v202
    v_add_f32 v63, v63, v203
    s_waitcnt lgkmcnt(12)
    v_add_f32 v64, v64, v204
    v_add_f32 v65, v65, v205
    s_waitcnt lgkmcnt(11)
    v_add_f32 v66, v66, v206
    v_add_f32 v67, v67, v207
    s_waitcnt lgkmcnt(10)
    v_add_f32 v68, v68, v208
    v_add_f32 v69, v69, v209
    s_waitcnt lgkmcnt(9)
    v_add_f32 v70, v70, v210
    v_add_f32 v71, v71, v211
    s_waitcnt lgkmcnt(8)
    v_add_f32 v72, v72, v212
    v_add_f32 v73, v73, v213
    s_waitcnt lgkmcnt(7)
    v_add_f32 v74, v74, v214
    v_add_f32 v75, v75, v215
    s_waitcnt lgkmcnt(6)
    v_add_f32 v76, v76, v216
    v_add_f32 v77, v77, v217
    s_waitcnt lgkmcnt(5)
    v_add_f32 v78, v78, v218
    v_add_f32 v79, v79, v219
    s_waitcnt lgkmcnt(4)
    v_add_f32 v80, v80, v220
    v_add_f32 v81, v81, v221
    s_waitcnt lgkmcnt(3)
    v_add_f32 v82, v82, v222
    v_add_f32 v83, v83, v223
    s_waitcnt lgkmcnt(2)
    v_add_f32 v84, v84, v224
    v_add_f32 v85, v85, v225
    s_waitcnt lgkmcnt(1)
    v_add_f32 v86, v86, v226
    v_add_f32 v87, v87, v227
    s_waitcnt lgkmcnt(0)
    v_add_f32 v88, v88, v228
    v_add_f32 v89, v89, v229
    s_waitcnt vmcnt(4)
    s_barrier
    s_add_u32 s58, s57, 823296
    s_add_u32 m0, s56, 12288
    s_nop 0
    buffer_load_dwordx4 v4, s[28:31], s58 offen lds
    s_add_u32 m0, m0, 1024
    s_nop 0
    buffer_load_dwordx4 v5, s[28:31], s58 offen lds
    s_add_u32 m0, m0, 1024
    s_nop 0
    buffer_load_dwordx4 v6, s[32:35], s58 offen lds
    s_add_u32 m0, m0, 1024
    s_nop 0
    buffer_load_dwordx4 v7, s[32:35], s58 offen lds
    s_add_u32 s58, s57, 1179648
    s_add_u32 m0, s56, 24576
    s_nop 0
    buffer_load_dwordx4 v4, s[28:31], s58 offen lds
    s_add_u32 m0, m0, 1024
    s_nop 0
    buffer_load_dwordx4 v5, s[28:31], s58 offen lds
    s_add_u32 m0, m0, 1024
    s_nop 0
    buffer_load_dwordx4 v6, s[32:35], s58 offen lds
    s_add_u32 m0, m0, 1024
    s_nop 0
    buffer_load_dwordx4 v7, s[32:35], s58 offen lds
    ds_read_b64_tr_b16 a[96:97], v16 offset:0
    ds_read_b64_tr_b16 a[98:99], v16 offset:768
    ds_read_b64_tr_b16 a[100:101], v16 offset:6144
    ds_read_b64_tr_b16 a[102:103], v16 offset:6912
    ds_read_b64_tr_b16 a[104:105], v17 offset:0
    ds_read_b64_tr_b16 a[106:107], v17 offset:768
    ds_read_b64_tr_b16 a[108:109], v16 offset:12288
    ds_read_b64_tr_b16 a[110:111], v16 offset:13056
    ds_read_b64_tr_b16 a[112:113], v16 offset:18432
    ds_read_b64_tr_b16 a[114:115], v16 offset:19200
    ds_read_b64_tr_b16 a[116:117], v17 offset:12288
    ds_read_b64_tr_b16 a[118:119], v17 offset:13056
    ds_read_b64_tr_b16 a[72:73], v14 offset:24576
    ds_read_b64_tr_b16 a[74:75], v14 offset:25344
    ds_read_b64_tr_b16 a[76:77], v14 offset:30720
    ds_read_b64_tr_b16 a[78:79], v14 offset:31488
    ds_read_b64_tr_b16 a[80:81], v15 offset:24576
    ds_read_b64_tr_b16 a[82:83], v15 offset:25344
    ds_read_b64_tr_b16 a[84:85], v14 offset:36864
    ds_read_b64_tr_b16 a[86:87], v14 offset:37632
    ds_read_b64_tr_b16 a[88:89], v14 offset:43008
    ds_read_b64_tr_b16 a[90:91], v14 offset:43776
    ds_read_b64_tr_b16 a[92:93], v15 offset:36864
    ds_read_b64_tr_b16 a[94:95], v15 offset:37632
    v_cvt_pk_bf16_f32 v232, v60, v61
    v_cvt_pk_bf16_f32 v233, v62, v63
    v_cvt_pk_bf16_f32 v234, v64, v65
    v_cvt_pk_bf16_f32 v235, v66, v67
    v_cvt_pk_bf16_f32 v236, v68, v69
    v_lshlrev_b32 v200, 16, v232
    v_and_b32 v201, 0xffff0000, v232
    v_lshlrev_b32 v202, 16, v233
    v_and_b32 v203, 0xffff0000, v233
    v_lshlrev_b32 v204, 16, v234
    v_and_b32 v205, 0xffff0000, v234
    v_lshlrev_b32 v206, 16, v235
    v_and_b32 v207, 0xffff0000, v235
    v_lshlrev_b32 v208, 16, v236
    v_and_b32 v209, 0xffff0000, v236
    v_cvt_pk_bf16_f32 v232, v70, v71
    v_cvt_pk_bf16_f32 v233, v72, v73
    v_cvt_pk_bf16_f32 v234, v74, v75
    v_cvt_pk_bf16_f32 v235, v76, v77
    v_cvt_pk_bf16_f32 v236, v78, v79
    v_lshlrev_b32 v210, 16, v232
    v_and_b32 v211, 0xffff0000, v232
    v_lshlrev_b32 v212, 16, v233
    v_and_b32 v213, 0xffff0000, v233
    v_lshlrev_b32 v214, 16, v234
    v_and_b32 v215, 0xffff0000, v234
    v_lshlrev_b32 v216, 16, v235
    v_and_b32 v217, 0xffff0000, v235
    v_lshlrev_b32 v218, 16, v236
    v_and_b32 v219, 0xffff0000, v236
    v_cvt_pk_bf16_f32 v232, v80, v81
    v_cvt_pk_bf16_f32 v233, v82, v83
    v_cvt_pk_bf16_f32 v234, v84, v85
    v_cvt_pk_bf16_f32 v235, v86, v87
    v_cvt_pk_bf16_f32 v236, v88, v89
    v_lshlrev_b32 v220, 16, v232
    v_and_b32 v221, 0xffff0000, v232
    v_lshlrev_b32 v222, 16, v233
    v_and_b32 v223, 0xffff0000, v233
    v_lshlrev_b32 v224, 16, v234
    v_and_b32 v225, 0xffff0000, v234
    v_lshlrev_b32 v226, 16, v235
    v_and_b32 v227, 0xffff0000, v235
    v_lshlrev_b32 v228, 16, v236
    v_and_b32 v229, 0xffff0000, v236
    v_add_f32 v220, 1.0, v220
    v_add_f32 v221, 1.0, v221
    v_add_f32 v222, 1.0, v222
    v_add_f32 v223, 1.0, v223
    v_add_f32 v224, 1.0, v224
    v_add_f32 v225, 1.0, v225
    v_add_f32 v226, 1.0, v226
    v_add_f32 v227, 1.0, v227
    v_add_f32 v228, 1.0, v228
    v_add_f32 v229, 1.0, v229
    v_cvt_pk_bf16_f32 v232, v220, v221
    v_cvt_pk_bf16_f32 v233, v222, v223
    v_cvt_pk_bf16_f32 v234, v224, v225
    v_cvt_pk_bf16_f32 v235, v226, v227
    v_cvt_pk_bf16_f32 v236, v228, v229
    v_lshlrev_b32 v220, 16, v232
    v_and_b32 v221, 0xffff0000, v232
    v_lshlrev_b32 v222, 16, v233
    v_and_b32 v223, 0xffff0000, v233
    v_lshlrev_b32 v224, 16, v234
    v_and_b32 v225, 0xffff0000, v234
    v_lshlrev_b32 v226, 16, v235
    v_and_b32 v227, 0xffff0000, v235
    v_lshlrev_b32 v228, 16, v236
    v_and_b32 v229, 0xffff0000, v236
    s_mul_i32 s52, s3, 160
    s_add_u32 s52, s52, 0
    v_mul_u32_u24 v248, 2560, v3
    v_lshl_add_u32 v248, v2, 2, v248
    v_add_u32 v248, s52, v248
    v_add_u32 v249, 1280, v248
    s_lshl_b32 s74, s3, 1
    v_and_b32 v240, 7, v1
    v_xor_b32 v240, s74, v240
    v_lshlrev_b32 v240, 4, v240
    v_lshl_add_u32 v240, v1, 7, v240
    v_xor_b32 v241, 16, v240
    v_bfe_u32 v242, v1, 2, 3
    v_xor_b32 v242, s74, v242
    v_lshlrev_b32 v242, 4, v242
    v_lshrrev_b32 v243, 2, v1
    v_lshl_add_u32 v242, v243, 7, v242
    v_and_b32 v243, 3, v1
    v_lshl_add_u32 v242, v243, 2, v242
    v_xor_b32 v243, 16, v242
    s_lshr_b32 s62, s13, 1
    s_lshl_b32 s54, s12, 3
    s_add_u32 s62, s62, s54
    s_mul_i32 s62, s62, 20480
    s_and_b32 s54, s13, 1
    s_lshl_b32 s54, s54, 7
    s_add_u32 s62, s62, s54
    s_add_u32 s62, s62, 0
    v_lshrrev_b32 v232, 3, v1
    v_xor_b32 v245, v232, v1
    v_and_b32 v245, 7, v245
    v_lshlrev_b32 v245, 4, v245
    v_lshl_add_u32 v245, v232, 8, v245
    s_mul_i32 s75, s13, 3072
    s_mul_i32 s52, s3, 768
    s_add_u32 s75, s75, s52
    s_mul_i32 s66, s12, 393216
    s_mul_i32 s67, s12, 163840
    s_mov_b32 s20, s46
    s_and_b32 s21, s47, 0xffff
    s_mov_b32 s22, 2621440
    s_mov_b32 s23, 0x20000
    s_mul_i32 s76, s12, 163840
    s_mul_i32 s77, s3, 10240
    s_add_u32 s76, s76, s77
    s_add_u32 s76, s76, 0
    s_lshl_b32 s78, s12, 7
    s_lshl_b32 s52, s13, 3
    s_add_u32 s78, s78, s52
    s_add_u32 s78, s78, s74
    s_mul_i32 s78, s78, 1280
    s_add_u32 s78, s78, 3145728
    s_and_b32 s79, s13, 7
    s_mul_i32 s80, s79, 48
    s_mul_i32 s52, s3, 12
    s_add_u32 s80, s80, s52
    s_mul_i32 s80, s80, 5120
    s_add_u32 s88, s80, 7340032
    s_waitcnt lgkmcnt(0)
    s_barrier
    ds_read2_b32 v[20:21], v248 offset0:0 offset1:160
    ds_read2_b32 v[22:23], v249 offset0:0 offset1:160
    ds_read2_b32 v[24:25], v248 offset0:16 offset1:176
    ds_read2_b32 v[26:27], v249 offset0:16 offset1:176
    ds_read2_b32 v[28:29], v248 offset0:24 offset1:184
    ds_read2_b32 v[30:31], v249 offset0:24 offset1:184
    s_add_u32 s58, s57, 1191936
    s_add_u32 m0, s56, 36864
    s_nop 0
    buffer_load_dwordx4 v4, s[28:31], s58 offen lds
    s_add_u32 m0, m0, 1024
    s_nop 0
    buffer_load_dwordx4 v5, s[28:31], s58 offen lds
adaLN_cond__spectral_fnet__geglu_ffn__prompt_kernel_hop5:
    s_cbranch_execz adaLN_cond__spectral_fnet__geglu_ffn__prompt_kernel_hop9
    s_add_u32 m0, m0, 1024
    s_nop 0
    buffer_load_dwordx4 v6, s[32:35], s58 offen lds
    s_add_u32 m0, m0, 1024
    s_nop 0
    buffer_load_dwordx4 v7, s[32:35], s58 offen lds
    s_add_u32 s58, s57, 1204224
    s_add_u32 m0, s56, 49152
    s_nop 0
    buffer_load_dwordx4 v4, s[28:31], s58 offen lds
    s_add_u32 m0, m0, 1024
    s_nop 0
    buffer_load_dwordx4 v5, s[28:31], s58 offen lds
    s_add_u32 m0, m0, 1024
    s_nop 0
    buffer_load_dwordx4 v6, s[32:35], s58 offen lds
    s_add_u32 m0, m0, 1024
    s_nop 0
    buffer_load_dwordx4 v7, s[32:35], s58 offen lds
    s_waitcnt lgkmcnt(4)
    v_mfma_f32_16x16x32_bf16 v[32:35], v[20:23], v[104:107], 0
    v_mfma_f32_16x16x32_bf16 v[36:39], v[20:23], v[108:111], 0
    s_waitcnt lgkmcnt(2)
    v_mfma_f32_16x16x32_bf16 v[40:43], v[24:27], v[104:107], 0
    v_mfma_f32_16x16x32_bf16 v[44:47], v[24:27], v[108:111], 0
    s_waitcnt lgkmcnt(0)
    v_mfma_f32_16x16x32_bf16 v[48:51], v[28:31], v[104:107], 0
    v_mfma_f32_16x16x32_bf16 v[52:55], v[28:31], v[108:111], 0
    s_nop 0
    v_pk_mul_f32 v[232:233], v[32:33], v[120:121]
    v_mfma_f32_16x16x32_bf16 v[56:59], v[20:23], v[112:115], 0
    v_pk_mul_f32 v[236:237], v[36:37], v[120:121]
    v_pk_mul_f32 v[234:235], v[34:35], v[122:123]
    v_mfma_f32_16x16x32_bf16 v[60:63], v[20:23], v[116:119], 0
    v_pk_mul_f32 v[238:239], v[38:39], v[122:123]
    v_pk_fma_f32 v[232:233], v[36:37], v[124:125], v[232:233]
    v_mfma_f32_16x16x32_bf16 v[64:67], v[24:27], v[112:115], 0
    v_pk_fma_f32 v[236:237], v[32:33], v[124:125], v[236:237] neg_lo:[1,0,0] neg_hi:[1,0,0]
    v_pk_fma_f32 v[234:235], v[38:39], v[126:127], v[234:235]
    v_mfma_f32_16x16x32_bf16 v[68:71], v[24:27], v[116:119], 0
    v_pk_fma_f32 v[238:239], v[34:35], v[126:127], v[238:239] neg_lo:[1,0,0] neg_hi:[1,0,0]
    v_cvt_pk_bf16_f32 v80, v232, v236
    v_mfma_f32_16x16x32_bf16 v[72:75], v[28:31], v[112:115], 0
    v_cvt_pk_bf16_f32 v81, v233, v237
    v_cvt_pk_bf16_f32 v82, v234, v238
    v_mfma_f32_16x16x32_bf16 v[76:79], v[28:31], v[116:119], 0
    v_cvt_pk_bf16_f32 v83, v235, v239
    v_pk_mul_f32 v[232:233], v[40:41], v[128:129]
    v_pk_mul_f32 v[236:237], v[44:45], v[128:129]
    v_pk_mul_f32 v[234:235], v[42:43], v[130:131]
    v_mfma_f32_16x16x32_bf16 v[20:23], v[144:147], v[80:83], 0
    v_pk_mul_f32 v[238:239], v[46:47], v[130:131]
    v_pk_fma_f32 v[232:233], v[44:45], v[132:133], v[232:233]
    v_pk_fma_f32 v[236:237], v[40:41], v[132:133], v[236:237] neg_lo:[1,0,0] neg_hi:[1,0,0]
    v_mfma_f32_16x16x32_bf16 v[24:27], v[156:159], v[80:83], 0
    v_pk_fma_f32 v[234:235], v[46:47], v[134:135], v[234:235]
    v_pk_fma_f32 v[238:239], v[42:43], v[134:135], v[238:239] neg_lo:[1,0,0] neg_hi:[1,0,0]
    v_cvt_pk_bf16_f32 v84, v232, v236
    v_mfma_f32_16x16x32_bf16 v[28:31], v[168:171], v[80:83], 0
    v_cvt_pk_bf16_f32 v85, v233, v237
    v_cvt_pk_bf16_f32 v86, v234, v238
    v_cvt_pk_bf16_f32 v87, v235, v239
    v_pk_mul_f32 v[232:233], v[48:49], v[136:137]
    v_pk_mul_f32 v[236:237], v[52:53], v[136:137]
    v_pk_mul_f32 v[234:235], v[50:51], v[138:139]
    v_mfma_f32_16x16x32_bf16 v[20:23], v[148:151], v[84:87], v[20:23]
    v_pk_mul_f32 v[238:239], v[54:55], v[138:139]
    v_pk_fma_f32 v[232:233], v[52:53], v[140:141], v[232:233]
    v_pk_fma_f32 v[236:237], v[48:49], v[140:141], v[236:237] neg_lo:[1,0,0] neg_hi:[1,0,0]
    v_mfma_f32_16x16x32_bf16 v[24:27], v[160:163], v[84:87], v[24:27]
    v_pk_fma_f32 v[234:235], v[54:55], v[142:143], v[234:235]
    v_pk_fma_f32 v[238:239], v[50:51], v[142:143], v[238:239] neg_lo:[1,0,0] neg_hi:[1,0,0]
    v_cvt_pk_bf16_f32 v88, v232, v236
    v_mfma_f32_16x16x32_bf16 v[28:31], v[172:175], v[84:87], v[28:31]
    v_cvt_pk_bf16_f32 v89, v233, v237
    v_cvt_pk_bf16_f32 v90, v234, v238
    v_cvt_pk_bf16_f32 v91, v235, v239
    v_pk_mul_f32 v[232:233], v[56:57], v[120:121]
    v_pk_mul_f32 v[236:237], v[60:61], v[120:121]
    v_pk_mul_f32 v[234:235], v[58:59], v[122:123]
    v_mfma_f32_16x16x32_bf16 v[20:23], v[152:155], v[88:91], v[20:23]
    v_pk_mul_f32 v[238:239], v[62:63], v[122:123]
    v_pk_fma_f32 v[232:233], v[60:61], v[124:125], v[232:233]
    v_pk_fma_f32 v[236:237], v[56:57], v[124:125], v[236:237] neg_lo:[1,0,0] neg_hi:[1,0,0]
    v_mfma_f32_16x16x32_bf16 v[24:27], v[164:167], v[88:91], v[24:27]
    v_pk_fma_f32 v[234:235], v[62:63], v[126:127], v[234:235]
    v_pk_fma_f32 v[238:239], v[58:59], v[126:127], v[238:239] neg_lo:[1,0,0] neg_hi:[1,0,0]
    v_cvt_pk_bf16_f32 v92, v232, v236
    v_mfma_f32_16x16x32_bf16 v[28:31], v[176:179], v[88:91], v[28:31]
    v_cvt_pk_bf16_f32 v93, v233, v237
    v_cvt_pk_bf16_f32 v94, v234, v238
    v_cvt_pk_bf16_f32 v95, v235, v239
    v_pk_mul_f32 v[232:233], v[64:65], v[128:129]
    v_pk_mul_f32 v[236:237], v[68:69], v[128:129]
    v_pk_mul_f32 v[234:235], v[66:67], v[130:131]
    v_mfma_f32_16x16x32_bf16 v[32:35], v[144:147], v[92:95], 0
    v_pk_mul_f32 v[238:239], v[70:71], v[130:131]
    v_pk_fma_f32 v[232:233], v[68:69], v[132:133], v[232:233]
    v_pk_fma_f32 v[236:237], v[64:65], v[132:133], v[236:237] neg_lo:[1,0,0] neg_hi:[1,0,0]
    v_mfma_f32_16x16x32_bf16 v[36:39], v[156:159], v[92:95], 0
    v_pk_fma_f32 v[234:235], v[70:71], v[134:135], v[234:235]
    v_pk_fma_f32 v[238:239], v[66:67], v[134:135], v[238:239] neg_lo:[1,0,0] neg_hi:[1,0,0]
    v_cvt_pk_bf16_f32 v96, v232, v236
    v_mfma_f32_16x16x32_bf16 v[40:43], v[168:171], v[92:95], 0
    v_cvt_pk_bf16_f32 v97, v233, v237
    v_cvt_pk_bf16_f32 v98, v234, v238
    v_cvt_pk_bf16_f32 v99, v235, v239
    v_pk_mul_f32 v[232:233], v[72:73], v[136:137]
    v_pk_mul_f32 v[236:237], v[76:77], v[136:137]
    v_pk_mul_f32 v[234:235], v[74:75], v[138:139]
    v_mfma_f32_16x16x32_bf16 v[32:35], v[148:151], v[96:99], v[32:35]
    v_pk_mul_f32 v[238:239], v[78:79], v[138:139]
    v_pk_fma_f32 v[232:233], v[76:77], v[140:141], v[232:233]
    v_pk_fma_f32 v[236:237], v[72:73], v[140:141], v[236:237] neg_lo:[1,0,0] neg_hi:[1,0,0]
    v_mfma_f32_16x16x32_bf16 v[36:39], v[160:163], v[96:99], v[36:39]
    v_pk_fma_f32 v[234:235], v[78:79], v[142:143], v[234:235]
    v_pk_fma_f32 v[238:239], v[74:75], v[142:143], v[238:239] neg_lo:[1,0,0] neg_hi:[1,0,0]
    v_cvt_pk_bf16_f32 v100, v232, v236
    v_mfma_f32_16x16x32_bf16 v[40:43], v[172:175], v[96:99], v[40:43]
    v_cvt_pk_bf16_f32 v101, v233, v237
    v_cvt_pk_bf16_f32 v102, v234, v238
    v_cvt_pk_bf16_f32 v103, v235, v239
    v_pk_fma_f32 v[180:181], v[200:201], v[20:21], v[180:181]
    v_pk_fma_f32 v[182:183], v[202:203], v[22:23], v[182:183]
    v_mfma_f32_16x16x32_bf16 v[32:35], v[152:155], v[100:103], v[32:35]
    v_pk_fma_f32 v[184:185], v[204:205], v[24:25], v[184:185]
    v_pk_fma_f32 v[186:187], v[206:207], v[26:27], v[186:187]
    v_mfma_f32_16x16x32_bf16 v[36:39], v[164:167], v[100:103], v[36:39]
    v_pk_fma_f32 v[188:189], v[208:209], v[28:29], v[188:189]
    v_pk_add_f32 v[232:233], v[180:181], v[182:183]
    v_mfma_f32_16x16x32_bf16 v[40:43], v[176:179], v[100:103], v[40:43]
    v_pk_mul_f32 v[234:235], v[180:181], v[180:181]
    v_pk_fma_f32 v[234:235], v[182:183], v[182:183], v[234:235]
    v_pk_add_f32 v[232:233], v[232:233], v[184:185]
    v_pk_fma_f32 v[234:235], v[184:185], v[184:185], v[234:235]
    v_pk_add_f32 v[232:233], v[232:233], v[186:187]
    v_pk_fma_f32 v[234:235], v[186:187], v[186:187], v[234:235]
    v_pk_add_f32 v[232:233], v[232:233], v[188:189]
    v_pk_fma_f32 v[234:235], v[188:189], v[188:189], v[234:235]
    v_add_f32 v230, v232, v233
    v_add_f32 v231, v234, v235
    s_add_u32 s58, s57, 1216512
    s_add_u32 m0, s56, 61440
    s_nop 0
    buffer_load_dwordx4 v4, s[28:31], s58 offen lds
    s_add_u32 m0, m0, 1024
    s_nop 0
    buffer_load_dwordx4 v5, s[28:31], s58 offen lds
    s_add_u32 m0, m0, 1024
    s_nop 0
    buffer_load_dwordx4 v6, s[32:35], s58 offen lds
    s_add_u32 m0, m0, 1024
    s_nop 0
    buffer_load_dwordx4 v7, s[32:35], s58 offen lds
    s_add_u32 s58, s57, 1572864
    s_add_u32 m0, s56, 73728
    s_nop 0
    buffer_load_dwordx4 v8, s[28:31], s58 offen lds
    s_add_u32 m0, m0, 1024
    s_nop 0
    buffer_load_dwordx4 v9, s[28:31], s58 offen lds
    s_add_u32 m0, m0, 1024
    s_nop 0
    buffer_load_dwordx4 v10, s[32:35], s58 offen lds
    s_add_u32 m0, m0, 1024
    s_nop 0
    buffer_load_dwordx4 v11, s[32:35], s58 offen lds
    v_pk_fma_f32 v[190:191], v[200:201], v[32:33], v[190:191]
    v_pk_fma_f32 v[192:193], v[202:203], v[34:35], v[192:193]
    v_pk_fma_f32 v[194:195], v[204:205], v[36:37], v[194:195]
    v_pk_fma_f32 v[196:197], v[206:207], v[38:39], v[196:197]
    v_pk_fma_f32 v[198:199], v[208:209], v[40:41], v[198:199]
    v_pk_add_f32 v[236:237], v[190:191], v[192:193]
    v_pk_mul_f32 v[238:239], v[190:191], v[190:191]
    v_pk_fma_f32 v[238:239], v[192:193], v[192:193], v[238:239]
    v_pk_add_f32 v[236:237], v[236:237], v[194:195]
    v_pk_fma_f32 v[238:239], v[194:195], v[194:195], v[238:239]
    v_pk_add_f32 v[236:237], v[236:237], v[196:197]
    v_pk_fma_f32 v[238:239], v[196:197], v[196:197], v[238:239]
    v_pk_add_f32 v[236:237], v[236:237], v[198:199]
    v_pk_fma_f32 v[238:239], v[198:199], v[198:199], v[238:239]
    v_add_f32 v254, v236, v237
    v_add_f32 v255, v238, v239
    v_permlane16_swap_b32 v230, v231
    s_nop 0
    v_permlane16_swap_b32 v254, v255
    v_add_f32 v232, v230, v231
    v_add_f32 v234, v254, v255
    s_nop 1
    v_permlane32_swap_b32 v232, v234
    v_add_f32 v232, v232, v234
    s_nop 1
    v_add_f32_dpp v232, v232, v232 row_ror:8 row_mask:0xf bank_mask:0xf
    s_nop 1
    v_add_f32_dpp v232, v232, v232 row_ror:4 row_mask:0xf bank_mask:0xf
    s_nop 1
    v_add_f32_dpp v232, v232, v232 row_ror:2 row_mask:0xf bank_mask:0xf
    s_nop 1
    v_add_f32_dpp v232, v232, v232 row_ror:1 row_mask:0xf bank_mask:0xf
    v_mul_f32 v232, 0x3acccccd, v232
    s_nop 0
    v_readlane_b32 s52, v232, 0
    v_readlane_b32 s53, v232, 16
    v_readlane_b32 s54, v232, 32
    v_readlane_b32 s55, v232, 48
    v_mov_b32 v234, s53
    v_mov_b32 v236, s52
    v_mov_b32 v235, s55
    v_mov_b32 v237, s54
    v_fma_f32 v234, -v236, v236, v234
    v_fma_f32 v235, -v237, v237, v235
    v_max_f32 v234, 0, v234
    v_max_f32 v235, 0, v235
    v_add_f32 v234, 0x3727c5ac, v234
    v_add_f32 v235, 0x3727c5ac, v235
    v_rsq_f32 v234, v234
    v_rsq_f32 v235, v235
    v_mul_f32 v236, -v236, v234
    v_mul_f32 v237, -v237, v235
    v_pk_fma_f32 v[48:49], v[180:181], v[234:235], v[236:237] op_sel:[0,0,0] op_sel_hi:[1,0,0]
    v_pk_fma_f32 v[50:51], v[182:183], v[234:235], v[236:237] op_sel:[0,0,0] op_sel_hi:[1,0,0]
    v_pk_fma_f32 v[52:53], v[184:185], v[234:235], v[236:237] op_sel:[0,0,0] op_sel_hi:[1,0,0]
    v_pk_fma_f32 v[54:55], v[186:187], v[234:235], v[236:237] op_sel:[0,0,0] op_sel_hi:[1,0,0]
    v_pk_fma_f32 v[56:57], v[188:189], v[234:235], v[236:237] op_sel:[0,0,0] op_sel_hi:[1,0,0]
    v_pk_fma_f32 v[48:49], v[48:49], v[220:221], v[210:211]
    v_pk_fma_f32 v[50:51], v[50:51], v[222:223], v[212:213]
    v_pk_fma_f32 v[52:53], v[52:53], v[224:225], v[214:215]
    v_pk_fma_f32 v[54:55], v[54:55], v[226:227], v[216:217]
    v_pk_fma_f32 v[56:57], v[56:57], v[228:229], v[218:219]
    v_cvt_pk_bf16_f32 v80, v48, v49
    v_cvt_pk_bf16_f32 v81, v50, v51
    v_cvt_pk_bf16_f32 v82, v52, v53
    v_cvt_pk_bf16_f32 v83, v54, v55
    v_cvt_pk_bf16_f32 v84, v56, v57
    ds_write_b128 v240, v[80:83] offset:10240
    ds_write_b32 v242, v84 offset:18432
    v_pk_fma_f32 v[60:61], v[190:191], v[234:235], v[236:237] op_sel:[0,1,1] op_sel_hi:[1,1,1]
    v_pk_fma_f32 v[62:63], v[192:193], v[234:235], v[236:237] op_sel:[0,1,1] op_sel_hi:[1,1,1]
    v_pk_fma_f32 v[64:65], v[194:195], v[234:235], v[236:237] op_sel:[0,1,1] op_sel_hi:[1,1,1]
    v_pk_fma_f32 v[66:67], v[196:197], v[234:235], v[236:237] op_sel:[0,1,1] op_sel_hi:[1,1,1]
    v_pk_fma_f32 v[68:69], v[198:199], v[234:235], v[236:237] op_sel:[0,1,1] op_sel_hi:[1,1,1]
    v_pk_fma_f32 v[60:61], v[60:61], v[220:221], v[210:211]
    v_pk_fma_f32 v[62:63], v[62:63], v[222:223], v[212:213]
    v_pk_fma_f32 v[64:65], v[64:65], v[224:225], v[214:215]
    v_pk_fma_f32 v[66:67], v[66:67], v[226:227], v[216:217]
    v_pk_fma_f32 v[68:69], v[68:69], v[228:229], v[218:219]
    v_cvt_pk_bf16_f32 v88, v60, v61
    v_cvt_pk_bf16_f32 v89, v62, v63
    v_cvt_pk_bf16_f32 v90, v64, v65
    v_cvt_pk_bf16_f32 v91, v66, v67
    v_cvt_pk_bf16_f32 v92, v68, v69
    ds_write_b128 v241, v[88:91] offset:10240
    ds_write_b32 v243, v92 offset:18432
    s_waitcnt vmcnt(12)
    s_waitcnt lgkmcnt(0)
    s_barrier
    v_add_u32 v250, 10240, v250
    v_add_u32 v251, 10240, v251
    s_add_u32 s72, s72, 10240
    v_cvt_pk_bf16_f32 v20, v180, v181
    v_cvt_pk_bf16_f32 v21, v182, v183
    v_cvt_pk_bf16_f32 v22, v184, v185
    v_cvt_pk_bf16_f32 v23, v186, v187
    v_cvt_pk_bf16_f32 v24, v188, v189
    ds_write_b16 v250, v20 offset:0
    ds_write_b16_d16_hi v250, v20 offset:32
    ds_write_b16 v250, v21 offset:64
    ds_write_b16_d16_hi v250, v21 offset:96
    ds_write_b16 v250, v22 offset:128
    ds_write_b16_d16_hi v250, v22 offset:160
    ds_write_b16 v250, v23 offset:192
    ds_write_b16_d16_hi v250, v23 offset:224
    ds_write_b16 v251, v24 offset:1024
    ds_write_b16_d16_hi v251, v24 offset:1056
    v_cvt_pk_bf16_f32 v28, v190, v191
    v_cvt_pk_bf16_f32 v29, v192, v193
    v_cvt_pk_bf16_f32 v30, v194, v195
    v_cvt_pk_bf16_f32 v31, v196, v197
    v_cvt_pk_bf16_f32 v32, v198, v199
    ds_write_b16 v250, v28 offset:1280
    ds_write_b16_d16_hi v250, v28 offset:1312
    ds_write_b16 v250, v29 offset:1344
    ds_write_b16_d16_hi v250, v29 offset:1376
    ds_write_b16 v250, v30 offset:1408
    ds_write_b16_d16_hi v250, v30 offset:1440
    ds_write_b16 v250, v31 offset:1472
    ds_write_b16_d16_hi v250, v31 offset:1504
    ds_write_b16 v251, v32 offset:2304
    ds_write_b16_d16_hi v251, v32 offset:2336
    v_add_u32 v234, s72, v18
    v_lshlrev_b32 v107, 2, v1
    v_add_u32 v235, s72, v107
    s_waitcnt lgkmcnt(0)
    ds_read_b128 v[96:99], v234 offset:0
    ds_read_b32 v104, v235 offset:1024
    ds_read_b128 v[100:103], v234 offset:1280
    ds_read_b32 v105, v235 offset:2304
    ds_read_b64_tr_b16 a[120:121], v12 offset:0
    ds_read_b64_tr_b16 a[122:123], v12 offset:768
    ds_read_b64_tr_b16 a[124:125], v12 offset:6144
    ds_read_b64_tr_b16 a[126:127], v12 offset:6912
    ds_read_b64_tr_b16 a[128:129], v13 offset:0
    ds_read_b64_tr_b16 a[130:131], v13 offset:768
    ds_read_b64_tr_b16 a[132:133], v12 offset:12288
    ds_read_b64_tr_b16 a[134:135], v12 offset:13056
    ds_read_b64_tr_b16 a[136:137], v12 offset:18432
    ds_read_b64_tr_b16 a[138:139], v12 offset:19200
    ds_read_b64_tr_b16 a[140:141], v13 offset:12288
    ds_read_b64_tr_b16 a[142:143], v13 offset:13056
    ds_read_b64_tr_b16 a[144:145], v12 offset:24576
    ds_read_b64_tr_b16 a[146:147], v12 offset:25344
    ds_read_b64_tr_b16 a[148:149], v12 offset:30720
    ds_read_b64_tr_b16 a[150:151], v12 offset:31488
    ds_read_b64_tr_b16 a[152:153], v13 offset:24576
    ds_read_b64_tr_b16 a[154:155], v13 offset:25344
    ds_read_b64_tr_b16 a[156:157], v12 offset:36864
    ds_read_b64_tr_b16 a[158:159], v12 offset:37632
    ds_read_b64_tr_b16 a[160:161], v12 offset:43008
    ds_read_b64_tr_b16 a[162:163], v12 offset:43776
    ds_read_b64_tr_b16 a[164:165], v13 offset:36864
    ds_read_b64_tr_b16 a[166:167], v13 offset:37632
    s_cmp_lt_u32 s3, 2
    s_cselect_b32 s28, s36, s38
    s_cselect_b32 s29, s37, s39
    s_and_b32 s29, s29, 0xffff
    s_mov_b32 s53, 357913942
    s_and_b32 s52, s3, 1
    s_mul_i32 s52, s52, 192
    s_mul_i32 s56, s3, 3072
    s_add_u32 s56, s56, 40960
    v_add_u32 v232, s52, v1
    v_mul_hi_u32 v233, v232, s53
    v_mul_u32_u24 v234, 12, v233
    v_sub_u32 v234, v232, v234
    v_lshrrev_b32 v235, 3, v233
    v_bfe_u32 v236, v233, 1, 2
    v_lshl_add_u32 v235, v235, 2, v236
    v_and_b32 v236, 1, v233
    v_lshl_add_u32 v235, v236, 4, v235
    v_mul_u32_u24 v235, 3072, v235
    v_lshl_add_u32 v4, v234, 4, v235
    v_add_u32 v232, s52, v1
    v_add_u32 v232, 64, v232
    v_mul_hi_u32 v233, v232, s53
    v_mul_u32_u24 v234, 12, v233
    v_sub_u32 v234, v232, v234
    v_lshrrev_b32 v235, 3, v233
    v_bfe_u32 v236, v233, 1, 2
    v_lshl_add_u32 v235, v235, 2, v236
    v_and_b32 v236, 1, v233
    v_lshl_add_u32 v235, v236, 4, v235
    v_mul_u32_u24 v235, 3072, v235
    v_lshl_add_u32 v5, v234, 4, v235
    v_add_u32 v232, s52, v1
    v_add_u32 v232, 128, v232
    v_mul_hi_u32 v233, v232, s53
    v_mul_u32_u24 v234, 12, v233
    v_sub_u32 v234, v232, v234
    v_lshrrev_b32 v235, 3, v233
    v_bfe_u32 v236, v233, 1, 2
    v_lshl_add_u32 v235, v235, 2, v236
    v_and_b32 v236, 1, v233
    v_lshl_add_u32 v235, v236, 4, v235
    v_mul_u32_u24 v235, 3072, v235
    v_lshl_add_u32 v6, v234, 4, v235
    s_waitcnt lgkmcnt(15)
    s_waitcnt lgkmcnt(0)
    s_barrier
adaLN_cond__spectral_fnet__geglu_ffn__prompt_kernel_x922:
    s_lshr_b32 s52, s3, 1
    s_mul_i32 s52, s52, 20480
    s_and_b32 s53, s3, 1
    s_sub_u32 s54, s76, s77
    s_add_u32 s54, s54, s52
    s_mul_i32 s55, s53, 4096
    s_add_u32 s55, s55, 0
    s_add_u32 s81, s54, s55
    s_add_u32 m0, s52, s55
    s_nop 0
    buffer_load_dwordx4 v18, s[16:19], s81 offen offset:0 sc1 lds
    buffer_load_dwordx4 v18, s[16:19], s81 offen offset:1024 sc1 lds
    buffer_load_dwordx4 v18, s[16:19], s81 offen offset:2048 sc1 lds
    buffer_load_dwordx4 v18, s[16:19], s81 offen offset:3072 sc1 lds
    s_mul_i32 s55, s53, 6144
    s_add_u32 s55, s55, 8192
    s_add_u32 s81, s54, s55
    s_add_u32 m0, s52, s55
    s_nop 0
    buffer_load_dwordx4 v18, s[16:19], s81 offen offset:0 sc1 lds
    buffer_load_dwordx4 v18, s[16:19], s81 offen offset:1024 sc1 lds
    buffer_load_dwordx4 v18, s[16:19], s81 offen offset:2048 sc1 lds
    buffer_load_dwordx4 v18, s[16:19], s81 offen offset:3072 sc1 lds
    s_add_u32 s81, s81, 4096
    s_add_u32 m0, m0, 4096
    s_nop 0
    buffer_load_dwordx4 v18, s[16:19], s81 offen offset:0 sc1 lds
    buffer_load_dwordx4 v18, s[16:19], s81 offen offset:1024 sc1 lds
    s_mul_i32 s52, s70, 1280
    buffer_store_dwordx4 v[96:99], v18, s[20:23], s52 offen
    buffer_store_dword v104, v107, s[20:23], s52 offen offset:1024
    s_mul_i32 s52, s71, 1280
    buffer_store_dwordx4 v[100:103], v18, s[20:23], s52 offen
    buffer_store_dword v105, v107, s[20:23], s52 offen offset:1024
    v_lshrrev_b32 v20, 2, v1
    v_min_u32 v20, 9, v20
    s_mul_i32 s53, s79, 320
    v_lshl_add_u32 v20, v20, 5, s53
    s_mov_b32 s52, 6296576
    buffer_load_dwordx4 v[80:83], v20, s[16:19], s52 offen offset:0 sc1
    buffer_load_dwordx4 v[84:87], v20, s[16:19], s52 offen offset:16 sc1
    s_mov_b32 s52, 6312960
    buffer_load_dwordx4 v[88:91], v20, s[16:19], s52 offen offset:0 sc1
    buffer_load_dwordx4 v[92:95], v20, s[16:19], s52 offen offset:16 sc1
    s_waitcnt vmcnt(14)
    s_cmp_eq_u32 s3, 0
    s_cbranch_scc1 adaLN_cond__spectral_fnet__geglu_ffn__prompt_kernel_wn87
adaLN_cond__spectral_fnet__geglu_ffn__prompt_kernel_wn87:
    s_barrier
    ds_read_b128 v[24:27], v18 offset:0
    ds_read_b128 v[32:35], v18 offset:1024
    ds_read_b128 v[28:31], v18 offset:20480
    ds_read_b128 v[36:39], v18 offset:21504
    s_waitcnt lgkmcnt(2)
    v_mfma_f32_16x16x32_bf16 v[56:59], a[0:3], v[24:27], 0
    s_add_u32 s58, s57, 1671168
    ds_read_b64_tr_b16 a[168:169], v14 offset:0
    v_mfma_f32_16x16x32_bf16 v[56:59], a[12:15], v[32:35], v[56:59]
    ds_read_b128 v[40:43], v18 offset:2048
    s_add_u32 m0, s56, 86016
    v_mfma_f32_16x16x32_bf16 v[60:63], a[4:7], v[24:27], 0
    buffer_load_dwordx4 v4, s[28:31], s58 offen lds
    ds_read_b64_tr_b16 a[170:171], v14 offset:768
    v_mfma_f32_16x16x32_bf16 v[60:63], a[16:19], v[32:35], v[60:63]
    ds_read_b128 v[48:51], v18 offset:3072
    s_add_u32 m0, s56, 87040
    v_mfma_f32_16x16x32_bf16 v[64:67], a[8:11], v[24:27], 0
    ds_read_b64_tr_b16 a[172:173], v14 offset:6144
    ds_read_b64_tr_b16 a[174:175], v14 offset:6912
    v_mfma_f32_16x16x32_bf16 v[64:67], a[20:23], v[32:35], v[64:67]
    ds_read_b128 v[44:47], v18 offset:22528
    buffer_load_dwordx4 v5, s[28:31], s58 offen lds
    s_waitcnt lgkmcnt(8)
    v_mfma_f32_16x16x32_bf16 v[68:71], a[0:3], v[28:31], 0
    s_add_u32 m0, s56, 88064
    ds_read_b64_tr_b16 a[176:177], v15 offset:0
    s_waitcnt lgkmcnt(8)
    v_mfma_f32_16x16x32_bf16 v[68:71], a[12:15], v[36:39], v[68:71]
    ds_read_b64_tr_b16 a[178:179], v15 offset:768
    ds_read_b64_tr_b16 a[180:181], v14 offset:12288
    v_mfma_f32_16x16x32_bf16 v[72:75], a[4:7], v[28:31], 0
    ds_read_b128 v[52:55], v18 offset:23552
    buffer_load_dwordx4 v6, s[28:31], s58 offen lds
    v_mfma_f32_16x16x32_bf16 v[72:75], a[16:19], v[36:39], v[72:75]
    s_add_u32 s58, s57, 1769472
    ds_read_b64_tr_b16 a[182:183], v14 offset:13056
    v_mfma_f32_16x16x32_bf16 v[76:79], a[8:11], v[28:31], 0
    s_add_u32 m0, s56, 98304
    ds_read_b64_tr_b16 a[184:185], v14 offset:18432
    v_mfma_f32_16x16x32_bf16 v[76:79], a[20:23], v[36:39], v[76:79]
    buffer_load_dwordx4 v4, s[28:31], s58 offen lds
    s_waitcnt lgkmcnt(2)
    v_mfma_f32_16x16x32_bf16 v[56:59], a[24:27], v[40:43], v[56:59]
    s_add_u32 m0, s56, 99328
    ds_read_b64_tr_b16 a[186:187], v14 offset:19200
    v_mfma_f32_16x16x32_bf16 v[56:59], a[36:39], v[48:51], v[56:59]
    ds_read_b128 v[24:27], v18 offset:4096
    ds_read_b64_tr_b16 a[188:189], v15 offset:12288
    v_mfma_f32_16x16x32_bf16 v[60:63], a[28:31], v[40:43], v[60:63]
    buffer_load_dwordx4 v5, s[28:31], s58 offen lds
    ds_read_b64_tr_b16 a[190:191], v15 offset:13056
    v_mfma_f32_16x16x32_bf16 v[60:63], a[40:43], v[48:51], v[60:63]
    ds_read_b128 v[32:35], v18 offset:5120
    s_add_u32 m0, s56, 100352
    v_mfma_f32_16x16x32_bf16 v[64:67], a[32:35], v[40:43], v[64:67]
    ds_read_b64_tr_b16 a[192:193], v14 offset:24576
    ds_read_b64_tr_b16 a[194:195], v14 offset:25344
    v_mfma_f32_16x16x32_bf16 v[64:67], a[44:47], v[48:51], v[64:67]
    ds_read_b128 v[28:31], v18 offset:24576
    buffer_load_dwordx4 v6, s[28:31], s58 offen lds
    v_mfma_f32_16x16x32_bf16 v[68:71], a[24:27], v[44:47], v[68:71]
    s_add_u32 s58, s57, 1867776
    ds_read_b64_tr_b16 a[196:197], v14 offset:30720
    v_mfma_f32_16x16x32_bf16 v[68:71], a[36:39], v[52:55], v[68:71]
    s_add_u32 m0, s56, 110592
    ds_read_b64_tr_b16 a[198:199], v14 offset:31488
    v_mfma_f32_16x16x32_bf16 v[72:75], a[28:31], v[44:47], v[72:75]
    ds_read_b128 v[36:39], v18 offset:25600
    buffer_load_dwordx4 v4, s[28:31], s58 offen lds
    v_mfma_f32_16x16x32_bf16 v[72:75], a[40:43], v[52:55], v[72:75]
    s_add_u32 m0, s56, 111616
    ds_read_b64_tr_b16 a[200:201], v15 offset:24576
    v_mfma_f32_16x16x32_bf16 v[76:79], a[32:35], v[44:47], v[76:79]
    ds_read_b64_tr_b16 a[202:203], v15 offset:25344
    v_and_b32 v20, 1, v3
    v_mfma_f32_16x16x32_bf16 v[76:79], a[44:47], v[52:55], v[76:79]
    buffer_load_dwordx4 v5, s[28:31], s58 offen lds
    s_waitcnt lgkmcnt(2)
    v_mfma_f32_16x16x32_bf16 v[56:59], a[48:51], v[24:27], v[56:59]
    s_add_u32 m0, s56, 112640
    v_lshrrev_b32 v21, 1, v3
    v_mfma_f32_16x16x32_bf16 v[56:59], a[60:63], v[32:35], v[56:59]
    ds_read_b128 v[40:43], v18 offset:6144
    v_mul_u32_u24 v248, 49152, v20
    v_mfma_f32_16x16x32_bf16 v[60:63], a[52:55], v[24:27], v[60:63]
    buffer_load_dwordx4 v6, s[28:31], s58 offen lds
    v_lshl_add_u32 v248, v21, 8, v248
    v_mfma_f32_16x16x32_bf16 v[60:63], a[64:67], v[32:35], v[60:63]
    ds_read_b128 v[48:51], v18 offset:7168
    s_add_u32 m0, s77, 40960
    v_mfma_f32_16x16x32_bf16 v[64:67], a[56:59], v[24:27], v[64:67]
    s_add_u32 s81, s76, 40960
    v_lshl_add_u32 v248, v2, 4, v248
    v_mfma_f32_16x16x32_bf16 v[64:67], a[68:71], v[32:35], v[64:67]
    ds_read_b128 v[44:47], v18 offset:26624
    buffer_load_dwordx4 v18, s[16:19], s81 offen offset:0 sc1 lds
    v_mfma_f32_16x16x32_bf16 v[68:71], a[48:51], v[28:31], v[68:71]
    v_mul_u32_u24 v249, 49152, v21
    v_lshl_add_u32 v249, v20, 3, v249
    v_mfma_f32_16x16x32_bf16 v[68:71], a[60:63], v[36:39], v[68:71]
    v_lshl_add_u32 v249, v2, 4, v249
    v_mov_b32 v250, 0xc0135761
    v_mfma_f32_16x16x32_bf16 v[72:75], a[52:55], v[28:31], v[72:75]
    ds_read_b128 v[52:55], v18 offset:27648
    buffer_load_dwordx4 v18, s[16:19], s81 offen offset:1024 sc1 lds
    v_mfma_f32_16x16x32_bf16 v[72:75], a[64:67], v[36:39], v[72:75]
    v_mov_b32 v254, 0xbdd2d3e8
    v_add_u32 v255, 40960, v18
    v_mfma_f32_16x16x32_bf16 v[76:79], a[56:59], v[28:31], v[76:79]
    s_lshr_b32 s83, s13, 3
    s_mul_i32 s52, s83, 49152
    v_mfma_f32_16x16x32_bf16 v[76:79], a[68:71], v[36:39], v[76:79]
    buffer_load_dwordx4 v18, s[16:19], s81 offen offset:2048 sc1 lds
    s_waitcnt lgkmcnt(0)
    v_mfma_f32_16x16x32_bf16 v[56:59], a[72:75], v[40:43], v[56:59]
    s_waitcnt vmcnt(20)
    s_barrier
    v_mfma_f32_16x16x32_bf16 v[56:59], a[84:87], v[48:51], v[56:59]
    ds_read_b128 v[24:27], v18 offset:8192
    s_mul_i32 s53, s3, 12288
    v_mfma_f32_16x16x32_bf16 v[60:63], a[76:79], v[40:43], v[60:63]
    buffer_load_dwordx4 v18, s[16:19], s81 offen offset:3072 sc1 lds
    s_add_u32 s52, s52, s53
    v_mfma_f32_16x16x32_bf16 v[60:63], a[88:91], v[48:51], v[60:63]
    ds_read_b128 v[32:35], v18 offset:9216
    s_add_u32 m0, s77, 45056
    v_mfma_f32_16x16x32_bf16 v[64:67], a[80:83], v[40:43], v[64:67]
    s_add_u32 s81, s76, 45056
    s_add_u32 s60, s52, s66
    v_mfma_f32_16x16x32_bf16 v[64:67], a[92:95], v[48:51], v[64:67]
    ds_read_b128 v[28:31], v18 offset:28672
    buffer_load_dwordx4 v18, s[16:19], s81 offen offset:0 sc1 lds
    v_mfma_f32_16x16x32_bf16 v[68:71], a[72:75], v[44:47], v[68:71]
    s_add_u32 s60, s60, 9437184
    s_add_u32 s61, s52, s66
    v_mfma_f32_16x16x32_bf16 v[68:71], a[84:87], v[52:55], v[68:71]
    s_add_u32 s61, s61, 9535488
    s_add_u32 s62, s52, s66
    v_mfma_f32_16x16x32_bf16 v[72:75], a[76:79], v[44:47], v[72:75]
    ds_read_b128 v[36:39], v18 offset:29696
    buffer_load_dwordx4 v18, s[16:19], s81 offen offset:1024 sc1 lds
    v_mfma_f32_16x16x32_bf16 v[72:75], a[88:91], v[52:55], v[72:75]
    s_add_u32 s62, s62, 9633792
    s_add_u32 s63, s52, s67
    v_mfma_f32_16x16x32_bf16 v[76:79], a[80:83], v[44:47], v[76:79]
    s_add_u32 s63, s63, 0
    s_mul_i32 s85, s3, 20480
    v_mfma_f32_16x16x32_bf16 v[76:79], a[92:95], v[52:55], v[76:79]
    buffer_load_dwordx4 v18, s[16:19], s81 offen offset:2048 sc1 lds
adaLN_cond__spectral_fnet__geglu_ffn__prompt_kernel_hop6:
    s_cbranch_execz adaLN_cond__spectral_fnet__geglu_ffn__prompt_kernel_back12
    s_waitcnt lgkmcnt(0)
    v_mfma_f32_16x16x32_bf16 v[56:59], a[96:99], v[24:27], v[56:59]
    s_add_u32 s85, s85, 81920
    s_lshl_b32 s86, s13, 4
    v_mfma_f32_16x16x32_bf16 v[56:59], a[108:111], v[32:35], v[56:59]
    ds_read_b128 v[40:43], v18 offset:10240
    s_lshl_b32 s52, s3, 2
    v_mfma_f32_16x16x32_bf16 v[60:63], a[100:103], v[24:27], v[60:63]
    buffer_load_dwordx4 v18, s[16:19], s81 offen offset:3072 sc1 lds
    s_add_u32 s86, s86, s52
    v_mfma_f32_16x16x32_bf16 v[60:63], a[112:115], v[32:35], v[60:63]
    ds_read_b128 v[48:51], v18 offset:11264
    s_add_u32 m0, s77, 49152
    v_mfma_f32_16x16x32_bf16 v[64:67], a[104:107], v[24:27], v[64:67]
    s_add_u32 s81, s76, 49152
    s_add_u32 s86, s86, s68
    v_mfma_f32_16x16x32_bf16 v[64:67], a[116:119], v[32:35], v[64:67]
    ds_read_b128 v[44:47], v18 offset:30720
    buffer_load_dwordx4 v18, s[16:19], s81 offen offset:0 sc1 lds
    v_mfma_f32_16x16x32_bf16 v[68:71], a[96:99], v[28:31], v[68:71]
    v_mov_b32 v252, s14
    v_mov_b32 v253, 0
    v_mfma_f32_16x16x32_bf16 v[68:71], a[108:111], v[36:39], v[68:71]
    v_and_b32 v20, 3, v1
    v_lshrrev_b32 v21, 2, v1
    v_mfma_f32_16x16x32_bf16 v[72:75], a[100:103], v[28:31], v[72:75]
    ds_read_b128 v[52:55], v18 offset:31744
    buffer_load_dwordx4 v18, s[16:19], s81 offen offset:1024 sc1 lds
    v_mfma_f32_16x16x32_bf16 v[72:75], a[112:115], v[36:39], v[72:75]
    s_add_u32 s80, s88, 0
    v_min_u32 v21, 9, v21
    v_mfma_f32_16x16x32_bf16 v[76:79], a[104:107], v[28:31], v[76:79]
    s_lshl_b32 s52, s3, 2
    v_add_u32 v20, s52, v20
    v_mfma_f32_16x16x32_bf16 v[76:79], a[116:119], v[36:39], v[76:79]
    buffer_load_dwordx4 v[116:119], v18, s[16:19], s80 offen offset:0 sc1
    s_waitcnt lgkmcnt(0)
    v_mfma_f32_16x16x32_bf16 v[56:59], a[120:123], v[40:43], v[56:59]
    v_lshrrev_b32 v22, 2, v21
    v_mul_u32_u24 v22, 2560, v22
    v_mfma_f32_16x16x32_bf16 v[56:59], a[132:135], v[48:51], v[56:59]
    ds_read_b128 v[24:27], v18 offset:12288
    v_and_b32 v23, 3, v21
    v_mfma_f32_16x16x32_bf16 v[60:63], a[124:127], v[40:43], v[60:63]
    buffer_load_dwordx4 v[120:123], v18, s[16:19], s80 offen offset:1024 sc1
    v_cmp_le_u32 vcc, 8, v21
    v_mfma_f32_16x16x32_bf16 v[60:63], a[136:139], v[48:51], v[60:63]
    ds_read_b128 v[32:35], v18 offset:13312
    v_lshlrev_b32 v9, 1, v23
    v_mfma_f32_16x16x32_bf16 v[64:67], a[128:131], v[40:43], v[64:67]
    v_cndmask_b32 v23, v23, v9, vcc
    v_mul_u32_u24 v23, 320, v23
    v_mfma_f32_16x16x32_bf16 v[64:67], a[140:143], v[48:51], v[64:67]
    ds_read_b128 v[28:31], v18 offset:32768
    buffer_load_dwordx4 v[124:127], v18, s[16:19], s80 offen offset:2048 sc1
    v_mfma_f32_16x16x32_bf16 v[68:71], a[120:123], v[44:47], v[68:71]
    v_add_u32 v22, v22, v23
    v_lshl_add_u32 v9, v20, 4, v22
    v_mfma_f32_16x16x32_bf16 v[68:71], a[132:135], v[52:55], v[68:71]
    v_mov_b32 v22, 1280
    v_mov_b32 v23, 320
    v_mfma_f32_16x16x32_bf16 v[72:75], a[124:127], v[44:47], v[72:75]
    ds_read_b128 v[36:39], v18 offset:33792
    buffer_load_dwordx4 v[128:131], v18, s[16:19], s80 offen offset:3072 sc1
    v_mfma_f32_16x16x32_bf16 v[72:75], a[136:139], v[52:55], v[72:75]
    s_add_u32 s80, s88, 4096
    v_cndmask_b32 v22, v22, v23, vcc
    v_mfma_f32_16x16x32_bf16 v[76:79], a[128:131], v[44:47], v[76:79]
    v_add_u32 v10, v9, v22
    s_mul_i32 s53, s79, 160
    v_mfma_f32_16x16x32_bf16 v[76:79], a[140:143], v[52:55], v[76:79]
    buffer_load_dwordx4 v[132:135], v18, s[16:19], s80 offen offset:0 sc1
    s_waitcnt lgkmcnt(0)
    v_mfma_f32_16x16x32_bf16 v[56:59], a[144:147], v[24:27], v[56:59]
    v_lshl_add_u32 v21, v21, 4, s53
    s_lshl_b32 s52, s83, 4
    v_mfma_f32_16x16x32_bf16 v[56:59], a[156:159], v[32:35], v[56:59]
    ds_read_b128 v[40:43], v18 offset:14336
    v_add_u32 v20, s52, v20
    v_mfma_f32_16x16x32_bf16 v[60:63], a[148:151], v[24:27], v[60:63]
    buffer_load_dwordx4 v[136:139], v18, s[16:19], s80 offen offset:1024 sc1
    v_mul_u32_u24 v11, 1280, v20
    v_mfma_f32_16x16x32_bf16 v[60:63], a[160:163], v[32:35], v[60:63]
    ds_read_b128 v[48:51], v18 offset:15360
    v_add_u32 v11, v11, v21
    v_mfma_f32_16x16x32_bf16 v[64:67], a[152:155], v[24:27], v[64:67]
    v_lshrrev_b32 v22, 1, v20
    v_lshl_add_u32 v22, v22, 5, s12
    v_mfma_f32_16x16x32_bf16 v[64:67], a[164:167], v[32:35], v[64:67]
    ds_read_b128 v[44:47], v18 offset:34816
    buffer_load_dwordx4 v[140:143], v18, s[16:19], s80 offen offset:2048 sc1
    v_mfma_f32_16x16x32_bf16 v[68:71], a[144:147], v[28:31], v[68:71]
    v_and_b32 v20, 1, v20
    s_cmp_eq_u32 s12, 0
    s_cselect_b32 s53, -1008, 0
    v_mfma_f32_16x16x32_bf16 v[68:71], a[156:159], v[36:39], v[68:71]
    v_sub_u32 v23, 2048, v22
    v_cmp_eq_u32 vcc, 0, v22
    v_mfma_f32_16x16x32_bf16 v[72:75], a[148:151], v[28:31], v[72:75]
    ds_read_b128 v[52:55], v18 offset:35840
    buffer_load_dwordx4 v[144:147], v18, s[16:19], s80 offen offset:3072 sc1
    v_mfma_f32_16x16x32_bf16 v[72:75], a[160:163], v[36:39], v[72:75]
    s_add_u32 s80, s88, 8192
    s_waitcnt vmcnt(28)
    v_add_f32 v80, v80, v88
    v_mfma_f32_16x16x32_bf16 v[76:79], a[152:155], v[28:31], v[76:79]
    v_add_f32 v81, v81, v89
    v_add_f32 v82, v82, v90
    v_mfma_f32_16x16x32_bf16 v[76:79], a[164:167], v[36:39], v[76:79]
    buffer_load_dwordx4 v[148:151], v18, s[16:19], s80 offen offset:0 sc1
    s_waitcnt lgkmcnt(0)
    v_mfma_f32_16x16x32_bf16 v[56:59], a[168:171], v[40:43], v[56:59]
    v_add_f32 v83, v83, v91
    s_waitcnt vmcnt(28)
    v_add_f32 v84, v84, v92
    v_mfma_f32_16x16x32_bf16 v[56:59], a[180:183], v[48:51], v[56:59]
    ds_read_b128 v[24:27], v18 offset:16384
    v_add_f32 v85, v85, v93
    v_mfma_f32_16x16x32_bf16 v[60:63], a[172:175], v[40:43], v[60:63]
    v_add_f32 v86, v86, v94
    v_add_f32 v87, v87, v95
    v_mfma_f32_16x16x32_bf16 v[60:63], a[184:187], v[48:51], v[60:63]
    s_waitcnt vmcnt(19)
    s_barrier
    ds_read_b128 v[32:35], v18 offset:17408
    v_mfma_f32_16x16x32_bf16 v[64:67], a[176:179], v[40:43], v[64:67]
    ds_read_b64_tr_b16 a[204:205], v14 offset:36864
    ds_read_b64_tr_b16 a[206:207], v14 offset:37632
    v_mfma_f32_16x16x32_bf16 v[64:67], a[188:191], v[48:51], v[64:67]
    ds_read_b128 v[28:31], v18 offset:36864
    ds_read_b64_tr_b16 a[208:209], v14 offset:43008
    v_mfma_f32_16x16x32_bf16 v[68:71], a[168:171], v[44:47], v[68:71]
    ds_read_b64_tr_b16 a[210:211], v14 offset:43776
    ds_read_b64_tr_b16 a[212:213], v15 offset:36864
    v_mfma_f32_16x16x32_bf16 v[68:71], a[180:183], v[52:55], v[68:71]
    ds_read_b64_tr_b16 a[214:215], v15 offset:37632
    ds_read_b64_tr_b16 a[216:217], v16 offset:0
    v_mfma_f32_16x16x32_bf16 v[72:75], a[172:175], v[44:47], v[72:75]
    ds_read_b128 v[36:39], v18 offset:37888
    ds_read_b64_tr_b16 a[218:219], v16 offset:768
    v_mfma_f32_16x16x32_bf16 v[72:75], a[184:187], v[52:55], v[72:75]
    ds_read_b64_tr_b16 a[220:221], v16 offset:6144
    ds_read_b64_tr_b16 a[222:223], v16 offset:6912
    v_mfma_f32_16x16x32_bf16 v[76:79], a[176:179], v[44:47], v[76:79]
    ds_read_b64_tr_b16 a[224:225], v17 offset:0
    ds_read_b64_tr_b16 a[226:227], v17 offset:768
    v_mfma_f32_16x16x32_bf16 v[76:79], a[188:191], v[52:55], v[76:79]
    ds_read_b64_tr_b16 a[228:229], v16 offset:12288
    s_waitcnt lgkmcnt(6)
    v_mfma_f32_16x16x32_bf16 v[56:59], a[192:195], v[24:27], v[56:59]
    ds_read_b64_tr_b16 a[230:231], v16 offset:13056
    ds_read_b64_tr_b16 a[232:233], v16 offset:18432
    v_mfma_f32_16x16x32_bf16 v[56:59], a[204:207], v[32:35], v[56:59]
    ds_read_b128 v[40:43], v18 offset:18432
    ds_read_b64_tr_b16 a[234:235], v16 offset:19200
    v_mfma_f32_16x16x32_bf16 v[60:63], a[196:199], v[24:27], v[60:63]
    ds_read_b64_tr_b16 a[236:237], v17 offset:12288
    ds_read_b64_tr_b16 a[238:239], v17 offset:13056
    v_mfma_f32_16x16x32_bf16 v[60:63], a[208:211], v[32:35], v[60:63]
    ds_read_b128 v[48:51], v18 offset:19456
    v_cvt_pk_bf16_f32 v80, v80, v81
    v_mfma_f32_16x16x32_bf16 v[64:67], a[200:203], v[24:27], v[64:67]
    v_cvt_pk_bf16_f32 v81, v82, v83
    v_cvt_pk_bf16_f32 v82, v84, v85
    v_mfma_f32_16x16x32_bf16 v[64:67], a[212:215], v[32:35], v[64:67]
    ds_read_b128 v[44:47], v18 offset:38912
    v_cvt_pk_bf16_f32 v83, v86, v87
    v_mfma_f32_16x16x32_bf16 v[68:71], a[192:195], v[28:31], v[68:71]
    v_accvgpr_write_b32 a252, v80
    v_accvgpr_write_b32 a253, v81
    v_mfma_f32_16x16x32_bf16 v[68:71], a[204:207], v[36:39], v[68:71]
    v_accvgpr_write_b32 a254, v82
    v_accvgpr_write_b32 a255, v83
    v_mfma_f32_16x16x32_bf16 v[72:75], a[196:199], v[28:31], v[72:75]
    ds_read_b128 v[52:55], v18 offset:39936
    v_mov_b32 v12, 1024
    v_mfma_f32_16x16x32_bf16 v[72:75], a[208:211], v[36:39], v[72:75]
    v_cndmask_b32 v23, v23, v12, vcc
    v_cmp_eq_u32 vcc, 1, v20
    v_mfma_f32_16x16x32_bf16 v[76:79], a[200:203], v[28:31], v[76:79]
    s_nop 0
    v_cndmask_b32 v12, v22, v23, vcc
    v_mul_u32_u24 v12, 1280, v12
    v_mfma_f32_16x16x32_bf16 v[76:79], a[212:215], v[36:39], v[76:79]
    v_add_u32 v12, v12, v21
    s_waitcnt lgkmcnt(0)
    v_mfma_f32_16x16x32_bf16 v[56:59], a[216:219], v[40:43], v[56:59]
    v_add_u32 v22, 512, v22
    v_sub_u32 v23, 2048, v22
    s_waitcnt vmcnt(9)
    s_waitcnt lgkmcnt(0)
    s_barrier
    v_mfma_f32_16x16x32_bf16 v[56:59], a[228:231], v[48:51], v[56:59]
    ds_read_b128 v[24:27], v255 offset:0
    v_cmp_eq_u32 vcc, 1, v20
    v_mfma_f32_16x16x32_bf16 v[60:63], a[220:223], v[40:43], v[60:63]
    s_nop 0
    v_cndmask_b32 v13, v22, v23, vcc
    v_mul_u32_u24 v13, 1280, v13
    v_mfma_f32_16x16x32_bf16 v[60:63], a[232:235], v[48:51], v[60:63]
    ds_read_b128 v[32:35], v255 offset:1024
    v_add_u32 v13, v13, v21
    v_mfma_f32_16x16x32_bf16 v[64:67], a[224:227], v[40:43], v[64:67]
    v_add_u32 v22, 512, v22
    v_add_u32 v22, s53, v22
    v_mfma_f32_16x16x32_bf16 v[64:67], a[236:239], v[48:51], v[64:67]
    ds_read_b128 v[28:31], v255 offset:20480
    v_sub_u32 v23, 2048, v22
    v_mfma_f32_16x16x32_bf16 v[68:71], a[216:219], v[44:47], v[68:71]
    v_cmp_eq_u32 vcc, 1, v20
    s_nop 1
    v_cndmask_b32 v16, v22, v23, vcc
    v_mfma_f32_16x16x32_bf16 v[68:71], a[228:231], v[52:55], v[68:71]
    v_mul_u32_u24 v16, 1280, v16
    v_add_u32 v16, v16, v21
    v_mfma_f32_16x16x32_bf16 v[72:75], a[220:223], v[44:47], v[72:75]
    ds_read_b128 v[36:39], v255 offset:21504
    v_add_u32 v22, 512, v22
    v_mfma_f32_16x16x32_bf16 v[72:75], a[232:235], v[52:55], v[72:75]
    v_sub_u32 v23, 2048, v22
    v_cmp_eq_u32 vcc, 1, v20
    v_mfma_f32_16x16x32_bf16 v[76:79], a[224:227], v[44:47], v[76:79]
    s_nop 0
    v_cndmask_b32 v17, v22, v23, vcc
    v_mul_u32_u24 v17, 1280, v17
    v_mfma_f32_16x16x32_bf16 v[76:79], a[236:239], v[52:55], v[76:79]
    v_add_u32 v17, v17, v21
    s_mul_i32 s84, s12, 163840
    s_add_u32 s84, s84, 3145728
    s_mul_i32 s64, s3, 6400
    v_add_u32 v15, s85, v18
    v_lshlrev_b32 v14, 2, v1
    s_waitcnt lgkmcnt(0)
    v_mfma_f32_16x16x32_bf16 v[80:83], a[0:3], v[24:27], 0
    s_add_u32 m0, s77, 0
    v_permlane32_swap_b32 v64, v76
    v_mfma_f32_16x16x32_bf16 v[80:83], a[12:15], v[32:35], v[80:83]
    ds_read_b128 v[40:43], v255 offset:2048
    s_add_u32 s81, s76, 81920
    v_mfma_f32_16x16x32_bf16 v[84:87], a[4:7], v[24:27], 0
    buffer_load_dwordx4 v18, s[16:19], s81 offen offset:0 sc1 lds
    v_permlane32_swap_b32 v65, v77
    v_mfma_f32_16x16x32_bf16 v[84:87], a[16:19], v[32:35], v[84:87]
    ds_read_b128 v[48:51], v255 offset:3072
    v_permlane32_swap_b32 v66, v78
    v_mfma_f32_16x16x32_bf16 v[88:91], a[8:11], v[24:27], 0
    v_permlane32_swap_b32 v67, v79
    v_mul_f32 v104, v56, v56
    v_mfma_f32_16x16x32_bf16 v[88:91], a[20:23], v[32:35], v[88:91]
    ds_read_b128 v[44:47], v255 offset:22528
    v_mul_f32 v105, v57, v57
    v_mfma_f32_16x16x32_bf16 v[92:95], a[0:3], v[28:31], 0
    buffer_load_dwordx4 v18, s[16:19], s81 offen offset:1024 sc1 lds
    v_mul_f32 v106, v58, v58
    v_mfma_f32_16x16x32_bf16 v[92:95], a[12:15], v[36:39], v[92:95]
    v_mul_f32 v107, v59, v59
    v_fma_f32 v104, v104, v254, v250
    v_mfma_f32_16x16x32_bf16 v[96:99], a[4:7], v[28:31], 0
    ds_read_b128 v[52:55], v255 offset:23552
    v_fma_f32 v105, v105, v254, v250
    v_mfma_f32_16x16x32_bf16 v[96:99], a[16:19], v[36:39], v[96:99]
    v_fma_f32 v106, v106, v254, v250
    v_fma_f32 v107, v107, v254, v250
    v_mfma_f32_16x16x32_bf16 v[100:103], a[8:11], v[28:31], 0
    buffer_load_dwordx4 v18, s[16:19], s81 offen offset:2048 sc1 lds
    v_mul_f32 v104, v104, v56
    v_mfma_f32_16x16x32_bf16 v[100:103], a[20:23], v[36:39], v[100:103]
    v_mul_f32 v105, v105, v57
    s_waitcnt lgkmcnt(0)
    v_mfma_f32_16x16x32_bf16 v[80:83], a[24:27], v[40:43], v[80:83]
    v_mul_f32 v106, v106, v58
    v_mul_f32 v107, v107, v59
    v_mfma_f32_16x16x32_bf16 v[80:83], a[36:39], v[48:51], v[80:83]
    ds_read_b128 v[24:27], v255 offset:4096
    v_mfma_f32_16x16x32_bf16 v[84:87], a[28:31], v[40:43], v[84:87]
    buffer_load_dwordx4 v18, s[16:19], s81 offen offset:3072 sc1 lds
    v_mfma_f32_16x16x32_bf16 v[84:87], a[40:43], v[48:51], v[84:87]
    ds_read_b128 v[32:35], v255 offset:5120
    s_add_u32 m0, s77, 4096
    v_mfma_f32_16x16x32_bf16 v[88:91], a[32:35], v[40:43], v[88:91]
    s_add_u32 s81, s76, 86016
    v_mfma_f32_16x16x32_bf16 v[88:91], a[44:47], v[48:51], v[88:91]
    ds_read_b128 v[28:31], v255 offset:24576
    v_mfma_f32_16x16x32_bf16 v[92:95], a[24:27], v[44:47], v[92:95]
    buffer_load_dwordx4 v18, s[16:19], s81 offen offset:0 sc1 lds
    v_mfma_f32_16x16x32_bf16 v[92:95], a[36:39], v[52:55], v[92:95]
    v_exp_f32 v104, v104
    v_mfma_f32_16x16x32_bf16 v[96:99], a[28:31], v[44:47], v[96:99]
    ds_read_b128 v[36:39], v255 offset:25600
    v_mfma_f32_16x16x32_bf16 v[96:99], a[40:43], v[52:55], v[96:99]
    v_exp_f32 v105, v105
    v_mfma_f32_16x16x32_bf16 v[100:103], a[32:35], v[44:47], v[100:103]
    buffer_load_dwordx4 v18, s[16:19], s81 offen offset:1024 sc1 lds
    v_mfma_f32_16x16x32_bf16 v[100:103], a[44:47], v[52:55], v[100:103]
    s_waitcnt lgkmcnt(0)
    v_mfma_f32_16x16x32_bf16 v[80:83], a[48:51], v[24:27], v[80:83]
    v_exp_f32 v106, v106
    v_mfma_f32_16x16x32_bf16 v[80:83], a[60:63], v[32:35], v[80:83]
    ds_read_b128 v[40:43], v255 offset:6144
    v_mfma_f32_16x16x32_bf16 v[84:87], a[52:55], v[24:27], v[84:87]
    buffer_load_dwordx4 v18, s[16:19], s81 offen offset:2048 sc1 lds
    v_mfma_f32_16x16x32_bf16 v[84:87], a[64:67], v[32:35], v[84:87]
    ds_read_b128 v[48:51], v255 offset:7168
    v_mfma_f32_16x16x32_bf16 v[88:91], a[56:59], v[24:27], v[88:91]
    v_exp_f32 v107, v107
    v_mfma_f32_16x16x32_bf16 v[88:91], a[68:71], v[32:35], v[88:91]
    ds_read_b128 v[44:47], v255 offset:26624
    v_mul_f32 v56, v56, v60
    v_mfma_f32_16x16x32_bf16 v[92:95], a[48:51], v[28:31], v[92:95]
    buffer_load_dwordx4 v18, s[16:19], s81 offen offset:3072 sc1 lds
    v_mul_f32 v57, v57, v61
    v_mfma_f32_16x16x32_bf16 v[92:95], a[60:63], v[36:39], v[92:95]
    s_add_u32 m0, s77, 8192
    v_mul_f32 v58, v58, v62
    v_mfma_f32_16x16x32_bf16 v[96:99], a[52:55], v[28:31], v[96:99]
    ds_read_b128 v[52:55], v255 offset:27648
    s_add_u32 s81, s76, 90112
    v_mfma_f32_16x16x32_bf16 v[96:99], a[64:67], v[36:39], v[96:99]
    v_mul_f32 v59, v59, v63
    v_add_f32 v104, 1.0, v104
    v_mfma_f32_16x16x32_bf16 v[100:103], a[56:59], v[28:31], v[100:103]
    buffer_load_dwordx4 v18, s[16:19], s81 offen offset:0 sc1 lds
    v_add_f32 v105, 1.0, v105
    v_mfma_f32_16x16x32_bf16 v[100:103], a[68:71], v[36:39], v[100:103]
    v_add_f32 v106, 1.0, v106
    s_waitcnt lgkmcnt(0)
    v_mfma_f32_16x16x32_bf16 v[80:83], a[72:75], v[40:43], v[80:83]
    v_add_f32 v107, 1.0, v107
    v_mfma_f32_16x16x32_bf16 v[80:83], a[84:87], v[48:51], v[80:83]
    ds_read_b128 v[24:27], v255 offset:8192
    v_mfma_f32_16x16x32_bf16 v[84:87], a[76:79], v[40:43], v[84:87]
    buffer_load_dwordx4 v18, s[16:19], s81 offen offset:1024 sc1 lds
    v_mfma_f32_16x16x32_bf16 v[84:87], a[88:91], v[48:51], v[84:87]
    ds_read_b128 v[32:35], v255 offset:9216
    s_add_u32 m0, s85, -1024
    v_mfma_f32_16x16x32_bf16 v[88:91], a[80:83], v[40:43], v[88:91]
    s_add_u32 s80, s88, 32768
    v_mfma_f32_16x16x32_bf16 v[88:91], a[92:95], v[48:51], v[88:91]
    ds_read_b128 v[28:31], v255 offset:28672
    v_mfma_f32_16x16x32_bf16 v[92:95], a[72:75], v[44:47], v[92:95]
    buffer_load_dwordx4 v18, s[16:19], s80 offen offset:1024 sc1 lds
    v_mfma_f32_16x16x32_bf16 v[92:95], a[84:87], v[52:55], v[92:95]
    s_add_u32 m0, s85, -1024
    v_mfma_f32_16x16x32_bf16 v[96:99], a[76:79], v[44:47], v[96:99]
    ds_read_b128 v[36:39], v255 offset:29696
    v_mfma_f32_16x16x32_bf16 v[96:99], a[88:91], v[52:55], v[96:99]
    v_rcp_f32 v104, v104
    v_mfma_f32_16x16x32_bf16 v[100:103], a[80:83], v[44:47], v[100:103]
    buffer_load_dwordx4 v18, s[16:19], s80 offen offset:2048 sc1 lds
    v_mfma_f32_16x16x32_bf16 v[100:103], a[92:95], v[52:55], v[100:103]
    s_add_u32 m0, s85, -1024
    s_waitcnt lgkmcnt(0)
    v_mfma_f32_16x16x32_bf16 v[80:83], a[96:99], v[24:27], v[80:83]
    v_rcp_f32 v105, v105
    v_mfma_f32_16x16x32_bf16 v[80:83], a[108:111], v[32:35], v[80:83]
    ds_read_b128 v[40:43], v255 offset:10240
    v_mfma_f32_16x16x32_bf16 v[84:87], a[100:103], v[24:27], v[84:87]
    buffer_load_dwordx4 v18, s[16:19], s80 offen offset:3072 sc1 lds
    v_mfma_f32_16x16x32_bf16 v[84:87], a[112:115], v[32:35], v[84:87]
    ds_read_b128 v[48:51], v255 offset:11264
    s_add_u32 m0, s85, 3072
    v_mfma_f32_16x16x32_bf16 v[88:91], a[104:107], v[24:27], v[88:91]
    s_add_u32 s80, s88, 36864
    v_mfma_f32_16x16x32_bf16 v[88:91], a[116:119], v[32:35], v[88:91]
    ds_read_b128 v[44:47], v255 offset:30720
    v_mfma_f32_16x16x32_bf16 v[92:95], a[96:99], v[28:31], v[92:95]
    buffer_load_dwordx4 v18, s[16:19], s80 offen offset:0 sc1 lds
    v_mfma_f32_16x16x32_bf16 v[92:95], a[108:111], v[36:39], v[92:95]
    s_add_u32 m0, s85, 3072
    v_mfma_f32_16x16x32_bf16 v[96:99], a[100:103], v[28:31], v[96:99]
    ds_read_b128 v[52:55], v255 offset:31744
    v_mfma_f32_16x16x32_bf16 v[96:99], a[112:115], v[36:39], v[96:99]
    v_rcp_f32 v106, v106
    v_mfma_f32_16x16x32_bf16 v[100:103], a[104:107], v[28:31], v[100:103]
    buffer_load_dwordx4 v18, s[16:19], s80 offen offset:1024 sc1 lds
    v_mfma_f32_16x16x32_bf16 v[100:103], a[116:119], v[36:39], v[100:103]
    s_add_u32 m0, s85, 3072
    s_waitcnt lgkmcnt(0)
    v_mfma_f32_16x16x32_bf16 v[80:83], a[120:123], v[40:43], v[80:83]
    v_rcp_f32 v107, v107
    v_mfma_f32_16x16x32_bf16 v[80:83], a[132:135], v[48:51], v[80:83]
    ds_read_b128 v[24:27], v255 offset:12288
    v_mul_f32 v56, v56, v104
    v_mfma_f32_16x16x32_bf16 v[84:87], a[124:127], v[40:43], v[84:87]
    buffer_load_dwordx4 v18, s[16:19], s80 offen offset:2048 sc1 lds
    v_mul_f32 v57, v57, v105
    v_mfma_f32_16x16x32_bf16 v[84:87], a[136:139], v[48:51], v[84:87]
    ds_read_b128 v[32:35], v255 offset:13312
    s_add_u32 m0, s85, 3072
    v_mfma_f32_16x16x32_bf16 v[88:91], a[128:131], v[40:43], v[88:91]
    v_mul_f32 v58, v58, v106
    v_mul_f32 v59, v59, v107
    v_mfma_f32_16x16x32_bf16 v[88:91], a[140:143], v[48:51], v[88:91]
    ds_read_b128 v[28:31], v255 offset:32768
    v_cvt_pk_bf16_f32 v108, v56, v57
    v_mfma_f32_16x16x32_bf16 v[92:95], a[120:123], v[44:47], v[92:95]
    buffer_load_dwordx4 v18, s[16:19], s80 offen offset:3072 sc1 lds
    v_cvt_pk_bf16_f32 v109, v58, v59
    v_mfma_f32_16x16x32_bf16 v[92:95], a[132:135], v[52:55], v[92:95]
    s_add_u32 m0, s85, 7168
    v_mul_f32 v104, v68, v68
    v_mfma_f32_16x16x32_bf16 v[96:99], a[124:127], v[44:47], v[96:99]
    ds_read_b128 v[36:39], v255 offset:33792
    s_add_u32 s80, s88, 40960
    v_mfma_f32_16x16x32_bf16 v[96:99], a[136:139], v[52:55], v[96:99]
    v_mul_f32 v105, v69, v69
    v_mul_f32 v106, v70, v70
    v_mfma_f32_16x16x32_bf16 v[100:103], a[128:131], v[44:47], v[100:103]
    buffer_load_dwordx4 v18, s[16:19], s80 offen offset:0 sc1 lds
    v_mul_f32 v107, v71, v71
    v_mfma_f32_16x16x32_bf16 v[100:103], a[140:143], v[52:55], v[100:103]
    s_add_u32 m0, s85, 7168
    s_waitcnt lgkmcnt(0)
    v_mfma_f32_16x16x32_bf16 v[80:83], a[144:147], v[24:27], v[80:83]
    v_fma_f32 v104, v104, v254, v250
    v_fma_f32 v105, v105, v254, v250
    v_mfma_f32_16x16x32_bf16 v[80:83], a[156:159], v[32:35], v[80:83]
    ds_read_b128 v[40:43], v255 offset:14336
    v_fma_f32 v106, v106, v254, v250
    v_mfma_f32_16x16x32_bf16 v[84:87], a[148:151], v[24:27], v[84:87]
    buffer_load_dwordx4 v18, s[16:19], s80 offen offset:1024 sc1 lds
    v_fma_f32 v107, v107, v254, v250
    v_mfma_f32_16x16x32_bf16 v[84:87], a[160:163], v[32:35], v[84:87]
    ds_read_b128 v[48:51], v255 offset:15360
    s_add_u32 m0, s85, 7168
    v_mfma_f32_16x16x32_bf16 v[88:91], a[152:155], v[24:27], v[88:91]
    v_mul_f32 v104, v104, v68
    v_mul_f32 v105, v105, v69
    v_mfma_f32_16x16x32_bf16 v[88:91], a[164:167], v[32:35], v[88:91]
    ds_read_b128 v[44:47], v255 offset:34816
    v_mul_f32 v106, v106, v70
    v_mfma_f32_16x16x32_bf16 v[92:95], a[144:147], v[28:31], v[92:95]
    buffer_load_dwordx4 v18, s[16:19], s80 offen offset:2048 sc1 lds
    v_mul_f32 v107, v107, v71
    v_mfma_f32_16x16x32_bf16 v[92:95], a[156:159], v[36:39], v[92:95]
    s_add_u32 m0, s85, 7168
    v_mfma_f32_16x16x32_bf16 v[96:99], a[148:151], v[28:31], v[96:99]
    ds_read_b128 v[52:55], v255 offset:35840
    v_mfma_f32_16x16x32_bf16 v[96:99], a[160:163], v[36:39], v[96:99]
    v_exp_f32 v104, v104
    v_mfma_f32_16x16x32_bf16 v[100:103], a[152:155], v[28:31], v[100:103]
    buffer_load_dwordx4 v18, s[16:19], s80 offen offset:3072 sc1 lds
    v_mfma_f32_16x16x32_bf16 v[100:103], a[164:167], v[36:39], v[100:103]
    s_add_u32 m0, s85, 11264
    s_waitcnt lgkmcnt(0)
    v_mfma_f32_16x16x32_bf16 v[80:83], a[168:171], v[40:43], v[80:83]
    s_add_u32 s80, s88, 45056
    v_mfma_f32_16x16x32_bf16 v[80:83], a[180:183], v[48:51], v[80:83]
    ds_read_b128 v[24:27], v255 offset:16384
    v_mfma_f32_16x16x32_bf16 v[84:87], a[172:175], v[40:43], v[84:87]
    buffer_load_dwordx4 v18, s[16:19], s80 offen offset:0 sc1 lds
    v_mfma_f32_16x16x32_bf16 v[84:87], a[184:187], v[48:51], v[84:87]
    ds_read_b128 v[32:35], v255 offset:17408
    s_add_u32 m0, s85, 11264
    v_mfma_f32_16x16x32_bf16 v[88:91], a[176:179], v[40:43], v[88:91]
    v_exp_f32 v105, v105
    v_mfma_f32_16x16x32_bf16 v[88:91], a[188:191], v[48:51], v[88:91]
    ds_read_b128 v[28:31], v255 offset:36864
    v_mfma_f32_16x16x32_bf16 v[92:95], a[168:171], v[44:47], v[92:95]
    buffer_load_dwordx4 v18, s[16:19], s80 offen offset:1024 sc1 lds
    v_mfma_f32_16x16x32_bf16 v[92:95], a[180:183], v[52:55], v[92:95]
    s_add_u32 m0, s85, 11264
    v_mfma_f32_16x16x32_bf16 v[96:99], a[172:175], v[44:47], v[96:99]
    ds_read_b128 v[36:39], v255 offset:37888
    v_mfma_f32_16x16x32_bf16 v[96:99], a[184:187], v[52:55], v[96:99]
    v_exp_f32 v106, v106
    v_mfma_f32_16x16x32_bf16 v[100:103], a[176:179], v[44:47], v[100:103]
    buffer_load_dwordx4 v18, s[16:19], s80 offen offset:2048 sc1 lds
    v_mfma_f32_16x16x32_bf16 v[100:103], a[188:191], v[52:55], v[100:103]
    s_add_u32 s80, s88, 8192
    s_waitcnt lgkmcnt(0)
    v_mfma_f32_16x16x32_bf16 v[80:83], a[192:195], v[24:27], v[80:83]
    v_exp_f32 v107, v107
    v_mfma_f32_16x16x32_bf16 v[80:83], a[204:207], v[32:35], v[80:83]
    ds_read_b128 v[40:43], v255 offset:18432
    v_mul_f32 v68, v68, v72
    v_mfma_f32_16x16x32_bf16 v[84:87], a[196:199], v[24:27], v[84:87]
    buffer_load_dwordx4 v[152:155], v18, s[16:19], s80 offen offset:1024 sc1
    v_mul_f32 v69, v69, v73
    v_mfma_f32_16x16x32_bf16 v[84:87], a[208:211], v[32:35], v[84:87]
    ds_read_b128 v[48:51], v255 offset:19456
    v_mul_f32 v70, v70, v74
    v_mfma_f32_16x16x32_bf16 v[88:91], a[200:203], v[24:27], v[88:91]
    v_mul_f32 v71, v71, v75
    v_add_f32 v104, 1.0, v104
    v_mfma_f32_16x16x32_bf16 v[88:91], a[212:215], v[32:35], v[88:91]
    ds_read_b128 v[44:47], v255 offset:38912
    v_add_f32 v105, 1.0, v105
    v_mfma_f32_16x16x32_bf16 v[92:95], a[192:195], v[28:31], v[92:95]
    buffer_load_dwordx4 v[156:159], v18, s[16:19], s80 offen offset:2048 sc1
    v_add_f32 v106, 1.0, v106
    v_mfma_f32_16x16x32_bf16 v[92:95], a[204:207], v[36:39], v[92:95]
    v_add_f32 v107, 1.0, v107
    v_mfma_f32_16x16x32_bf16 v[96:99], a[196:199], v[28:31], v[96:99]
    ds_read_b128 v[52:55], v255 offset:39936
    v_mfma_f32_16x16x32_bf16 v[96:99], a[208:211], v[36:39], v[96:99]
    v_rcp_f32 v104, v104
    v_mfma_f32_16x16x32_bf16 v[100:103], a[200:203], v[28:31], v[100:103]
    buffer_load_dwordx4 v[160:163], v18, s[16:19], s80 offen offset:3072 sc1
    v_mfma_f32_16x16x32_bf16 v[100:103], a[212:215], v[36:39], v[100:103]
    s_waitcnt lgkmcnt(0)
    v_mfma_f32_16x16x32_bf16 v[80:83], a[216:219], v[40:43], v[80:83]
    v_rcp_f32 v105, v105
    s_waitcnt vmcnt(17)
    s_barrier
    v_mfma_f32_16x16x32_bf16 v[80:83], a[228:231], v[48:51], v[80:83]
    ds_read_b128 v[24:27], v18 offset:0
    v_mfma_f32_16x16x32_bf16 v[84:87], a[220:223], v[40:43], v[84:87]
    v_rcp_f32 v106, v106
    v_mfma_f32_16x16x32_bf16 v[84:87], a[232:235], v[48:51], v[84:87]
    ds_read_b128 v[32:35], v18 offset:1024
    v_mfma_f32_16x16x32_bf16 v[88:91], a[224:227], v[40:43], v[88:91]
    v_rcp_f32 v107, v107
    v_mfma_f32_16x16x32_bf16 v[88:91], a[236:239], v[48:51], v[88:91]
    ds_read_b128 v[28:31], v18 offset:20480
    v_mul_f32 v68, v68, v104
    v_mfma_f32_16x16x32_bf16 v[92:95], a[216:219], v[44:47], v[92:95]
    v_mul_f32 v69, v69, v105
    v_mul_f32 v70, v70, v106
    v_mfma_f32_16x16x32_bf16 v[92:95], a[228:231], v[52:55], v[92:95]
    v_mul_f32 v71, v71, v107
    v_cvt_pk_bf16_f32 v110, v68, v69
    v_mfma_f32_16x16x32_bf16 v[96:99], a[220:223], v[44:47], v[96:99]
    ds_read_b128 v[36:39], v18 offset:21504
    v_cvt_pk_bf16_f32 v111, v70, v71
    v_mfma_f32_16x16x32_bf16 v[96:99], a[232:235], v[52:55], v[96:99]
    s_add_u32 s82, s75, s66
    s_add_u32 s82, s82, 9437184
    v_mfma_f32_16x16x32_bf16 v[100:103], a[224:227], v[44:47], v[100:103]
    v_permlane16_swap_b32 v108, v110
    v_permlane16_swap_b32 v109, v111
    v_mfma_f32_16x16x32_bf16 v[100:103], a[236:239], v[52:55], v[100:103]
    buffer_store_dwordx4 v[108:111], v248, s[16:19], s82 offen sc1
    v_mul_f32 v104, v64, v64
    v_mul_f32 v105, v65, v65
    v_mul_f32 v106, v66, v66
    v_mul_f32 v107, v67, v67
    v_fma_f32 v104, v104, v254, v250
    v_fma_f32 v105, v105, v254, v250
    v_fma_f32 v106, v106, v254, v250
    v_fma_f32 v107, v107, v254, v250
    v_mul_f32 v104, v104, v64
    v_mul_f32 v105, v105, v65
    v_mul_f32 v106, v106, v66
    v_mul_f32 v107, v107, v67
    v_exp_f32 v104, v104
    v_exp_f32 v105, v105
    v_exp_f32 v106, v106
    v_exp_f32 v107, v107
    v_mul_f32 v64, v64, v76
    v_mul_f32 v65, v65, v77
    v_mul_f32 v66, v66, v78
    v_mul_f32 v67, v67, v79
    v_add_f32 v104, 1.0, v104
    v_add_f32 v105, 1.0, v105
    v_add_f32 v106, 1.0, v106
    v_add_f32 v107, 1.0, v107
    v_rcp_f32 v104, v104
    v_rcp_f32 v105, v105
    v_rcp_f32 v106, v106
    v_rcp_f32 v107, v107
    v_mul_f32 v64, v64, v104
    v_mul_f32 v65, v65, v105
    v_mul_f32 v66, v66, v106
    v_mul_f32 v67, v67, v107
    v_cvt_pk_bf16_f32 v112, v64, v65
    v_cvt_pk_bf16_f32 v113, v66, v67
    buffer_store_dwordx2 v[112:113], v249, s[16:19], s82 offen offset:512 sc1
    s_waitcnt lgkmcnt(0)
    v_mfma_f32_16x16x32_bf16 v[56:59], a[0:3], v[24:27], 0
    s_add_u32 m0, s77, 40960
    v_permlane32_swap_b32 v88, v100
    v_mfma_f32_16x16x32_bf16 v[56:59], a[12:15], v[32:35], v[56:59]
    ds_read_b128 v[40:43], v18 offset:2048
    s_add_u32 s81, s76, 122880
    v_mfma_f32_16x16x32_bf16 v[60:63], a[4:7], v[24:27], 0
    buffer_load_dwordx4 v18, s[16:19], s81 offen offset:0 sc1 lds
    v_permlane32_swap_b32 v89, v101
    v_mfma_f32_16x16x32_bf16 v[60:63], a[16:19], v[32:35], v[60:63]
    ds_read_b128 v[48:51], v18 offset:3072
    v_permlane32_swap_b32 v90, v102
    v_mfma_f32_16x16x32_bf16 v[64:67], a[8:11], v[24:27], 0
    v_permlane32_swap_b32 v91, v103
    v_mul_f32 v104, v80, v80
    v_mfma_f32_16x16x32_bf16 v[64:67], a[20:23], v[32:35], v[64:67]
    ds_read_b128 v[44:47], v18 offset:22528
    v_mul_f32 v105, v81, v81
    v_mfma_f32_16x16x32_bf16 v[68:71], a[0:3], v[28:31], 0
    buffer_load_dwordx4 v18, s[16:19], s81 offen offset:1024 sc1 lds
    v_mul_f32 v106, v82, v82
    v_mfma_f32_16x16x32_bf16 v[68:71], a[12:15], v[36:39], v[68:71]
    v_mul_f32 v107, v83, v83
    v_fma_f32 v104, v104, v254, v250
    v_mfma_f32_16x16x32_bf16 v[72:75], a[4:7], v[28:31], 0
    ds_read_b128 v[52:55], v18 offset:23552
    v_fma_f32 v105, v105, v254, v250
    v_mfma_f32_16x16x32_bf16 v[72:75], a[16:19], v[36:39], v[72:75]
    v_fma_f32 v106, v106, v254, v250
    v_fma_f32 v107, v107, v254, v250
    v_mfma_f32_16x16x32_bf16 v[76:79], a[8:11], v[28:31], 0
    buffer_load_dwordx4 v18, s[16:19], s81 offen offset:2048 sc1 lds
    v_mul_f32 v104, v104, v80
adaLN_cond__spectral_fnet__geglu_ffn__prompt_kernel_hop7:
    s_cbranch_execz adaLN_cond__spectral_fnet__geglu_ffn__prompt_kernel_back12
    v_mfma_f32_16x16x32_bf16 v[76:79], a[20:23], v[36:39], v[76:79]
    v_mul_f32 v105, v105, v81
    s_waitcnt lgkmcnt(0)
    v_mfma_f32_16x16x32_bf16 v[56:59], a[24:27], v[40:43], v[56:59]
    v_mul_f32 v106, v106, v82
    v_mul_f32 v107, v107, v83
    v_mfma_f32_16x16x32_bf16 v[56:59], a[36:39], v[48:51], v[56:59]
    ds_read_b128 v[24:27], v18 offset:4096
    v_mfma_f32_16x16x32_bf16 v[60:63], a[28:31], v[40:43], v[60:63]
    buffer_load_dwordx4 v18, s[16:19], s81 offen offset:3072 sc1 lds
    v_mfma_f32_16x16x32_bf16 v[60:63], a[40:43], v[48:51], v[60:63]
    ds_read_b128 v[32:35], v18 offset:5120
    s_add_u32 m0, s77, 45056
    v_mfma_f32_16x16x32_bf16 v[64:67], a[32:35], v[40:43], v[64:67]
    s_add_u32 s81, s76, 126976
    v_mfma_f32_16x16x32_bf16 v[64:67], a[44:47], v[48:51], v[64:67]
    ds_read_b128 v[28:31], v18 offset:24576
    v_mfma_f32_16x16x32_bf16 v[68:71], a[24:27], v[44:47], v[68:71]
    buffer_load_dwordx4 v18, s[16:19], s81 offen offset:0 sc1 lds
    v_mfma_f32_16x16x32_bf16 v[68:71], a[36:39], v[52:55], v[68:71]
    v_exp_f32 v104, v104
    v_mfma_f32_16x16x32_bf16 v[72:75], a[28:31], v[44:47], v[72:75]
    ds_read_b128 v[36:39], v18 offset:25600
    v_mfma_f32_16x16x32_bf16 v[72:75], a[40:43], v[52:55], v[72:75]
    v_exp_f32 v105, v105
    v_mfma_f32_16x16x32_bf16 v[76:79], a[32:35], v[44:47], v[76:79]
    buffer_load_dwordx4 v18, s[16:19], s81 offen offset:1024 sc1 lds
    v_mfma_f32_16x16x32_bf16 v[76:79], a[44:47], v[52:55], v[76:79]
    s_waitcnt lgkmcnt(0)
    v_mfma_f32_16x16x32_bf16 v[56:59], a[48:51], v[24:27], v[56:59]
    v_exp_f32 v106, v106
    v_mfma_f32_16x16x32_bf16 v[56:59], a[60:63], v[32:35], v[56:59]
    ds_read_b128 v[40:43], v18 offset:6144
    v_mfma_f32_16x16x32_bf16 v[60:63], a[52:55], v[24:27], v[60:63]
    buffer_load_dwordx4 v18, s[16:19], s81 offen offset:2048 sc1 lds
    v_mfma_f32_16x16x32_bf16 v[60:63], a[64:67], v[32:35], v[60:63]
    ds_read_b128 v[48:51], v18 offset:7168
    v_mfma_f32_16x16x32_bf16 v[64:67], a[56:59], v[24:27], v[64:67]
    v_exp_f32 v107, v107
    v_mfma_f32_16x16x32_bf16 v[64:67], a[68:71], v[32:35], v[64:67]
    ds_read_b128 v[44:47], v18 offset:26624
    v_mul_f32 v80, v80, v84
    v_mfma_f32_16x16x32_bf16 v[68:71], a[48:51], v[28:31], v[68:71]
    buffer_load_dwordx4 v18, s[16:19], s81 offen offset:3072 sc1 lds
    v_mul_f32 v81, v81, v85
    v_mfma_f32_16x16x32_bf16 v[68:71], a[60:63], v[36:39], v[68:71]
    s_add_u32 m0, s77, 49152
    v_mul_f32 v82, v82, v86
    v_mfma_f32_16x16x32_bf16 v[72:75], a[52:55], v[28:31], v[72:75]
    ds_read_b128 v[52:55], v18 offset:27648
    s_add_u32 s81, s76, 131072
    v_mfma_f32_16x16x32_bf16 v[72:75], a[64:67], v[36:39], v[72:75]
    v_mul_f32 v83, v83, v87
    v_add_f32 v104, 1.0, v104
    v_mfma_f32_16x16x32_bf16 v[76:79], a[56:59], v[28:31], v[76:79]
    buffer_load_dwordx4 v18, s[16:19], s81 offen offset:0 sc1 lds
    v_add_f32 v105, 1.0, v105
    v_mfma_f32_16x16x32_bf16 v[76:79], a[68:71], v[36:39], v[76:79]
    v_add_f32 v106, 1.0, v106
    s_waitcnt lgkmcnt(0)
    v_mfma_f32_16x16x32_bf16 v[56:59], a[72:75], v[40:43], v[56:59]
    v_add_f32 v107, 1.0, v107
    v_mfma_f32_16x16x32_bf16 v[56:59], a[84:87], v[48:51], v[56:59]
    ds_read_b128 v[24:27], v18 offset:8192
    v_mfma_f32_16x16x32_bf16 v[60:63], a[76:79], v[40:43], v[60:63]
    buffer_load_dwordx4 v18, s[16:19], s81 offen offset:1024 sc1 lds
    v_mfma_f32_16x16x32_bf16 v[60:63], a[88:91], v[48:51], v[60:63]
    ds_read_b128 v[32:35], v18 offset:9216
    s_add_u32 s80, s88, 12288
    v_mfma_f32_16x16x32_bf16 v[64:67], a[80:83], v[40:43], v[64:67]
    v_rcp_f32 v104, v104
    v_mfma_f32_16x16x32_bf16 v[64:67], a[92:95], v[48:51], v[64:67]
    ds_read_b128 v[28:31], v18 offset:28672
    v_mfma_f32_16x16x32_bf16 v[68:71], a[72:75], v[44:47], v[68:71]
    buffer_load_dwordx4 v[164:167], v18, s[16:19], s80 offen offset:0 sc1
    v_mfma_f32_16x16x32_bf16 v[68:71], a[84:87], v[52:55], v[68:71]
    v_rcp_f32 v105, v105
    v_mfma_f32_16x16x32_bf16 v[72:75], a[76:79], v[44:47], v[72:75]
    ds_read_b128 v[36:39], v18 offset:29696
    v_mfma_f32_16x16x32_bf16 v[72:75], a[88:91], v[52:55], v[72:75]
    v_rcp_f32 v106, v106
    v_mfma_f32_16x16x32_bf16 v[76:79], a[80:83], v[44:47], v[76:79]
    buffer_load_dwordx4 v[168:171], v18, s[16:19], s80 offen offset:1024 sc1
    v_mfma_f32_16x16x32_bf16 v[76:79], a[92:95], v[52:55], v[76:79]
    s_waitcnt lgkmcnt(0)
    v_mfma_f32_16x16x32_bf16 v[56:59], a[96:99], v[24:27], v[56:59]
    v_rcp_f32 v107, v107
    v_mfma_f32_16x16x32_bf16 v[56:59], a[108:111], v[32:35], v[56:59]
    ds_read_b128 v[40:43], v18 offset:10240
    v_mul_f32 v80, v80, v104
    v_mfma_f32_16x16x32_bf16 v[60:63], a[100:103], v[24:27], v[60:63]
    buffer_load_dwordx4 v[172:175], v18, s[16:19], s80 offen offset:2048 sc1
    v_mul_f32 v81, v81, v105
    v_mfma_f32_16x16x32_bf16 v[60:63], a[112:115], v[32:35], v[60:63]
    ds_read_b128 v[48:51], v18 offset:11264
    v_mul_f32 v82, v82, v106
    v_mfma_f32_16x16x32_bf16 v[64:67], a[104:107], v[24:27], v[64:67]
    v_mul_f32 v83, v83, v107
    v_cvt_pk_bf16_f32 v108, v80, v81
    v_mfma_f32_16x16x32_bf16 v[64:67], a[116:119], v[32:35], v[64:67]
    ds_read_b128 v[44:47], v18 offset:30720
    v_cvt_pk_bf16_f32 v109, v82, v83
    v_mfma_f32_16x16x32_bf16 v[68:71], a[96:99], v[28:31], v[68:71]
    buffer_load_dwordx4 v[176:179], v18, s[16:19], s80 offen offset:3072 sc1
    v_mul_f32 v104, v92, v92
    v_mfma_f32_16x16x32_bf16 v[68:71], a[108:111], v[36:39], v[68:71]
    s_add_u32 s80, s88, 16384
    v_mul_f32 v105, v93, v93
    v_mfma_f32_16x16x32_bf16 v[72:75], a[100:103], v[28:31], v[72:75]
    ds_read_b128 v[52:55], v18 offset:31744
    v_mul_f32 v106, v94, v94
    v_mfma_f32_16x16x32_bf16 v[72:75], a[112:115], v[36:39], v[72:75]
    v_mul_f32 v107, v95, v95
    v_fma_f32 v104, v104, v254, v250
    v_mfma_f32_16x16x32_bf16 v[76:79], a[104:107], v[28:31], v[76:79]
    buffer_load_dwordx4 v[180:183], v18, s[16:19], s80 offen offset:0 sc1
    v_fma_f32 v105, v105, v254, v250
    v_mfma_f32_16x16x32_bf16 v[76:79], a[116:119], v[36:39], v[76:79]
    v_fma_f32 v106, v106, v254, v250
    s_waitcnt lgkmcnt(0)
    v_mfma_f32_16x16x32_bf16 v[56:59], a[120:123], v[40:43], v[56:59]
    v_fma_f32 v107, v107, v254, v250
    v_mul_f32 v104, v104, v92
    v_mfma_f32_16x16x32_bf16 v[56:59], a[132:135], v[48:51], v[56:59]
    ds_read_b128 v[24:27], v18 offset:12288
    v_mul_f32 v105, v105, v93
    v_mfma_f32_16x16x32_bf16 v[60:63], a[124:127], v[40:43], v[60:63]
    buffer_load_dwordx4 v[184:187], v18, s[16:19], s80 offen offset:1024 sc1
    v_mul_f32 v106, v106, v94
    v_mfma_f32_16x16x32_bf16 v[60:63], a[136:139], v[48:51], v[60:63]
    ds_read_b128 v[32:35], v18 offset:13312
    v_mul_f32 v107, v107, v95
    v_mfma_f32_16x16x32_bf16 v[64:67], a[128:131], v[40:43], v[64:67]
    v_exp_f32 v104, v104
    v_mfma_f32_16x16x32_bf16 v[64:67], a[140:143], v[48:51], v[64:67]
    ds_read_b128 v[28:31], v18 offset:32768
    v_mfma_f32_16x16x32_bf16 v[68:71], a[120:123], v[44:47], v[68:71]
    buffer_load_dwordx4 v[188:191], v18, s[16:19], s80 offen offset:2048 sc1
    v_mfma_f32_16x16x32_bf16 v[68:71], a[132:135], v[52:55], v[68:71]
    v_exp_f32 v105, v105
    v_mfma_f32_16x16x32_bf16 v[72:75], a[124:127], v[44:47], v[72:75]
    ds_read_b128 v[36:39], v18 offset:33792
    v_mfma_f32_16x16x32_bf16 v[72:75], a[136:139], v[52:55], v[72:75]
    v_exp_f32 v106, v106
    v_mfma_f32_16x16x32_bf16 v[76:79], a[128:131], v[44:47], v[76:79]
    buffer_load_dwordx4 v[192:195], v18, s[16:19], s80 offen offset:3072 sc1
    v_mfma_f32_16x16x32_bf16 v[76:79], a[140:143], v[52:55], v[76:79]
    s_add_u32 s80, s88, 20480
    s_waitcnt lgkmcnt(0)
    v_mfma_f32_16x16x32_bf16 v[56:59], a[144:147], v[24:27], v[56:59]
    v_exp_f32 v107, v107
    v_mfma_f32_16x16x32_bf16 v[56:59], a[156:159], v[32:35], v[56:59]
    ds_read_b128 v[40:43], v18 offset:14336
    v_mul_f32 v92, v92, v96
    v_mfma_f32_16x16x32_bf16 v[60:63], a[148:151], v[24:27], v[60:63]
    buffer_load_dwordx4 v[196:199], v18, s[16:19], s80 offen offset:0 sc1
    v_mul_f32 v93, v93, v97
    v_mfma_f32_16x16x32_bf16 v[60:63], a[160:163], v[32:35], v[60:63]
    ds_read_b128 v[48:51], v18 offset:15360
    v_mul_f32 v94, v94, v98
    v_mfma_f32_16x16x32_bf16 v[64:67], a[152:155], v[24:27], v[64:67]
    v_mul_f32 v95, v95, v99
    v_add_f32 v104, 1.0, v104
    v_mfma_f32_16x16x32_bf16 v[64:67], a[164:167], v[32:35], v[64:67]
    ds_read_b128 v[44:47], v18 offset:34816
    v_add_f32 v105, 1.0, v105
    v_mfma_f32_16x16x32_bf16 v[68:71], a[144:147], v[28:31], v[68:71]
    buffer_load_dwordx4 v[200:203], v18, s[16:19], s80 offen offset:1024 sc1
    v_add_f32 v106, 1.0, v106
    v_mfma_f32_16x16x32_bf16 v[68:71], a[156:159], v[36:39], v[68:71]
    v_add_f32 v107, 1.0, v107
    v_mfma_f32_16x16x32_bf16 v[72:75], a[148:151], v[28:31], v[72:75]
    ds_read_b128 v[52:55], v18 offset:35840
    v_mfma_f32_16x16x32_bf16 v[72:75], a[160:163], v[36:39], v[72:75]
    v_rcp_f32 v104, v104
    v_mfma_f32_16x16x32_bf16 v[76:79], a[152:155], v[28:31], v[76:79]
    buffer_load_dwordx4 v[204:207], v18, s[16:19], s80 offen offset:2048 sc1
    v_mfma_f32_16x16x32_bf16 v[76:79], a[164:167], v[36:39], v[76:79]
    s_waitcnt lgkmcnt(0)
    v_mfma_f32_16x16x32_bf16 v[56:59], a[168:171], v[40:43], v[56:59]
    v_rcp_f32 v105, v105
    v_mfma_f32_16x16x32_bf16 v[56:59], a[180:183], v[48:51], v[56:59]
    ds_read_b128 v[24:27], v18 offset:16384
    v_mfma_f32_16x16x32_bf16 v[60:63], a[172:175], v[40:43], v[60:63]
    buffer_load_dwordx4 v[208:211], v18, s[16:19], s80 offen offset:3072 sc1
    v_mfma_f32_16x16x32_bf16 v[60:63], a[184:187], v[48:51], v[60:63]
    ds_read_b128 v[32:35], v18 offset:17408
    s_add_u32 s80, s88, 24576
    v_mfma_f32_16x16x32_bf16 v[64:67], a[176:179], v[40:43], v[64:67]
    v_rcp_f32 v106, v106
    v_mfma_f32_16x16x32_bf16 v[64:67], a[188:191], v[48:51], v[64:67]
    ds_read_b128 v[28:31], v18 offset:36864
    v_mfma_f32_16x16x32_bf16 v[68:71], a[168:171], v[44:47], v[68:71]
    buffer_load_dwordx4 v[212:215], v18, s[16:19], s80 offen offset:0 sc1
    v_mfma_f32_16x16x32_bf16 v[68:71], a[180:183], v[52:55], v[68:71]
    v_rcp_f32 v107, v107
    v_mfma_f32_16x16x32_bf16 v[72:75], a[172:175], v[44:47], v[72:75]
    ds_read_b128 v[36:39], v18 offset:37888
    v_mul_f32 v92, v92, v104
    v_mfma_f32_16x16x32_bf16 v[72:75], a[184:187], v[52:55], v[72:75]
    v_mul_f32 v93, v93, v105
    v_mul_f32 v94, v94, v106
    v_mfma_f32_16x16x32_bf16 v[76:79], a[176:179], v[44:47], v[76:79]
    buffer_load_dwordx4 v[216:219], v18, s[16:19], s80 offen offset:1024 sc1
    v_mul_f32 v95, v95, v107
    v_mfma_f32_16x16x32_bf16 v[76:79], a[188:191], v[52:55], v[76:79]
    s_waitcnt vmcnt(24)
    s_add_u32 s52, s86, 8192
    s_mov_b64 exec, 1
    s_cmp_eq_u32 s15, 0
    s_cbranch_scc1 adaLN_cond__spectral_fnet__geglu_ffn__prompt_kernel_s88
    buffer_store_dword v252, v253, s[16:19], s52 offen
    s_branch adaLN_cond__spectral_fnet__geglu_ffn__prompt_kernel_e89
adaLN_cond__spectral_fnet__geglu_ffn__prompt_kernel_s88:
    buffer_wbl2 sc1
    s_waitcnt vmcnt(0)
    buffer_store_dword v252, v253, s[16:19], s52 offen sc1
adaLN_cond__spectral_fnet__geglu_ffn__prompt_kernel_e89:
    s_mov_b64 exec, -1
    s_waitcnt lgkmcnt(0)
    v_mfma_f32_16x16x32_bf16 v[56:59], a[192:195], v[24:27], v[56:59]
    v_cvt_pk_bf16_f32 v110, v92, v93
    v_cvt_pk_bf16_f32 v111, v94, v95
    v_mfma_f32_16x16x32_bf16 v[56:59], a[204:207], v[32:35], v[56:59]
    ds_read_b128 v[40:43], v18 offset:18432
    s_add_u32 s82, s75, s66
    v_mfma_f32_16x16x32_bf16 v[60:63], a[196:199], v[24:27], v[60:63]
    buffer_load_dwordx4 v[220:223], v18, s[16:19], s80 offen offset:2048 sc1
    s_add_u32 s82, s82, 9535488
    v_mfma_f32_16x16x32_bf16 v[60:63], a[208:211], v[32:35], v[60:63]
    ds_read_b128 v[48:51], v18 offset:19456
    v_permlane16_swap_b32 v108, v110
    v_mfma_f32_16x16x32_bf16 v[64:67], a[200:203], v[24:27], v[64:67]
    v_permlane16_swap_b32 v109, v111
    buffer_store_dwordx4 v[108:111], v248, s[16:19], s82 offen sc1
    v_mfma_f32_16x16x32_bf16 v[64:67], a[212:215], v[32:35], v[64:67]
    ds_read_b128 v[44:47], v18 offset:38912
    v_mul_f32 v104, v88, v88
    v_mfma_f32_16x16x32_bf16 v[68:71], a[192:195], v[28:31], v[68:71]
    buffer_load_dwordx4 v[224:227], v18, s[16:19], s80 offen offset:3072 sc1
    v_mul_f32 v105, v89, v89
    v_mfma_f32_16x16x32_bf16 v[68:71], a[204:207], v[36:39], v[68:71]
    v_mul_f32 v106, v90, v90
    v_mul_f32 v107, v91, v91
    v_mfma_f32_16x16x32_bf16 v[72:75], a[196:199], v[28:31], v[72:75]
    ds_read_b128 v[52:55], v18 offset:39936
    v_fma_f32 v104, v104, v254, v250
    v_mfma_f32_16x16x32_bf16 v[72:75], a[208:211], v[36:39], v[72:75]
    v_fma_f32 v105, v105, v254, v250
    v_fma_f32 v106, v106, v254, v250
    v_mfma_f32_16x16x32_bf16 v[76:79], a[200:203], v[28:31], v[76:79]
    v_fma_f32 v107, v107, v254, v250
    v_mul_f32 v104, v104, v88
    v_mfma_f32_16x16x32_bf16 v[76:79], a[212:215], v[36:39], v[76:79]
    v_mul_f32 v105, v105, v89
    s_waitcnt lgkmcnt(0)
    v_mfma_f32_16x16x32_bf16 v[56:59], a[216:219], v[40:43], v[56:59]
    v_mul_f32 v106, v106, v90
    v_mul_f32 v107, v107, v91
    s_waitcnt vmcnt(18)
    s_barrier
    v_mfma_f32_16x16x32_bf16 v[56:59], a[228:231], v[48:51], v[56:59]
    ds_read_b128 v[24:27], v255 offset:0
    v_mfma_f32_16x16x32_bf16 v[60:63], a[220:223], v[40:43], v[60:63]
    v_exp_f32 v104, v104
    v_mfma_f32_16x16x32_bf16 v[60:63], a[232:235], v[48:51], v[60:63]
    ds_read_b128 v[32:35], v255 offset:1024
    v_mfma_f32_16x16x32_bf16 v[64:67], a[224:227], v[40:43], v[64:67]
    v_exp_f32 v105, v105
    v_mfma_f32_16x16x32_bf16 v[64:67], a[236:239], v[48:51], v[64:67]
    ds_read_b128 v[28:31], v255 offset:20480
    v_mfma_f32_16x16x32_bf16 v[68:71], a[216:219], v[44:47], v[68:71]
    v_exp_f32 v106, v106
    v_mfma_f32_16x16x32_bf16 v[68:71], a[228:231], v[52:55], v[68:71]
    v_exp_f32 v107, v107
    v_mfma_f32_16x16x32_bf16 v[72:75], a[220:223], v[44:47], v[72:75]
    ds_read_b128 v[36:39], v255 offset:21504
    v_mul_f32 v88, v88, v100
    v_mfma_f32_16x16x32_bf16 v[72:75], a[232:235], v[52:55], v[72:75]
    v_mul_f32 v89, v89, v101
    v_mul_f32 v90, v90, v102
    v_mfma_f32_16x16x32_bf16 v[76:79], a[224:227], v[44:47], v[76:79]
    v_mul_f32 v91, v91, v103
    v_add_f32 v104, 1.0, v104
    v_mfma_f32_16x16x32_bf16 v[76:79], a[236:239], v[52:55], v[76:79]
    v_add_f32 v105, 1.0, v105
    v_add_f32 v106, 1.0, v106
    v_add_f32 v107, 1.0, v107
    v_rcp_f32 v104, v104
    v_rcp_f32 v105, v105
    v_rcp_f32 v106, v106
    v_rcp_f32 v107, v107
    v_mul_f32 v88, v88, v104
    v_mul_f32 v89, v89, v105
    v_mul_f32 v90, v90, v106
    v_mul_f32 v91, v91, v107
    v_cvt_pk_bf16_f32 v112, v88, v89
    v_cvt_pk_bf16_f32 v113, v90, v91
    buffer_store_dwordx2 v[112:113], v249, s[16:19], s82 offen offset:512 sc1
    s_waitcnt lgkmcnt(0)
    v_mfma_f32_16x16x32_bf16 v[80:83], a[0:3], v[24:27], 0
    s_add_u32 s80, s88, 28672
    v_permlane32_swap_b32 v64, v76
    v_mfma_f32_16x16x32_bf16 v[80:83], a[12:15], v[32:35], v[80:83]
    ds_read_b128 v[40:43], v255 offset:2048
    buffer_load_dwordx4 v[228:231], v18, s[16:19], s80 offen offset:0 sc1
    v_mfma_f32_16x16x32_bf16 v[84:87], a[4:7], v[24:27], 0
    v_permlane32_swap_b32 v65, v77
    v_permlane32_swap_b32 v66, v78
    v_mfma_f32_16x16x32_bf16 v[84:87], a[16:19], v[32:35], v[84:87]
    ds_read_b128 v[48:51], v255 offset:3072
    v_permlane32_swap_b32 v67, v79
    v_mfma_f32_16x16x32_bf16 v[88:91], a[8:11], v[24:27], 0
    v_mul_f32 v104, v56, v56
    v_mul_f32 v105, v57, v57
    v_mfma_f32_16x16x32_bf16 v[88:91], a[20:23], v[32:35], v[88:91]
    ds_read_b128 v[44:47], v255 offset:22528
    buffer_load_dwordx4 v[232:235], v18, s[16:19], s80 offen offset:1024 sc1
    v_mfma_f32_16x16x32_bf16 v[92:95], a[0:3], v[28:31], 0
    v_mul_f32 v106, v58, v58
    v_mul_f32 v107, v59, v59
    v_mfma_f32_16x16x32_bf16 v[92:95], a[12:15], v[36:39], v[92:95]
    v_fma_f32 v104, v104, v254, v250
    v_fma_f32 v105, v105, v254, v250
    v_mfma_f32_16x16x32_bf16 v[96:99], a[4:7], v[28:31], 0
    ds_read_b128 v[52:55], v255 offset:23552
    v_fma_f32 v106, v106, v254, v250
    v_mfma_f32_16x16x32_bf16 v[96:99], a[16:19], v[36:39], v[96:99]
    buffer_load_dwordx4 v[236:239], v18, s[16:19], s80 offen offset:2048 sc1
    v_fma_f32 v107, v107, v254, v250
    v_mfma_f32_16x16x32_bf16 v[100:103], a[8:11], v[28:31], 0
    v_mul_f32 v104, v104, v56
    v_mul_f32 v105, v105, v57
    v_mfma_f32_16x16x32_bf16 v[100:103], a[20:23], v[36:39], v[100:103]
    v_mul_f32 v106, v106, v58
    s_waitcnt lgkmcnt(0)
    v_mfma_f32_16x16x32_bf16 v[80:83], a[24:27], v[40:43], v[80:83]
    v_mul_f32 v107, v107, v59
    v_mfma_f32_16x16x32_bf16 v[80:83], a[36:39], v[48:51], v[80:83]
    ds_read_b128 v[24:27], v255 offset:4096
    buffer_load_dwordx4 v[240:243], v18, s[16:19], s80 offen offset:3072 sc1
    v_mfma_f32_16x16x32_bf16 v[84:87], a[28:31], v[40:43], v[84:87]
    s_add_u32 s80, s88, 32768
    v_mfma_f32_16x16x32_bf16 v[84:87], a[40:43], v[48:51], v[84:87]
    ds_read_b128 v[32:35], v255 offset:5120
    v_mfma_f32_16x16x32_bf16 v[88:91], a[32:35], v[40:43], v[88:91]
    v_exp_f32 v104, v104
    v_mfma_f32_16x16x32_bf16 v[88:91], a[44:47], v[48:51], v[88:91]
    ds_read_b128 v[28:31], v255 offset:24576
    buffer_load_dwordx4 v[244:247], v18, s[16:19], s80 offen offset:0 sc1
    v_mfma_f32_16x16x32_bf16 v[92:95], a[24:27], v[44:47], v[92:95]
    v_exp_f32 v105, v105
    v_mfma_f32_16x16x32_bf16 v[92:95], a[36:39], v[52:55], v[92:95]
    v_exp_f32 v106, v106
    v_mfma_f32_16x16x32_bf16 v[96:99], a[28:31], v[44:47], v[96:99]
    ds_read_b128 v[36:39], v255 offset:25600
    v_mfma_f32_16x16x32_bf16 v[96:99], a[40:43], v[52:55], v[96:99]
    v_exp_f32 v107, v107
    v_mfma_f32_16x16x32_bf16 v[100:103], a[32:35], v[44:47], v[100:103]
    v_mul_f32 v56, v56, v60
    v_mul_f32 v57, v57, v61
    v_mfma_f32_16x16x32_bf16 v[100:103], a[44:47], v[52:55], v[100:103]
    v_mul_f32 v58, v58, v62
    s_waitcnt lgkmcnt(0)
    v_mfma_f32_16x16x32_bf16 v[80:83], a[48:51], v[24:27], v[80:83]
    v_mul_f32 v59, v59, v63
    v_add_f32 v104, 1.0, v104
    v_mfma_f32_16x16x32_bf16 v[80:83], a[60:63], v[32:35], v[80:83]
    ds_read_b128 v[40:43], v255 offset:6144
    v_add_f32 v105, 1.0, v105
    v_mfma_f32_16x16x32_bf16 v[84:87], a[52:55], v[24:27], v[84:87]
    v_mfma_f32_16x16x32_bf16 v[84:87], a[64:67], v[32:35], v[84:87]
    ds_read_b128 v[48:51], v255 offset:7168
    v_add_f32 v106, 1.0, v106
    v_mfma_f32_16x16x32_bf16 v[88:91], a[56:59], v[24:27], v[88:91]
    ds_read_b128 a[0:3], v15 offset:0
    v_add_f32 v107, 1.0, v107
    v_mfma_f32_16x16x32_bf16 v[88:91], a[68:71], v[32:35], v[88:91]
    ds_read_b128 v[44:47], v255 offset:26624
    v_mfma_f32_16x16x32_bf16 v[92:95], a[48:51], v[28:31], v[92:95]
    v_rcp_f32 v104, v104
    v_mfma_f32_16x16x32_bf16 v[92:95], a[60:63], v[36:39], v[92:95]
    ds_read_b128 a[4:7], v15 offset:1024
    v_mfma_f32_16x16x32_bf16 v[96:99], a[52:55], v[28:31], v[96:99]
    ds_read_b128 v[52:55], v255 offset:27648
    v_mfma_f32_16x16x32_bf16 v[96:99], a[64:67], v[36:39], v[96:99]
    ds_read_b128 a[8:11], v15 offset:2048
    v_mfma_f32_16x16x32_bf16 v[100:103], a[56:59], v[28:31], v[100:103]
    s_add_u32 s80, s88, 45056
    v_mfma_f32_16x16x32_bf16 v[100:103], a[68:71], v[36:39], v[100:103]
    buffer_load_dwordx4 a[56:59], v18, s[16:19], s80 offen offset:3072 sc1
    s_waitcnt lgkmcnt(1)
    v_mfma_f32_16x16x32_bf16 v[80:83], a[72:75], v[40:43], v[80:83]
    ds_read_b128 a[12:15], v15 offset:3072
    s_add_u32 s80, s88, 49152
    v_mfma_f32_16x16x32_bf16 v[80:83], a[84:87], v[48:51], v[80:83]
    s_add_u32 s87, s68, 8192
    buffer_load_dword v251, v14, s[16:19], s87 offen sc1
    ds_read_b128 v[24:27], v255 offset:8192
    v_mfma_f32_16x16x32_bf16 v[84:87], a[76:79], v[40:43], v[84:87]
    ds_read_b128 a[16:19], v15 offset:4096
    v_mfma_f32_16x16x32_bf16 v[84:87], a[88:91], v[48:51], v[84:87]
    ds_read_b128 v[32:35], v255 offset:9216
    buffer_load_dwordx4 a[60:63], v18, s[16:19], s80 offen offset:0 sc1
    v_mfma_f32_16x16x32_bf16 v[88:91], a[80:83], v[40:43], v[88:91]
    ds_read_b128 a[20:23], v15 offset:5120
    v_mfma_f32_16x16x32_bf16 v[88:91], a[92:95], v[48:51], v[88:91]
    ds_read_b128 v[28:31], v255 offset:28672
    v_mfma_f32_16x16x32_bf16 v[92:95], a[72:75], v[44:47], v[92:95]
    v_rcp_f32 v105, v105
    v_mfma_f32_16x16x32_bf16 v[92:95], a[84:87], v[52:55], v[92:95]
    ds_read_b128 a[24:27], v15 offset:6144
    buffer_load_dwordx4 a[64:67], v18, s[16:19], s80 offen offset:1024 sc1
    v_mfma_f32_16x16x32_bf16 v[96:99], a[76:79], v[44:47], v[96:99]
    ds_read_b128 v[36:39], v255 offset:29696
    v_mfma_f32_16x16x32_bf16 v[96:99], a[88:91], v[52:55], v[96:99]
    ds_read_b128 a[28:31], v15 offset:7168
    v_mfma_f32_16x16x32_bf16 v[100:103], a[80:83], v[44:47], v[100:103]
    v_rcp_f32 v106, v106
    v_mfma_f32_16x16x32_bf16 v[100:103], a[92:95], v[52:55], v[100:103]
    s_waitcnt lgkmcnt(1)
    v_mfma_f32_16x16x32_bf16 v[80:83], a[96:99], v[24:27], v[80:83]
    ds_read_b128 a[32:35], v15 offset:8192
    v_mfma_f32_16x16x32_bf16 v[80:83], a[108:111], v[32:35], v[80:83]
    ds_read_b128 v[40:43], v255 offset:10240
    v_mfma_f32_16x16x32_bf16 v[84:87], a[100:103], v[24:27], v[84:87]
    ds_read_b128 a[36:39], v15 offset:9216
    v_mfma_f32_16x16x32_bf16 v[84:87], a[112:115], v[32:35], v[84:87]
    ds_read_b128 v[48:51], v255 offset:11264
    v_mfma_f32_16x16x32_bf16 v[88:91], a[104:107], v[24:27], v[88:91]
    ds_read_b128 a[40:43], v15 offset:10240
    v_mfma_f32_16x16x32_bf16 v[88:91], a[116:119], v[32:35], v[88:91]
    ds_read_b128 v[44:47], v255 offset:30720
    v_mfma_f32_16x16x32_bf16 v[92:95], a[96:99], v[28:31], v[92:95]
    v_rcp_f32 v107, v107
    v_mfma_f32_16x16x32_bf16 v[92:95], a[108:111], v[36:39], v[92:95]
    ds_read_b128 a[44:47], v15 offset:11264
    v_mul_f32 v56, v56, v104
    v_mfma_f32_16x16x32_bf16 v[96:99], a[100:103], v[28:31], v[96:99]
    ds_read_b128 v[52:55], v255 offset:31744
    v_mul_f32 v57, v57, v105
    v_mfma_f32_16x16x32_bf16 v[96:99], a[112:115], v[36:39], v[96:99]
    s_waitcnt vmcnt(2)
    v_cmp_ne_u32 vcc, s14, v251
    s_nop 0
    s_cbranch_vccz adaLN_cond__spectral_fnet__geglu_ffn__prompt_kernel_ok90
    s_mov_b32 s52, 0
adaLN_cond__spectral_fnet__geglu_ffn__prompt_kernel_p91:
    buffer_load_dword v251, v14, s[16:19], s87 offen sc1
    s_waitcnt vmcnt(0)
    s_add_u32 s52, s52, 1
    s_cmp_gt_u32 s52, 0x400000
    s_cbranch_scc1 adaLN_cond__spectral_fnet__geglu_ffn__prompt_kernel_x92
    v_cmp_ne_u32 vcc, s14, v251
    s_nop 0
    s_cbranch_vccnz adaLN_cond__spectral_fnet__geglu_ffn__prompt_kernel_p91
adaLN_cond__spectral_fnet__geglu_ffn__prompt_kernel_x92:
adaLN_cond__spectral_fnet__geglu_ffn__prompt_kernel_ok90:
    ds_read_b128 a[48:51], v15 offset:12288
    v_mfma_f32_16x16x32_bf16 v[100:103], a[104:107], v[28:31], v[100:103]
    v_mul_f32 v58, v58, v106
    v_mul_f32 v59, v59, v107
    v_mfma_f32_16x16x32_bf16 v[100:103], a[116:119], v[36:39], v[100:103]
    buffer_load_dwordx4 a[108:111], v18, s[16:19], s60 offen offset:0 sc1
    s_waitcnt lgkmcnt(1)
    v_mfma_f32_16x16x32_bf16 v[80:83], a[120:123], v[40:43], v[80:83]
    ds_read_b128 a[52:55], v15 offset:13312
    v_cvt_pk_bf16_f32 v108, v56, v57
    v_mfma_f32_16x16x32_bf16 v[80:83], a[132:135], v[48:51], v[80:83]
    ds_read_b128 v[24:27], v255 offset:12288
    v_cvt_pk_bf16_f32 v109, v58, v59
    v_mfma_f32_16x16x32_bf16 v[84:87], a[124:127], v[40:43], v[84:87]
    v_mul_f32 v104, v68, v68
    v_mul_f32 v105, v69, v69
    v_mfma_f32_16x16x32_bf16 v[84:87], a[136:139], v[48:51], v[84:87]
    ds_read_b128 v[32:35], v255 offset:13312
    buffer_load_dwordx4 a[112:115], v18, s[16:19], s60 offen offset:1024 sc1
    v_mfma_f32_16x16x32_bf16 v[88:91], a[128:131], v[40:43], v[88:91]
    v_mul_f32 v106, v70, v70
    v_mul_f32 v107, v71, v71
    v_mfma_f32_16x16x32_bf16 v[88:91], a[140:143], v[48:51], v[88:91]
    ds_read_b128 v[28:31], v255 offset:32768
    v_fma_f32 v104, v104, v254, v250
    v_mfma_f32_16x16x32_bf16 v[92:95], a[120:123], v[44:47], v[92:95]
    v_fma_f32 v105, v105, v254, v250
    v_fma_f32 v106, v106, v254, v250
    v_mfma_f32_16x16x32_bf16 v[92:95], a[132:135], v[52:55], v[92:95]
    buffer_load_dwordx4 a[116:119], v18, s[16:19], s60 offen offset:2048 sc1
    v_fma_f32 v107, v107, v254, v250
    v_mfma_f32_16x16x32_bf16 v[96:99], a[124:127], v[44:47], v[96:99]
    ds_read_b128 v[36:39], v255 offset:33792
    v_mul_f32 v104, v104, v68
    v_mfma_f32_16x16x32_bf16 v[96:99], a[136:139], v[52:55], v[96:99]
    v_mul_f32 v105, v105, v69
    v_mul_f32 v106, v106, v70
    v_mfma_f32_16x16x32_bf16 v[100:103], a[128:131], v[44:47], v[100:103]
    v_mul_f32 v107, v107, v71
    v_mfma_f32_16x16x32_bf16 v[100:103], a[140:143], v[52:55], v[100:103]
    s_add_u32 s52, s86, 12288
    s_mov_b64 exec, 1
    s_cmp_eq_u32 s15, 0
    s_cbranch_scc1 adaLN_cond__spectral_fnet__geglu_ffn__prompt_kernel_s93
    buffer_store_dword v252, v253, s[16:19], s52 offen
    s_branch adaLN_cond__spectral_fnet__geglu_ffn__prompt_kernel_e94
adaLN_cond__spectral_fnet__geglu_ffn__prompt_kernel_s93:
    buffer_store_dword v252, v253, s[16:19], s52 offen sc1
adaLN_cond__spectral_fnet__geglu_ffn__prompt_kernel_e94:
    s_mov_b64 exec, -1
    s_waitcnt lgkmcnt(0)
    v_mfma_f32_16x16x32_bf16 v[80:83], a[144:147], v[24:27], v[80:83]
    buffer_load_dwordx4 a[120:123], v18, s[16:19], s60 offen offset:3072 sc1
    v_mfma_f32_16x16x32_bf16 v[80:83], a[156:159], v[32:35], v[80:83]
    ds_read_b128 v[40:43], v255 offset:14336
    s_add_u32 s60, s60, 4096
    v_mfma_f32_16x16x32_bf16 v[84:87], a[148:151], v[24:27], v[84:87]
    v_exp_f32 v104, v104
    v_mfma_f32_16x16x32_bf16 v[84:87], a[160:163], v[32:35], v[84:87]
    ds_read_b128 v[48:51], v255 offset:15360
    v_mfma_f32_16x16x32_bf16 v[88:91], a[152:155], v[24:27], v[88:91]
    buffer_load_dwordx4 a[124:127], v18, s[16:19], s60 offen offset:0 sc1
    v_mfma_f32_16x16x32_bf16 v[88:91], a[164:167], v[32:35], v[88:91]
    ds_read_b128 v[44:47], v255 offset:34816
    v_mfma_f32_16x16x32_bf16 v[92:95], a[144:147], v[28:31], v[92:95]
    v_exp_f32 v105, v105
    v_mfma_f32_16x16x32_bf16 v[92:95], a[156:159], v[36:39], v[92:95]
    v_exp_f32 v106, v106
    v_mfma_f32_16x16x32_bf16 v[96:99], a[148:151], v[28:31], v[96:99]
    ds_read_b128 v[52:55], v255 offset:35840
    buffer_load_dwordx4 a[128:131], v18, s[16:19], s60 offen offset:1024 sc1
    v_mfma_f32_16x16x32_bf16 v[96:99], a[160:163], v[36:39], v[96:99]
    v_exp_f32 v107, v107
    v_mfma_f32_16x16x32_bf16 v[100:103], a[152:155], v[28:31], v[100:103]
    v_mul_f32 v68, v68, v72
    v_mul_f32 v69, v69, v73
    v_mfma_f32_16x16x32_bf16 v[100:103], a[164:167], v[36:39], v[100:103]
    v_mul_f32 v70, v70, v74
    s_waitcnt lgkmcnt(0)
    v_mfma_f32_16x16x32_bf16 v[80:83], a[168:171], v[40:43], v[80:83]
    buffer_load_dwordx4 a[132:135], v18, s[16:19], s60 offen offset:2048 sc1
    v_mul_f32 v71, v71, v75
    v_mfma_f32_16x16x32_bf16 v[80:83], a[180:183], v[48:51], v[80:83]
    ds_read_b128 v[24:27], v255 offset:16384
    v_add_f32 v104, 1.0, v104
    v_mfma_f32_16x16x32_bf16 v[84:87], a[172:175], v[40:43], v[84:87]
    v_add_f32 v105, 1.0, v105
    v_add_f32 v106, 1.0, v106
    v_mfma_f32_16x16x32_bf16 v[84:87], a[184:187], v[48:51], v[84:87]
    ds_read_b128 v[32:35], v255 offset:17408
    v_add_f32 v107, 1.0, v107
    v_mfma_f32_16x16x32_bf16 v[88:91], a[176:179], v[40:43], v[88:91]
    buffer_load_dwordx4 a[136:139], v18, s[16:19], s60 offen offset:3072 sc1
    v_mfma_f32_16x16x32_bf16 v[88:91], a[188:191], v[48:51], v[88:91]
    ds_read_b128 v[28:31], v255 offset:36864
    s_add_u32 s60, s60, 4096
    v_mfma_f32_16x16x32_bf16 v[92:95], a[168:171], v[44:47], v[92:95]
    v_rcp_f32 v104, v104
    v_mfma_f32_16x16x32_bf16 v[92:95], a[180:183], v[52:55], v[92:95]
    v_rcp_f32 v105, v105
    v_mfma_f32_16x16x32_bf16 v[96:99], a[172:175], v[44:47], v[96:99]
    ds_read_b128 v[36:39], v255 offset:37888
    buffer_load_dwordx4 a[140:143], v18, s[16:19], s60 offen offset:0 sc1
    v_mfma_f32_16x16x32_bf16 v[96:99], a[184:187], v[52:55], v[96:99]
    v_rcp_f32 v106, v106
    v_mfma_f32_16x16x32_bf16 v[100:103], a[176:179], v[44:47], v[100:103]
    v_rcp_f32 v107, v107
    v_mfma_f32_16x16x32_bf16 v[100:103], a[188:191], v[52:55], v[100:103]
    v_mul_f32 v68, v68, v104
    s_waitcnt lgkmcnt(0)
    v_mfma_f32_16x16x32_bf16 v[80:83], a[192:195], v[24:27], v[80:83]
    buffer_load_dwordx4 a[144:147], v18, s[16:19], s60 offen offset:1024 sc1
    v_mul_f32 v69, v69, v105
    v_mfma_f32_16x16x32_bf16 v[80:83], a[204:207], v[32:35], v[80:83]
    ds_read_b128 v[40:43], v255 offset:18432
    v_mul_f32 v70, v70, v106
    v_mfma_f32_16x16x32_bf16 v[84:87], a[196:199], v[24:27], v[84:87]
    v_mul_f32 v71, v71, v107
    v_cvt_pk_bf16_f32 v110, v68, v69
    v_mfma_f32_16x16x32_bf16 v[84:87], a[208:211], v[32:35], v[84:87]
    s_add_u32 s87, s68, 12288
    buffer_load_dword v251, v14, s[16:19], s87 offen sc1
    ds_read_b128 v[48:51], v255 offset:19456
    v_mfma_f32_16x16x32_bf16 v[88:91], a[200:203], v[24:27], v[88:91]
    buffer_load_dwordx4 a[148:151], v18, s[16:19], s60 offen offset:2048 sc1
    v_cvt_pk_bf16_f32 v111, v70, v71
    v_mfma_f32_16x16x32_bf16 v[88:91], a[212:215], v[32:35], v[88:91]
    ds_read_b128 v[44:47], v255 offset:38912
    s_add_u32 s82, s75, s66
    v_mfma_f32_16x16x32_bf16 v[92:95], a[192:195], v[28:31], v[92:95]
    s_add_u32 s82, s82, 9633792
    v_permlane16_swap_b32 v108, v110
    v_mfma_f32_16x16x32_bf16 v[92:95], a[204:207], v[36:39], v[92:95]
    v_permlane16_swap_b32 v109, v111
    buffer_store_dwordx4 v[108:111], v248, s[16:19], s82 offen sc1
    v_mfma_f32_16x16x32_bf16 v[96:99], a[196:199], v[28:31], v[96:99]
    ds_read_b128 v[52:55], v255 offset:39936
    buffer_load_dwordx4 a[152:155], v18, s[16:19], s60 offen offset:3072 sc1
    v_mfma_f32_16x16x32_bf16 v[96:99], a[208:211], v[36:39], v[96:99]
    v_mul_f32 v104, v64, v64
    v_mul_f32 v105, v65, v65
    v_mfma_f32_16x16x32_bf16 v[100:103], a[200:203], v[28:31], v[100:103]
    v_mul_f32 v106, v66, v66
    v_mul_f32 v107, v67, v67
    v_mfma_f32_16x16x32_bf16 v[100:103], a[212:215], v[36:39], v[100:103]
    v_fma_f32 v104, v104, v254, v250
    s_waitcnt lgkmcnt(0)
    v_mfma_f32_16x16x32_bf16 v[80:83], a[216:219], v[40:43], v[80:83]
    buffer_load_dwordx4 a[68:71], v18, s[16:19], s80 offen offset:2048 sc1
    v_fma_f32 v105, v105, v254, v250
    v_mfma_f32_16x16x32_bf16 v[80:83], a[228:231], v[48:51], v[80:83]
    v_fma_f32 v106, v106, v254, v250
    v_fma_f32 v107, v107, v254, v250
    v_mfma_f32_16x16x32_bf16 v[84:87], a[220:223], v[40:43], v[84:87]
    v_mul_f32 v104, v104, v64
    v_mul_f32 v105, v105, v65
    v_mfma_f32_16x16x32_bf16 v[84:87], a[232:235], v[48:51], v[84:87]
    v_mul_f32 v106, v106, v66
    v_mul_f32 v107, v107, v67
adaLN_cond__spectral_fnet__geglu_ffn__prompt_kernel_hop8:
    s_cbranch_execz adaLN_cond__spectral_fnet__geglu_ffn__prompt_kernel_back12
    v_mfma_f32_16x16x32_bf16 v[88:91], a[224:227], v[40:43], v[88:91]
    v_exp_f32 v104, v104
    v_mfma_f32_16x16x32_bf16 v[88:91], a[236:239], v[48:51], v[88:91]
    v_exp_f32 v105, v105
    v_mfma_f32_16x16x32_bf16 v[92:95], a[216:219], v[44:47], v[92:95]
    v_exp_f32 v106, v106
    v_mfma_f32_16x16x32_bf16 v[92:95], a[228:231], v[52:55], v[92:95]
    v_exp_f32 v107, v107
    v_mfma_f32_16x16x32_bf16 v[96:99], a[220:223], v[44:47], v[96:99]
    v_mul_f32 v64, v64, v76
    v_mul_f32 v65, v65, v77
    v_mfma_f32_16x16x32_bf16 v[96:99], a[232:235], v[52:55], v[96:99]
    v_mul_f32 v66, v66, v78
    v_mul_f32 v67, v67, v79
    v_mfma_f32_16x16x32_bf16 v[100:103], a[224:227], v[44:47], v[100:103]
    v_add_f32 v104, 1.0, v104
    v_add_f32 v105, 1.0, v105
    v_mfma_f32_16x16x32_bf16 v[100:103], a[236:239], v[52:55], v[100:103]
    v_add_f32 v106, 1.0, v106
    v_add_f32 v107, 1.0, v107
    v_rcp_f32 v104, v104
    v_rcp_f32 v105, v105
    v_rcp_f32 v106, v106
    v_rcp_f32 v107, v107
    v_mul_f32 v64, v64, v104
    v_mul_f32 v65, v65, v105
    v_mul_f32 v66, v66, v106
    v_mul_f32 v67, v67, v107
    v_cvt_pk_bf16_f32 v112, v64, v65
    v_cvt_pk_bf16_f32 v113, v66, v67
    buffer_store_dwordx2 v[112:113], v249, s[16:19], s82 offen offset:512 sc1
    v_lshl_add_u32 v8, v3, 6, v18
    v_add_u32 v8, s64, v8
    v_permlane32_swap_b32 v88, v100
    v_permlane32_swap_b32 v89, v101
    v_permlane32_swap_b32 v90, v102
    v_permlane32_swap_b32 v91, v103
    v_pk_mul_f32 v[104:105], v[80:81], v[80:81]
    v_pk_mul_f32 v[106:107], v[82:83], v[82:83]
    s_waitcnt vmcnt(5)
    v_pk_fma_f32 v[104:105], v[104:105], v[254:255], v[250:251] op_sel_hi:[1,0,0]
    v_pk_fma_f32 v[106:107], v[106:107], v[254:255], v[250:251] op_sel_hi:[1,0,0]
    v_pk_mul_f32 v[104:105], v[104:105], v[80:81]
    v_pk_mul_f32 v[106:107], v[106:107], v[82:83]
    v_exp_f32 v104, v104
    v_exp_f32 v105, v105
    v_cmp_ne_u32 vcc, s14, v251
    s_nop 0
    s_cbranch_vccz adaLN_cond__spectral_fnet__geglu_ffn__prompt_kernel_ok95
    s_mov_b32 s52, 0
adaLN_cond__spectral_fnet__geglu_ffn__prompt_kernel_p96:
    buffer_load_dword v251, v14, s[16:19], s87 offen sc1
    s_waitcnt vmcnt(0)
    s_add_u32 s52, s52, 1
    s_cmp_gt_u32 s52, 0x400000
    s_cbranch_scc1 adaLN_cond__spectral_fnet__geglu_ffn__prompt_kernel_x97
    v_cmp_ne_u32 vcc, s14, v251
    s_nop 0
    s_cbranch_vccnz adaLN_cond__spectral_fnet__geglu_ffn__prompt_kernel_p96
adaLN_cond__spectral_fnet__geglu_ffn__prompt_kernel_x97:
adaLN_cond__spectral_fnet__geglu_ffn__prompt_kernel_ok95:
    v_exp_f32 v106, v106
    s_add_u32 s80, s88, 49152
    buffer_load_dwordx4 a[72:75], v18, s[16:19], s80 offen offset:3072 sc1
    v_exp_f32 v107, v107
    v_pk_mul_f32 v[80:81], v[80:81], v[84:85]
    v_pk_mul_f32 v[82:83], v[82:83], v[86:87]
    v_pk_add_f32 v[104:105], v[104:105], 1.0 op_sel_hi:[1,0]
    v_pk_add_f32 v[106:107], v[106:107], 1.0 op_sel_hi:[1,0]
    v_rcp_f32 v104, v104
    v_rcp_f32 v105, v105
    v_rcp_f32 v106, v106
    v_rcp_f32 v107, v107
    v_pk_mul_f32 v[80:81], v[80:81], v[104:105]
    s_add_u32 s80, s88, 53248
    buffer_load_dwordx4 a[76:79], v18, s[16:19], s80 offen offset:0 sc1
    v_pk_mul_f32 v[82:83], v[82:83], v[106:107]
    v_cvt_pk_bf16_f32 v108, v80, v81
    v_cvt_pk_bf16_f32 v109, v82, v83
    v_pk_mul_f32 v[104:105], v[92:93], v[92:93]
    v_pk_mul_f32 v[106:107], v[94:95], v[94:95]
    v_pk_fma_f32 v[104:105], v[104:105], v[254:255], v[250:251] op_sel_hi:[1,0,0]
    v_pk_fma_f32 v[106:107], v[106:107], v[254:255], v[250:251] op_sel_hi:[1,0,0]
    v_pk_mul_f32 v[104:105], v[104:105], v[92:93]
    v_pk_mul_f32 v[106:107], v[106:107], v[94:95]
    v_exp_f32 v104, v104
    buffer_load_dwordx4 a[80:83], v18, s[16:19], s80 offen offset:1024 sc1
    v_exp_f32 v105, v105
    v_exp_f32 v106, v106
    v_exp_f32 v107, v107
    v_pk_mul_f32 v[92:93], v[92:93], v[96:97]
    v_pk_mul_f32 v[94:95], v[94:95], v[98:99]
    v_pk_add_f32 v[104:105], v[104:105], 1.0 op_sel_hi:[1,0]
    v_pk_add_f32 v[106:107], v[106:107], 1.0 op_sel_hi:[1,0]
    v_rcp_f32 v104, v104
    v_rcp_f32 v105, v105
    v_rcp_f32 v106, v106
    buffer_load_dwordx4 a[84:87], v18, s[16:19], s80 offen offset:2048 sc1
    v_rcp_f32 v107, v107
    v_pk_mul_f32 v[92:93], v[92:93], v[104:105]
    v_pk_mul_f32 v[94:95], v[94:95], v[106:107]
    v_cvt_pk_bf16_f32 v110, v92, v93
    v_cvt_pk_bf16_f32 v111, v94, v95
    s_add_u32 s82, s75, s67
    s_add_u32 s82, s82, 0
    v_permlane16_swap_b32 v108, v110
    v_permlane16_swap_b32 v109, v111
    buffer_store_dwordx4 v[108:111], v248, s[16:19], s82 offen
    s_waitcnt vmcnt(5)
    s_add_u32 s52, s86, 16384
    s_mov_b64 exec, 1
    s_cmp_eq_u32 s15, 0
    s_cbranch_scc1 adaLN_cond__spectral_fnet__geglu_ffn__prompt_kernel_s98
    buffer_store_dword v252, v253, s[16:19], s52 offen
    s_branch adaLN_cond__spectral_fnet__geglu_ffn__prompt_kernel_e99
adaLN_cond__spectral_fnet__geglu_ffn__prompt_kernel_s98:
    buffer_store_dword v252, v253, s[16:19], s52 offen sc1
adaLN_cond__spectral_fnet__geglu_ffn__prompt_kernel_e99:
    s_mov_b64 exec, -1
    buffer_load_dwordx4 a[88:91], v18, s[16:19], s80 offen offset:3072 sc1
    v_pk_mul_f32 v[104:105], v[88:89], v[88:89]
    v_pk_mul_f32 v[106:107], v[90:91], v[90:91]
    v_pk_fma_f32 v[104:105], v[104:105], v[254:255], v[250:251] op_sel_hi:[1,0,0]
    v_pk_fma_f32 v[106:107], v[106:107], v[254:255], v[250:251] op_sel_hi:[1,0,0]
    v_pk_mul_f32 v[104:105], v[104:105], v[88:89]
    v_pk_mul_f32 v[106:107], v[106:107], v[90:91]
    v_exp_f32 v104, v104
    v_exp_f32 v105, v105
    v_exp_f32 v106, v106
    v_exp_f32 v107, v107
    s_add_u32 s80, s88, 57344
    buffer_load_dwordx4 a[92:95], v18, s[16:19], s80 offen offset:0 sc1
    v_pk_mul_f32 v[88:89], v[88:89], v[100:101]
    v_pk_mul_f32 v[90:91], v[90:91], v[102:103]
    v_pk_add_f32 v[104:105], v[104:105], 1.0 op_sel_hi:[1,0]
    v_pk_add_f32 v[106:107], v[106:107], 1.0 op_sel_hi:[1,0]
    v_rcp_f32 v104, v104
    v_rcp_f32 v105, v105
    v_rcp_f32 v106, v106
    v_rcp_f32 v107, v107
    v_pk_mul_f32 v[88:89], v[88:89], v[104:105]
    v_pk_mul_f32 v[90:91], v[90:91], v[106:107]
    buffer_load_dwordx4 a[96:99], v18, s[16:19], s80 offen offset:1024 sc1
    v_cvt_pk_bf16_f32 v112, v88, v89
    v_cvt_pk_bf16_f32 v113, v90, v91
    buffer_store_dwordx2 v[112:113], v249, s[16:19], s82 offen offset:512
    v_mfma_f32_16x16x32_bf16 v[24:27], v[116:119], a[108:111], 0
    buffer_load_dwordx4 a[100:103], v18, s[16:19], s80 offen offset:2048 sc1
    v_accvgpr_read_b32 v97, a252
    v_mfma_f32_16x16x32_bf16 v[24:27], v[136:139], a[112:115], v[24:27]
    v_accvgpr_read_b32 v99, a253
    v_accvgpr_read_b32 v101, a254
    v_mfma_f32_16x16x32_bf16 v[28:31], v[120:123], a[108:111], 0
    v_accvgpr_read_b32 v103, a255
    v_lshlrev_b32 v96, 16, v97
    v_mfma_f32_16x16x32_bf16 v[28:31], v[140:143], a[112:115], v[28:31]
    v_and_b32 v97, 0xffff0000, v97
    v_lshlrev_b32 v98, 16, v99
    v_mfma_f32_16x16x32_bf16 v[32:35], v[124:127], a[108:111], 0
    buffer_load_dwordx4 a[104:107], v18, s[16:19], s80 offen offset:3072 sc1
    v_and_b32 v99, 0xffff0000, v99
    v_mfma_f32_16x16x32_bf16 v[32:35], v[144:147], a[112:115], v[32:35]
    v_lshlrev_b32 v100, 16, v101
    v_and_b32 v101, 0xffff0000, v101
    v_mfma_f32_16x16x32_bf16 v[36:39], v[128:131], a[108:111], 0
    v_lshlrev_b32 v102, 16, v103
    v_and_b32 v103, 0xffff0000, v103
    v_mfma_f32_16x16x32_bf16 v[36:39], v[148:151], a[112:115], v[36:39]
    v_mfma_f32_16x16x32_bf16 v[40:43], v[132:135], a[108:111], 0
    buffer_load_dwordx4 a[156:159], v18, s[16:19], s61 offen offset:0 sc1
    v_mfma_f32_16x16x32_bf16 v[40:43], v[152:155], a[112:115], v[40:43]
    s_add_u32 s87, s68, 16384
    buffer_load_dword v251, v14, s[16:19], s87 offen sc1
    v_mfma_f32_16x16x32_bf16 v[24:27], v[156:159], a[116:119], v[24:27]
    v_mfma_f32_16x16x32_bf16 v[24:27], v[176:179], a[120:123], v[24:27]
    v_mfma_f32_16x16x32_bf16 v[28:31], v[160:163], a[116:119], v[28:31]
    buffer_load_dwordx4 a[160:163], v18, s[16:19], s61 offen offset:1024 sc1
    v_mfma_f32_16x16x32_bf16 v[28:31], v[180:183], a[120:123], v[28:31]
    v_mfma_f32_16x16x32_bf16 v[32:35], v[164:167], a[116:119], v[32:35]
    v_mfma_f32_16x16x32_bf16 v[32:35], v[184:187], a[120:123], v[32:35]
    v_mfma_f32_16x16x32_bf16 v[36:39], v[168:171], a[116:119], v[36:39]
    buffer_load_dwordx4 a[164:167], v18, s[16:19], s61 offen offset:2048 sc1
    v_mfma_f32_16x16x32_bf16 v[36:39], v[188:191], a[120:123], v[36:39]
    v_mfma_f32_16x16x32_bf16 v[40:43], v[172:175], a[116:119], v[40:43]
    v_mfma_f32_16x16x32_bf16 v[40:43], v[192:195], a[120:123], v[40:43]
    v_mfma_f32_16x16x32_bf16 v[24:27], v[196:199], a[124:127], v[24:27]
    buffer_load_dwordx4 a[168:171], v18, s[16:19], s61 offen offset:3072 sc1
    v_mfma_f32_16x16x32_bf16 v[24:27], v[216:219], a[128:131], v[24:27]
    s_add_u32 s61, s61, 4096
    v_mfma_f32_16x16x32_bf16 v[28:31], v[200:203], a[124:127], v[28:31]
    v_mfma_f32_16x16x32_bf16 v[28:31], v[220:223], a[128:131], v[28:31]
    v_mfma_f32_16x16x32_bf16 v[32:35], v[204:207], a[124:127], v[32:35]
    buffer_load_dwordx4 a[172:175], v18, s[16:19], s61 offen offset:0 sc1
    v_mfma_f32_16x16x32_bf16 v[32:35], v[224:227], a[128:131], v[32:35]
    v_mfma_f32_16x16x32_bf16 v[36:39], v[208:211], a[124:127], v[36:39]
    v_mfma_f32_16x16x32_bf16 v[36:39], v[228:231], a[128:131], v[36:39]
    v_mfma_f32_16x16x32_bf16 v[40:43], v[212:215], a[124:127], v[40:43]
    buffer_load_dwordx4 a[176:179], v18, s[16:19], s61 offen offset:1024 sc1
    v_mfma_f32_16x16x32_bf16 v[40:43], v[232:235], a[128:131], v[40:43]
    s_waitcnt vmcnt(9)
    s_add_u32 s52, s86, 20480
    s_mov_b64 exec, 1
    s_cmp_eq_u32 s15, 0
    s_cbranch_scc1 adaLN_cond__spectral_fnet__geglu_ffn__prompt_kernel_s100
    buffer_store_dword v252, v253, s[16:19], s52 offen
    s_branch adaLN_cond__spectral_fnet__geglu_ffn__prompt_kernel_e101
adaLN_cond__spectral_fnet__geglu_ffn__prompt_kernel_s100:
    buffer_wbl2 sc1
    s_waitcnt vmcnt(0)
    buffer_store_dword v252, v253, s[16:19], s52 offen sc1
adaLN_cond__spectral_fnet__geglu_ffn__prompt_kernel_e101:
    s_mov_b64 exec, -1
    v_mfma_f32_16x16x32_bf16 v[24:27], v[236:239], a[132:135], v[24:27]
    v_mfma_f32_16x16x32_bf16 v[24:27], a[8:11], a[136:139], v[24:27]
    v_mfma_f32_16x16x32_bf16 v[28:31], v[240:243], a[132:135], v[28:31]
    buffer_load_dwordx4 a[180:183], v18, s[16:19], s61 offen offset:2048 sc1
    v_mfma_f32_16x16x32_bf16 v[28:31], a[12:15], a[136:139], v[28:31]
    v_mfma_f32_16x16x32_bf16 v[32:35], v[244:247], a[132:135], v[32:35]
    v_mfma_f32_16x16x32_bf16 v[32:35], a[16:19], a[136:139], v[32:35]
    v_mfma_f32_16x16x32_bf16 v[36:39], a[0:3], a[132:135], v[36:39]
    buffer_load_dwordx4 a[184:187], v18, s[16:19], s61 offen offset:3072 sc1
    v_mfma_f32_16x16x32_bf16 v[36:39], a[20:23], a[136:139], v[36:39]
    s_add_u32 s61, s61, 4096
    v_mfma_f32_16x16x32_bf16 v[40:43], a[4:7], a[132:135], v[40:43]
    v_mfma_f32_16x16x32_bf16 v[40:43], a[24:27], a[136:139], v[40:43]
    s_waitcnt vmcnt(8)
    v_cmp_ne_u32 vcc, s14, v251
    s_nop 0
    s_cbranch_vccz adaLN_cond__spectral_fnet__geglu_ffn__prompt_kernel_ok102
    s_mov_b32 s52, 0
adaLN_cond__spectral_fnet__geglu_ffn__prompt_kernel_p103:
    buffer_load_dword v251, v14, s[16:19], s87 offen sc1
    s_waitcnt vmcnt(0)
    s_add_u32 s52, s52, 1
    s_cmp_gt_u32 s52, 0x400000
    s_cbranch_scc1 adaLN_cond__spectral_fnet__geglu_ffn__prompt_kernel_x104
    v_cmp_ne_u32 vcc, s14, v251
    s_nop 0
    s_cbranch_vccnz adaLN_cond__spectral_fnet__geglu_ffn__prompt_kernel_p103
adaLN_cond__spectral_fnet__geglu_ffn__prompt_kernel_x104:
adaLN_cond__spectral_fnet__geglu_ffn__prompt_kernel_ok102:
    v_mfma_f32_16x16x32_bf16 v[24:27], a[28:31], a[140:143], v[24:27]
    buffer_load_dwordx4 a[188:191], v18, s[16:19], s61 offen offset:0 sc1
    v_mfma_f32_16x16x32_bf16 v[24:27], a[48:51], a[144:147], v[24:27]
    v_mfma_f32_16x16x32_bf16 v[28:31], a[32:35], a[140:143], v[28:31]
    v_mfma_f32_16x16x32_bf16 v[28:31], a[52:55], a[144:147], v[28:31]
    v_mfma_f32_16x16x32_bf16 v[32:35], a[36:39], a[140:143], v[32:35]
    buffer_load_dwordx4 a[192:195], v18, s[16:19], s61 offen offset:1024 sc1
    v_mfma_f32_16x16x32_bf16 v[32:35], a[56:59], a[144:147], v[32:35]
    v_mfma_f32_16x16x32_bf16 v[36:39], a[40:43], a[140:143], v[36:39]
    v_mfma_f32_16x16x32_bf16 v[36:39], a[60:63], a[144:147], v[36:39]
    v_mfma_f32_16x16x32_bf16 v[40:43], a[44:47], a[140:143], v[40:43]
    buffer_load_dwordx4 a[196:199], v18, s[16:19], s61 offen offset:2048 sc1
    v_mfma_f32_16x16x32_bf16 v[40:43], a[64:67], a[144:147], v[40:43]
    v_mfma_f32_16x16x32_bf16 v[24:27], a[68:71], a[148:151], v[24:27]
    v_mfma_f32_16x16x32_bf16 v[24:27], a[88:91], a[152:155], v[24:27]
    v_mfma_f32_16x16x32_bf16 v[28:31], a[72:75], a[148:151], v[28:31]
    buffer_load_dwordx4 a[200:203], v18, s[16:19], s61 offen offset:3072 sc1
    v_mfma_f32_16x16x32_bf16 v[28:31], a[92:95], a[152:155], v[28:31]
    v_mfma_f32_16x16x32_bf16 v[32:35], a[76:79], a[148:151], v[32:35]
    v_mfma_f32_16x16x32_bf16 v[32:35], a[96:99], a[152:155], v[32:35]
    v_mfma_f32_16x16x32_bf16 v[36:39], a[80:83], a[148:151], v[36:39]
    buffer_load_dwordx4 v[20:23], v12, s[20:23], 0 offen sc1
    v_mfma_f32_16x16x32_bf16 v[36:39], a[100:103], a[152:155], v[36:39]
    v_mfma_f32_16x16x32_bf16 v[40:43], a[84:87], a[148:151], v[40:43]
    v_mfma_f32_16x16x32_bf16 v[40:43], a[104:107], a[152:155], v[40:43]
    s_waitcnt vmcnt(10)
    v_mfma_f32_16x16x32_bf16 v[44:47], v[116:119], a[156:159], 0
    buffer_load_dwordx4 a[204:207], v18, s[16:19], s62 offen offset:0 sc1
    v_mfma_f32_16x16x32_bf16 v[44:47], v[136:139], a[160:163], v[44:47]
    v_mfma_f32_16x16x32_bf16 v[48:51], v[120:123], a[156:159], 0
    v_mfma_f32_16x16x32_bf16 v[48:51], v[140:143], a[160:163], v[48:51]
    v_mfma_f32_16x16x32_bf16 v[52:55], v[124:127], a[156:159], 0
    buffer_load_dwordx4 a[208:211], v18, s[16:19], s62 offen offset:1024 sc1
    v_mfma_f32_16x16x32_bf16 v[52:55], v[144:147], a[160:163], v[52:55]
    ds_write_b128 v8, v[24:27] offset:0
    v_mfma_f32_16x16x32_bf16 v[56:59], v[128:131], a[156:159], 0
    v_mfma_f32_16x16x32_bf16 v[56:59], v[148:151], a[160:163], v[56:59]
    v_mfma_f32_16x16x32_bf16 v[60:63], v[132:135], a[156:159], 0
    ds_write_b128 v8, v[28:31] offset:1280
    buffer_load_dwordx4 a[212:215], v18, s[16:19], s62 offen offset:2048 sc1
    v_mfma_f32_16x16x32_bf16 v[60:63], v[152:155], a[160:163], v[60:63]
    v_mfma_f32_16x16x32_bf16 v[44:47], v[156:159], a[164:167], v[44:47]
    v_mfma_f32_16x16x32_bf16 v[44:47], v[176:179], a[168:171], v[44:47]
    ds_write_b128 v8, v[32:35] offset:2560
    v_mfma_f32_16x16x32_bf16 v[48:51], v[160:163], a[164:167], v[48:51]
    buffer_load_dwordx4 a[216:219], v18, s[16:19], s62 offen offset:3072 sc1
    v_mfma_f32_16x16x32_bf16 v[48:51], v[180:183], a[168:171], v[48:51]
    s_add_u32 s87, s68, 20480
    buffer_load_dword v251, v14, s[16:19], s87 offen sc1
    v_mfma_f32_16x16x32_bf16 v[52:55], v[164:167], a[164:167], v[52:55]
    ds_write_b128 v8, v[36:39] offset:3840
    s_add_u32 s62, s62, 4096
    v_mfma_f32_16x16x32_bf16 v[52:55], v[184:187], a[168:171], v[52:55]
    v_mfma_f32_16x16x32_bf16 v[56:59], v[168:171], a[164:167], v[56:59]
    buffer_load_dwordx4 a[220:223], v18, s[16:19], s62 offen offset:0 sc1
    v_mfma_f32_16x16x32_bf16 v[56:59], v[188:191], a[168:171], v[56:59]
    ds_write_b128 v8, v[40:43] offset:5120
    v_mfma_f32_16x16x32_bf16 v[60:63], v[172:175], a[164:167], v[60:63]
    v_mfma_f32_16x16x32_bf16 v[60:63], v[192:195], a[168:171], v[60:63]
    s_waitcnt vmcnt(11)
    v_mfma_f32_16x16x32_bf16 v[44:47], v[196:199], a[172:175], v[44:47]
    buffer_load_dwordx4 a[224:227], v18, s[16:19], s62 offen offset:1024 sc1
    v_mfma_f32_16x16x32_bf16 v[44:47], v[216:219], a[176:179], v[44:47]
    v_mfma_f32_16x16x32_bf16 v[48:51], v[200:203], a[172:175], v[48:51]
    v_mfma_f32_16x16x32_bf16 v[48:51], v[220:223], a[176:179], v[48:51]
    s_waitcnt lgkmcnt(0)
    s_barrier
    v_mfma_f32_16x16x32_bf16 v[52:55], v[204:207], a[172:175], v[52:55]
    buffer_load_dwordx4 a[228:231], v18, s[16:19], s62 offen offset:2048 sc1
    v_mfma_f32_16x16x32_bf16 v[52:55], v[224:227], a[176:179], v[52:55]
    ds_read_b128 v[64:67], v9 offset:0
    v_mfma_f32_16x16x32_bf16 v[56:59], v[208:211], a[172:175], v[56:59]
    ds_read_b128 v[68:71], v10 offset:0
    v_mfma_f32_16x16x32_bf16 v[56:59], v[228:231], a[176:179], v[56:59]
    ds_read_b128 v[72:75], v9 offset:6400
    v_mfma_f32_16x16x32_bf16 v[60:63], v[212:215], a[172:175], v[60:63]
    buffer_load_dwordx4 a[232:235], v18, s[16:19], s62 offen offset:3072 sc1
    v_mfma_f32_16x16x32_bf16 v[60:63], v[232:235], a[176:179], v[60:63]
    s_add_u32 s62, s62, 4096
    v_mfma_f32_16x16x32_bf16 v[44:47], v[236:239], a[180:183], v[44:47]
    ds_read_b128 v[76:79], v10 offset:6400
    v_mfma_f32_16x16x32_bf16 v[44:47], a[8:11], a[184:187], v[44:47]
    ds_read_b128 v[80:83], v9 offset:12800
    v_mfma_f32_16x16x32_bf16 v[48:51], v[240:243], a[180:183], v[48:51]
    buffer_load_dwordx4 a[236:239], v18, s[16:19], s62 offen offset:0 sc1
    v_mfma_f32_16x16x32_bf16 v[48:51], a[12:15], a[184:187], v[48:51]
    ds_read_b128 v[84:87], v10 offset:12800
    v_mfma_f32_16x16x32_bf16 v[52:55], v[244:247], a[180:183], v[52:55]
    ds_read_b128 v[88:91], v9 offset:19200
    v_mfma_f32_16x16x32_bf16 v[52:55], a[16:19], a[184:187], v[52:55]
    ds_read_b128 v[92:95], v10 offset:19200
    v_mfma_f32_16x16x32_bf16 v[56:59], a[0:3], a[180:183], v[56:59]
    buffer_load_dwordx4 a[240:243], v18, s[16:19], s62 offen offset:1024 sc1
    v_mfma_f32_16x16x32_bf16 v[56:59], a[20:23], a[184:187], v[56:59]
    v_mfma_f32_16x16x32_bf16 v[60:63], a[4:7], a[180:183], v[60:63]
    v_mfma_f32_16x16x32_bf16 v[60:63], a[24:27], a[184:187], v[60:63]
    s_waitcnt vmcnt(12)
    v_mfma_f32_16x16x32_bf16 v[44:47], a[28:31], a[188:191], v[44:47]
    buffer_load_dwordx4 a[244:247], v18, s[16:19], s62 offen offset:2048 sc1
    v_mfma_f32_16x16x32_bf16 v[44:47], a[48:51], a[192:195], v[44:47]
    v_mfma_f32_16x16x32_bf16 v[48:51], a[32:35], a[188:191], v[48:51]
    s_waitcnt lgkmcnt(5)
    v_add_f32 v64, v64, v72
    v_add_f32 v65, v65, v73
    v_mfma_f32_16x16x32_bf16 v[48:51], a[52:55], a[192:195], v[48:51]
    s_waitcnt vmcnt(7)
    v_cmp_ne_u32 vcc, s14, v251
    s_nop 0
    s_cbranch_vccz adaLN_cond__spectral_fnet__geglu_ffn__prompt_kernel_ok105
    s_mov_b32 s52, 0
adaLN_cond__spectral_fnet__geglu_ffn__prompt_kernel_p106:
    buffer_load_dword v251, v14, s[16:19], s87 offen sc1
    s_waitcnt vmcnt(0)
    s_add_u32 s52, s52, 1
    s_cmp_gt_u32 s52, 0x400000
    s_cbranch_scc1 adaLN_cond__spectral_fnet__geglu_ffn__prompt_kernel_x107
    v_cmp_ne_u32 vcc, s14, v251
    s_nop 0
    s_cbranch_vccnz adaLN_cond__spectral_fnet__geglu_ffn__prompt_kernel_p106
adaLN_cond__spectral_fnet__geglu_ffn__prompt_kernel_x107:
adaLN_cond__spectral_fnet__geglu_ffn__prompt_kernel_ok105:
    v_mfma_f32_16x16x32_bf16 v[52:55], a[36:39], a[188:191], v[52:55]
    buffer_load_dwordx4 a[248:251], v18, s[16:19], s62 offen offset:3072 sc1
    v_add_f32 v66, v66, v74
    v_mfma_f32_16x16x32_bf16 v[52:55], a[56:59], a[192:195], v[52:55]
    v_add_f32 v67, v67, v75
    s_waitcnt lgkmcnt(4)
    v_add_f32 v68, v68, v76
    v_mfma_f32_16x16x32_bf16 v[56:59], a[40:43], a[188:191], v[56:59]
    v_add_f32 v69, v69, v77
    v_add_f32 v70, v70, v78
    v_mfma_f32_16x16x32_bf16 v[56:59], a[60:63], a[192:195], v[56:59]
    v_add_f32 v71, v71, v79
    s_waitcnt lgkmcnt(1)
    v_add_f32 v80, v80, v88
    v_mfma_f32_16x16x32_bf16 v[60:63], a[44:47], a[188:191], v[60:63]
    buffer_load_dwordx4 v[4:7], v13, s[20:23], 0 offen sc1
    v_add_f32 v81, v81, v89
    v_mfma_f32_16x16x32_bf16 v[60:63], a[64:67], a[192:195], v[60:63]
    v_add_f32 v82, v82, v90
    v_add_f32 v83, v83, v91
    v_mfma_f32_16x16x32_bf16 v[44:47], a[68:71], a[196:199], v[44:47]
    s_waitcnt lgkmcnt(0)
    v_add_f32 v84, v84, v92
    v_add_f32 v85, v85, v93
    v_mfma_f32_16x16x32_bf16 v[44:47], a[88:91], a[200:203], v[44:47]
    v_add_f32 v86, v86, v94
    v_add_f32 v87, v87, v95
    v_mfma_f32_16x16x32_bf16 v[48:51], a[72:75], a[196:199], v[48:51]
    buffer_load_dwordx4 a[108:111], v18, s[16:19], s63 offen offset:0 sc1
    v_lshlrev_b32 v72, 16, v20
    v_mfma_f32_16x16x32_bf16 v[48:51], a[92:95], a[200:203], v[48:51]
    v_and_b32 v73, 0xffff0000, v20
    v_lshlrev_b32 v74, 16, v21
    v_mfma_f32_16x16x32_bf16 v[52:55], a[76:79], a[196:199], v[52:55]
    v_and_b32 v75, 0xffff0000, v21
    v_lshlrev_b32 v76, 16, v22
    v_mfma_f32_16x16x32_bf16 v[52:55], a[96:99], a[200:203], v[52:55]
    v_and_b32 v77, 0xffff0000, v22
    v_lshlrev_b32 v78, 16, v23
    v_mfma_f32_16x16x32_bf16 v[56:59], a[80:83], a[196:199], v[56:59]
    buffer_load_dwordx4 a[112:115], v18, s[16:19], s63 offen offset:1024 sc1
    v_and_b32 v79, 0xffff0000, v23
    v_mfma_f32_16x16x32_bf16 v[56:59], a[100:103], a[200:203], v[56:59]
    v_add_f32 v64, v64, v80
    v_add_f32 v65, v65, v81
    v_mfma_f32_16x16x32_bf16 v[60:63], a[84:87], a[196:199], v[60:63]
    v_add_f32 v66, v66, v82
    v_add_f32 v67, v67, v83
    v_mfma_f32_16x16x32_bf16 v[60:63], a[104:107], a[200:203], v[60:63]
    v_add_f32 v68, v68, v84
    v_add_f32 v69, v69, v85
    v_add_f32 v70, v70, v86
    v_add_f32 v71, v71, v87
    v_fmac_f32 v72, v64, v96
    v_fmac_f32 v73, v65, v97
    v_fmac_f32 v74, v66, v98
    v_fmac_f32 v75, v67, v99
    v_fmac_f32 v76, v68, v100
    v_fmac_f32 v77, v69, v101
    v_fmac_f32 v78, v70, v102
    v_fmac_f32 v79, v71, v103
    v_cvt_pk_bf16_f32 v64, v72, v73
    v_cvt_pk_bf16_f32 v65, v74, v75
    v_cvt_pk_bf16_f32 v66, v76, v77
    v_cvt_pk_bf16_f32 v67, v78, v79
    s_mov_b32 exec_hi, 0xff
    buffer_store_dwordx4 v[64:67], v12, s[20:23], 0 offen nt
    s_mov_b32 exec_hi, -1
    v_mfma_f32_16x16x32_bf16 v[24:27], v[116:119], a[204:207], 0
    buffer_load_dwordx4 a[116:119], v18, s[16:19], s63 offen offset:2048 sc1
    v_mfma_f32_16x16x32_bf16 v[24:27], v[136:139], a[208:211], v[24:27]
    v_mfma_f32_16x16x32_bf16 v[28:31], v[120:123], a[204:207], 0
    v_mfma_f32_16x16x32_bf16 v[28:31], v[140:143], a[208:211], v[28:31]
    v_mfma_f32_16x16x32_bf16 v[32:35], v[124:127], a[204:207], 0
    buffer_load_dwordx4 a[120:123], v18, s[16:19], s63 offen offset:3072 sc1
    v_mfma_f32_16x16x32_bf16 v[32:35], v[144:147], a[208:211], v[32:35]
    ds_write_b128 v8, v[44:47] offset:25600
    s_add_u32 s63, s63, 4096
    v_mfma_f32_16x16x32_bf16 v[36:39], v[128:131], a[204:207], 0
    v_mfma_f32_16x16x32_bf16 v[36:39], v[148:151], a[208:211], v[36:39]
    v_mfma_f32_16x16x32_bf16 v[40:43], v[132:135], a[204:207], 0
    ds_write_b128 v8, v[48:51] offset:26880
    buffer_load_dwordx4 a[124:127], v18, s[16:19], s63 offen offset:0 sc1
    v_mfma_f32_16x16x32_bf16 v[40:43], v[152:155], a[208:211], v[40:43]
    v_mfma_f32_16x16x32_bf16 v[24:27], v[156:159], a[212:215], v[24:27]
    v_mfma_f32_16x16x32_bf16 v[24:27], v[176:179], a[216:219], v[24:27]
    ds_write_b128 v8, v[52:55] offset:28160
    v_mfma_f32_16x16x32_bf16 v[28:31], v[160:163], a[212:215], v[28:31]
    buffer_load_dwordx4 a[128:131], v18, s[16:19], s63 offen offset:1024 sc1
    v_mfma_f32_16x16x32_bf16 v[28:31], v[180:183], a[216:219], v[28:31]
    v_mfma_f32_16x16x32_bf16 v[32:35], v[164:167], a[212:215], v[32:35]
    ds_write_b128 v8, v[56:59] offset:29440
    v_mfma_f32_16x16x32_bf16 v[32:35], v[184:187], a[216:219], v[32:35]
    v_mfma_f32_16x16x32_bf16 v[36:39], v[168:171], a[212:215], v[36:39]
    buffer_load_dwordx4 a[132:135], v18, s[16:19], s63 offen offset:2048 sc1
    v_mfma_f32_16x16x32_bf16 v[36:39], v[188:191], a[216:219], v[36:39]
    ds_write_b128 v8, v[60:63] offset:30720
    v_mfma_f32_16x16x32_bf16 v[40:43], v[172:175], a[212:215], v[40:43]
    v_mfma_f32_16x16x32_bf16 v[40:43], v[192:195], a[216:219], v[40:43]
    s_waitcnt vmcnt(13)
    v_mfma_f32_16x16x32_bf16 v[24:27], v[196:199], a[220:223], v[24:27]
    buffer_load_dwordx4 a[136:139], v18, s[16:19], s63 offen offset:3072 sc1
    v_mfma_f32_16x16x32_bf16 v[24:27], v[216:219], a[224:227], v[24:27]
    s_add_u32 s63, s63, 4096
    v_mfma_f32_16x16x32_bf16 v[28:31], v[200:203], a[220:223], v[28:31]
    v_mfma_f32_16x16x32_bf16 v[28:31], v[220:223], a[224:227], v[28:31]
    s_waitcnt lgkmcnt(0)
    s_barrier
    v_mfma_f32_16x16x32_bf16 v[32:35], v[204:207], a[220:223], v[32:35]
    buffer_load_dwordx4 a[140:143], v18, s[16:19], s63 offen offset:0 sc1
    v_mfma_f32_16x16x32_bf16 v[32:35], v[224:227], a[224:227], v[32:35]
    ds_read_b128 v[64:67], v9 offset:25600
    v_mfma_f32_16x16x32_bf16 v[36:39], v[208:211], a[220:223], v[36:39]
    ds_read_b128 v[68:71], v10 offset:25600
    v_mfma_f32_16x16x32_bf16 v[36:39], v[228:231], a[224:227], v[36:39]
    ds_read_b128 v[72:75], v9 offset:32000
    v_mfma_f32_16x16x32_bf16 v[40:43], v[212:215], a[220:223], v[40:43]
    buffer_load_dwordx4 a[144:147], v18, s[16:19], s63 offen offset:1024 sc1
    v_mfma_f32_16x16x32_bf16 v[40:43], v[232:235], a[224:227], v[40:43]
    ds_read_b128 v[76:79], v10 offset:32000
    v_mfma_f32_16x16x32_bf16 v[24:27], v[236:239], a[228:231], v[24:27]
    ds_read_b128 v[80:83], v9 offset:38400
    v_mfma_f32_16x16x32_bf16 v[24:27], a[8:11], a[232:235], v[24:27]
    ds_read_b128 v[84:87], v10 offset:38400
    v_mfma_f32_16x16x32_bf16 v[28:31], v[240:243], a[228:231], v[28:31]
    buffer_load_dwordx4 a[148:151], v18, s[16:19], s63 offen offset:2048 sc1
    v_mfma_f32_16x16x32_bf16 v[28:31], a[12:15], a[232:235], v[28:31]
    ds_read_b128 v[88:91], v9 offset:44800
    v_mfma_f32_16x16x32_bf16 v[32:35], v[244:247], a[228:231], v[32:35]
    ds_read_b128 v[92:95], v10 offset:44800
    v_mfma_f32_16x16x32_bf16 v[32:35], a[16:19], a[232:235], v[32:35]
    v_mfma_f32_16x16x32_bf16 v[36:39], a[0:3], a[228:231], v[36:39]
    buffer_load_dwordx4 a[152:155], v18, s[16:19], s63 offen offset:3072 sc1
    v_mfma_f32_16x16x32_bf16 v[36:39], a[20:23], a[232:235], v[36:39]
    v_mfma_f32_16x16x32_bf16 v[40:43], a[4:7], a[228:231], v[40:43]
    v_mfma_f32_16x16x32_bf16 v[40:43], a[24:27], a[232:235], v[40:43]
    s_waitcnt vmcnt(14)
    v_mfma_f32_16x16x32_bf16 v[24:27], a[28:31], a[236:239], v[24:27]
    buffer_load_dwordx4 v[20:23], v16, s[20:23], 0 offen sc1
    v_mfma_f32_16x16x32_bf16 v[24:27], a[48:51], a[240:243], v[24:27]
    s_waitcnt lgkmcnt(5)
    v_add_f32 v64, v64, v72
    v_add_f32 v65, v65, v73
    v_mfma_f32_16x16x32_bf16 v[28:31], a[32:35], a[236:239], v[28:31]
    v_add_f32 v66, v66, v74
    v_add_f32 v67, v67, v75
    v_mfma_f32_16x16x32_bf16 v[28:31], a[52:55], a[240:243], v[28:31]
    s_waitcnt lgkmcnt(4)
    v_add_f32 v68, v68, v76
    v_add_f32 v69, v69, v77
    v_mfma_f32_16x16x32_bf16 v[32:35], a[36:39], a[236:239], v[32:35]
    v_add_f32 v70, v70, v78
    v_add_f32 v71, v71, v79
    v_mfma_f32_16x16x32_bf16 v[32:35], a[56:59], a[240:243], v[32:35]
    s_waitcnt lgkmcnt(1)
    v_add_f32 v80, v80, v88
    v_add_f32 v81, v81, v89
    v_mfma_f32_16x16x32_bf16 v[36:39], a[40:43], a[236:239], v[36:39]
    v_add_f32 v82, v82, v90
    v_add_f32 v83, v83, v91
    v_mfma_f32_16x16x32_bf16 v[36:39], a[60:63], a[240:243], v[36:39]
    s_waitcnt lgkmcnt(0)
    v_add_f32 v84, v84, v92
    v_add_f32 v85, v85, v93
    v_mfma_f32_16x16x32_bf16 v[40:43], a[44:47], a[236:239], v[40:43]
    v_add_f32 v86, v86, v94
    v_add_f32 v87, v87, v95
    v_mfma_f32_16x16x32_bf16 v[40:43], a[64:67], a[240:243], v[40:43]
    s_waitcnt vmcnt(14)
    v_lshlrev_b32 v72, 16, v4
    v_and_b32 v73, 0xffff0000, v4
    v_mfma_f32_16x16x32_bf16 v[24:27], a[68:71], a[244:247], v[24:27]
    v_lshlrev_b32 v74, 16, v5
    v_and_b32 v75, 0xffff0000, v5
    v_mfma_f32_16x16x32_bf16 v[24:27], a[88:91], a[248:251], v[24:27]
    v_lshlrev_b32 v76, 16, v6
    v_and_b32 v77, 0xffff0000, v6
    v_mfma_f32_16x16x32_bf16 v[28:31], a[72:75], a[244:247], v[28:31]
    v_lshlrev_b32 v78, 16, v7
    v_and_b32 v79, 0xffff0000, v7
    v_mfma_f32_16x16x32_bf16 v[28:31], a[92:95], a[248:251], v[28:31]
    v_add_f32 v64, v64, v80
    v_add_f32 v65, v65, v81
    v_mfma_f32_16x16x32_bf16 v[32:35], a[76:79], a[244:247], v[32:35]
    v_add_f32 v66, v66, v82
    v_add_f32 v67, v67, v83
    v_mfma_f32_16x16x32_bf16 v[32:35], a[96:99], a[248:251], v[32:35]
    v_add_f32 v68, v68, v84
    v_add_f32 v69, v69, v85
    v_mfma_f32_16x16x32_bf16 v[36:39], a[80:83], a[244:247], v[36:39]
    v_add_f32 v70, v70, v86
    v_add_f32 v71, v71, v87
    v_mfma_f32_16x16x32_bf16 v[36:39], a[100:103], a[248:251], v[36:39]
    v_fmac_f32 v72, v64, v96
    v_fmac_f32 v73, v65, v97
    v_mfma_f32_16x16x32_bf16 v[40:43], a[84:87], a[244:247], v[40:43]
    v_fmac_f32 v74, v66, v98
    v_fmac_f32 v75, v67, v99
    v_mfma_f32_16x16x32_bf16 v[40:43], a[104:107], a[248:251], v[40:43]
    v_fmac_f32 v76, v68, v100
    v_fmac_f32 v77, v69, v101
    v_fmac_f32 v78, v70, v102
    v_fmac_f32 v79, v71, v103
    v_cvt_pk_bf16_f32 v64, v72, v73
    v_cvt_pk_bf16_f32 v65, v74, v75
    v_cvt_pk_bf16_f32 v66, v76, v77
    v_cvt_pk_bf16_f32 v67, v78, v79
    s_mov_b32 exec_hi, 0xff
    buffer_store_dwordx4 v[64:67], v13, s[20:23], 0 offen nt
    s_mov_b32 exec_hi, -1
    s_waitcnt vmcnt(10)
    v_mfma_f32_16x16x32_bf16 v[44:47], v[116:119], a[108:111], 0
    buffer_load_dwordx4 v[4:7], v17, s[20:23], 0 offen sc1
    v_mfma_f32_16x16x32_bf16 v[44:47], v[136:139], a[112:115], v[44:47]
    v_mfma_f32_16x16x32_bf16 v[48:51], v[120:123], a[108:111], 0
    v_mfma_f32_16x16x32_bf16 v[48:51], v[140:143], a[112:115], v[48:51]
    v_mfma_f32_16x16x32_bf16 v[52:55], v[124:127], a[108:111], 0
    v_mfma_f32_16x16x32_bf16 v[52:55], v[144:147], a[112:115], v[52:55]
    ds_write_b128 v8, v[24:27] offset:0
    v_mfma_f32_16x16x32_bf16 v[56:59], v[128:131], a[108:111], 0
    v_mfma_f32_16x16x32_bf16 v[56:59], v[148:151], a[112:115], v[56:59]
    v_mfma_f32_16x16x32_bf16 v[60:63], v[132:135], a[108:111], 0
    ds_write_b128 v8, v[28:31] offset:1280
    v_mfma_f32_16x16x32_bf16 v[60:63], v[152:155], a[112:115], v[60:63]
    v_mfma_f32_16x16x32_bf16 v[44:47], v[156:159], a[116:119], v[44:47]
    v_mfma_f32_16x16x32_bf16 v[44:47], v[176:179], a[120:123], v[44:47]
    ds_write_b128 v8, v[32:35] offset:2560
    v_mfma_f32_16x16x32_bf16 v[48:51], v[160:163], a[116:119], v[48:51]
    v_mfma_f32_16x16x32_bf16 v[48:51], v[180:183], a[120:123], v[48:51]
    v_mfma_f32_16x16x32_bf16 v[52:55], v[164:167], a[116:119], v[52:55]
    ds_write_b128 v8, v[36:39] offset:3840
    v_mfma_f32_16x16x32_bf16 v[52:55], v[184:187], a[120:123], v[52:55]
    v_mfma_f32_16x16x32_bf16 v[56:59], v[168:171], a[116:119], v[56:59]
    v_mfma_f32_16x16x32_bf16 v[56:59], v[188:191], a[120:123], v[56:59]
    ds_write_b128 v8, v[40:43] offset:5120
    v_mfma_f32_16x16x32_bf16 v[60:63], v[172:175], a[116:119], v[60:63]
    v_mfma_f32_16x16x32_bf16 v[60:63], v[192:195], a[120:123], v[60:63]
    s_waitcnt vmcnt(7)
    v_mfma_f32_16x16x32_bf16 v[44:47], v[196:199], a[124:127], v[44:47]
    v_mfma_f32_16x16x32_bf16 v[44:47], v[216:219], a[128:131], v[44:47]
    v_mfma_f32_16x16x32_bf16 v[44:47], v[236:239], a[132:135], v[44:47]
    v_mfma_f32_16x16x32_bf16 v[44:47], a[8:11], a[136:139], v[44:47]
    s_waitcnt lgkmcnt(0)
    s_barrier
    s_waitcnt vmcnt(3)
    v_mfma_f32_16x16x32_bf16 v[44:47], a[28:31], a[140:143], v[44:47]
    ds_read_b128 v[64:67], v9 offset:0
    v_mfma_f32_16x16x32_bf16 v[44:47], a[48:51], a[144:147], v[44:47]
    ds_read_b128 v[68:71], v10 offset:0
    v_mfma_f32_16x16x32_bf16 v[44:47], a[68:71], a[148:151], v[44:47]
    ds_read_b128 v[72:75], v9 offset:6400
    v_mfma_f32_16x16x32_bf16 v[44:47], a[88:91], a[152:155], v[44:47]
    ds_read_b128 v[76:79], v10 offset:6400
    v_mfma_f32_16x16x32_bf16 v[48:51], v[200:203], a[124:127], v[48:51]
    ds_read_b128 v[80:83], v9 offset:12800
    v_mfma_f32_16x16x32_bf16 v[48:51], v[220:223], a[128:131], v[48:51]
    ds_read_b128 v[84:87], v10 offset:12800
    v_mfma_f32_16x16x32_bf16 v[48:51], v[240:243], a[132:135], v[48:51]
    ds_read_b128 v[88:91], v9 offset:19200
    v_mfma_f32_16x16x32_bf16 v[48:51], a[12:15], a[136:139], v[48:51]
    ds_write_b128 v8, v[44:47] offset:25600
    v_mfma_f32_16x16x32_bf16 v[48:51], a[32:35], a[140:143], v[48:51]
    ds_read_b128 v[92:95], v10 offset:19200
adaLN_cond__spectral_fnet__geglu_ffn__prompt_kernel_hop9:
    s_cbranch_execz adaLN_cond__spectral_fnet__geglu_ffn__prompt_kernel_back12
    v_mfma_f32_16x16x32_bf16 v[48:51], a[52:55], a[144:147], v[48:51]
    v_mfma_f32_16x16x32_bf16 v[48:51], a[72:75], a[148:151], v[48:51]
    v_mfma_f32_16x16x32_bf16 v[48:51], a[92:95], a[152:155], v[48:51]
    v_mfma_f32_16x16x32_bf16 v[52:55], v[204:207], a[124:127], v[52:55]
    v_mfma_f32_16x16x32_bf16 v[52:55], v[224:227], a[128:131], v[52:55]
    v_mfma_f32_16x16x32_bf16 v[52:55], v[244:247], a[132:135], v[52:55]
    v_mfma_f32_16x16x32_bf16 v[52:55], a[16:19], a[136:139], v[52:55]
    s_nop 3
    ds_write_b128 v8, v[48:51] offset:26880
    v_mfma_f32_16x16x32_bf16 v[52:55], a[36:39], a[140:143], v[52:55]
    s_waitcnt lgkmcnt(7)
    v_add_f32 v64, v64, v72
    v_add_f32 v65, v65, v73
    v_mfma_f32_16x16x32_bf16 v[52:55], a[56:59], a[144:147], v[52:55]
    v_add_f32 v66, v66, v74
    v_add_f32 v67, v67, v75
    v_mfma_f32_16x16x32_bf16 v[52:55], a[76:79], a[148:151], v[52:55]
    s_waitcnt lgkmcnt(6)
    v_add_f32 v68, v68, v76
    v_add_f32 v69, v69, v77
    v_mfma_f32_16x16x32_bf16 v[52:55], a[96:99], a[152:155], v[52:55]
    v_add_f32 v70, v70, v78
    v_add_f32 v71, v71, v79
    v_mfma_f32_16x16x32_bf16 v[56:59], v[208:211], a[124:127], v[56:59]
    s_waitcnt lgkmcnt(3)
    v_add_f32 v80, v80, v88
    v_add_f32 v81, v81, v89
    v_mfma_f32_16x16x32_bf16 v[56:59], v[228:231], a[128:131], v[56:59]
    v_add_f32 v82, v82, v90
    v_add_f32 v83, v83, v91
    v_mfma_f32_16x16x32_bf16 v[56:59], a[0:3], a[132:135], v[56:59]
    s_waitcnt lgkmcnt(1)
    v_add_f32 v84, v84, v92
    v_add_f32 v85, v85, v93
    v_mfma_f32_16x16x32_bf16 v[56:59], a[20:23], a[136:139], v[56:59]
    ds_write_b128 v8, v[52:55] offset:28160
    v_add_f32 v86, v86, v94
    v_mfma_f32_16x16x32_bf16 v[56:59], a[40:43], a[140:143], v[56:59]
    v_add_f32 v87, v87, v95
    s_waitcnt vmcnt(2)
    v_lshlrev_b32 v72, 16, v20
    v_mfma_f32_16x16x32_bf16 v[56:59], a[60:63], a[144:147], v[56:59]
    v_and_b32 v73, 0xffff0000, v20
    v_lshlrev_b32 v74, 16, v21
    v_mfma_f32_16x16x32_bf16 v[56:59], a[80:83], a[148:151], v[56:59]
    v_and_b32 v75, 0xffff0000, v21
    v_lshlrev_b32 v76, 16, v22
    v_mfma_f32_16x16x32_bf16 v[56:59], a[100:103], a[152:155], v[56:59]
    v_and_b32 v77, 0xffff0000, v22
    v_lshlrev_b32 v78, 16, v23
    v_mfma_f32_16x16x32_bf16 v[60:63], v[212:215], a[124:127], v[60:63]
    v_and_b32 v79, 0xffff0000, v23
    v_add_f32 v64, v64, v80
    v_mfma_f32_16x16x32_bf16 v[60:63], v[232:235], a[128:131], v[60:63]
    v_add_f32 v65, v65, v81
    v_add_f32 v66, v66, v82
    v_mfma_f32_16x16x32_bf16 v[60:63], a[4:7], a[132:135], v[60:63]
    v_add_f32 v67, v67, v83
    v_add_f32 v68, v68, v84
    v_mfma_f32_16x16x32_bf16 v[60:63], a[24:27], a[136:139], v[60:63]
    ds_write_b128 v8, v[56:59] offset:29440
    v_add_f32 v69, v69, v85
    v_mfma_f32_16x16x32_bf16 v[60:63], a[44:47], a[140:143], v[60:63]
    v_add_f32 v70, v70, v86
    v_add_f32 v71, v71, v87
    v_mfma_f32_16x16x32_bf16 v[60:63], a[64:67], a[144:147], v[60:63]
    v_fmac_f32 v72, v64, v96
    v_fmac_f32 v73, v65, v97
    v_mfma_f32_16x16x32_bf16 v[60:63], a[84:87], a[148:151], v[60:63]
    v_fmac_f32 v74, v66, v98
    v_fmac_f32 v75, v67, v99
    v_mfma_f32_16x16x32_bf16 v[60:63], a[104:107], a[152:155], v[60:63]
    v_fmac_f32 v76, v68, v100
    v_fmac_f32 v77, v69, v101
    v_fmac_f32 v78, v70, v102
    v_fmac_f32 v79, v71, v103
    v_cvt_pk_bf16_f32 v64, v72, v73
    v_cvt_pk_bf16_f32 v65, v74, v75
    v_cvt_pk_bf16_f32 v66, v76, v77
    v_cvt_pk_bf16_f32 v67, v78, v79
    s_mov_b32 exec_hi, 0xff
    buffer_store_dwordx4 v[64:67], v16, s[20:23], 0 offen nt
    s_mov_b32 exec_hi, -1
    s_waitcnt vmcnt(1)
    v_lshlrev_b32 v64, 16, v4
    v_and_b32 v65, 0xffff0000, v4
    v_lshlrev_b32 v66, 16, v5
    v_and_b32 v67, 0xffff0000, v5
    v_lshlrev_b32 v68, 16, v6
    v_and_b32 v69, 0xffff0000, v6
    v_lshlrev_b32 v70, 16, v7
    v_and_b32 v71, 0xffff0000, v7
    ds_write_b128 v8, v[60:63] offset:30720
    s_waitcnt lgkmcnt(0)
    s_barrier
    ds_read_b128 v[116:119], v9 offset:25600
    ds_read_b128 v[120:123], v10 offset:25600
    ds_read_b128 v[124:127], v9 offset:32000
    ds_read_b128 v[128:131], v10 offset:32000
    ds_read_b128 v[132:135], v9 offset:38400
    ds_read_b128 v[136:139], v10 offset:38400
    ds_read_b128 v[140:143], v9 offset:44800
    ds_read_b128 v[144:147], v10 offset:44800
    s_waitcnt lgkmcnt(5)
    v_pk_add_f32 v[116:117], v[116:117], v[124:125]
    v_pk_add_f32 v[118:119], v[118:119], v[126:127]
    s_waitcnt lgkmcnt(4)
    v_pk_add_f32 v[120:121], v[120:121], v[128:129]
    v_pk_add_f32 v[122:123], v[122:123], v[130:131]
    s_waitcnt lgkmcnt(1)
    v_pk_add_f32 v[132:133], v[132:133], v[140:141]
    v_pk_add_f32 v[134:135], v[134:135], v[142:143]
    s_waitcnt lgkmcnt(0)
    v_pk_add_f32 v[136:137], v[136:137], v[144:145]
    v_pk_add_f32 v[138:139], v[138:139], v[146:147]
    v_pk_add_f32 v[116:117], v[116:117], v[132:133]
    v_pk_add_f32 v[118:119], v[118:119], v[134:135]
    v_pk_add_f32 v[120:121], v[120:121], v[136:137]
    v_pk_add_f32 v[122:123], v[122:123], v[138:139]
    v_pk_fma_f32 v[116:117], v[116:117], v[96:97], v[64:65]
    v_pk_fma_f32 v[118:119], v[118:119], v[98:99], v[66:67]
    v_pk_fma_f32 v[120:121], v[120:121], v[100:101], v[68:69]
    v_pk_fma_f32 v[122:123], v[122:123], v[102:103], v[70:71]
    v_cvt_pk_bf16_f32 v116, v116, v117
    v_cvt_pk_bf16_f32 v117, v118, v119
    v_cvt_pk_bf16_f32 v118, v120, v121
    v_cvt_pk_bf16_f32 v119, v122, v123
    s_mov_b32 exec_hi, 0xff
    buffer_store_dwordx4 v[116:119], v17, s[20:23], 0 offen nt
adaLN_cond__spectral_fnet__geglu_ffn__prompt_kernel_end1:
    s_endpgm
.p2align 8
adaLN_cond__spectral_fnet__geglu_ffn__prompt_kernel_tab:
.long 0x00003f80, 0x00003f80, 0x00003f80, 0x00003f80, 0x00003f80, 0x3ec43f6d, 0x3f353f35, 0x3f6d3ec4
.long 0x00003f80, 0x3f353f35, 0x3f80248d, 0x3f35bf35, 0x00003f80, 0x3f6d3ec4, 0x3f35bf35, 0xbec4bf6d
.long 0x00003f80, 0x3f80248d, 0x250dbf80, 0xbf80a554, 0x00003f80, 0x3f6dbec4, 0xbf35bf35, 0xbec43f6d
.long 0x00003f80, 0x3f35bf35, 0xbf80a554, 0x3f353f35, 0x00003f80, 0x3ec4bf6d, 0xbf353f35, 0x3f6dbec4
.long 0x00003f80, 0x250dbf80, 0x00003f80, 0x250dbf80, 0x00003f80, 0xbec4bf6d, 0x3f353f35, 0xbf6dbec4
.long 0x00003f80, 0xbf35bf35, 0x3f80248d, 0xbf353f35, 0x00003f80, 0xbf6dbec4, 0x3f35bf35, 0x3ec43f6d
.long 0x00003f80, 0xbf80a554, 0x250dbf80, 0x3f80248d, 0x00003f80, 0xbf6d3ec4, 0xbf35bf35, 0x3ec4bf6d
.long 0x00003f80, 0xbf353f35, 0xbf80a554, 0xbf35bf35, 0x00003f80, 0xbec43f6d, 0xbf353f35, 0xbf6d3ec4
.long 0x00003f80, 0x00003f80, 0x00003f80, 0x00003f80, 0x3f80248d, 0x3f6dbec4, 0x3f35bf35, 0x3ec4bf6d
.long 0x250dbf80, 0xbf35bf35, 0xbf80a554, 0xbf353f35, 0xbf80a554, 0xbec43f6d, 0x3f353f35, 0x3f6dbec4
.long 0x00003f80, 0x3f80248d, 0x250dbf80, 0xbf80a554, 0x3f80248d, 0xbec4bf6d, 0xbf353f35, 0x3f6d3ec4
.long 0x250dbf80, 0xbf353f35, 0x3f80248d, 0xbf35bf35, 0xbf80a554, 0x3f6d3ec4, 0xbf35bf35, 0x3ec43f6d
.long 0x00003f80, 0x250dbf80, 0x00003f80, 0x250dbf80, 0x3f80248d, 0xbf6d3ec4, 0x3f35bf35, 0xbec43f6d
.long 0x250dbf80, 0x3f353f35, 0xbf80a554, 0x3f35bf35, 0xbf80a554, 0x3ec4bf6d, 0x3f353f35, 0xbf6d3ec4
.long 0x00003f80, 0xbf80a554, 0x250dbf80, 0x3f80248d, 0x3f80248d, 0x3ec43f6d, 0xbf353f35, 0xbf6dbec4
.long 0x250dbf80, 0x3f35bf35, 0x3f80248d, 0x3f353f35, 0xbf80a554, 0xbf6dbec4, 0xbf35bf35, 0xbec4bf6d
.long 0x00003f80, 0x00003f80, 0x00003f80, 0x00003f80, 0x250dbf80, 0xbec4bf6d, 0xbf35bf35, 0xbf6dbec4
.long 0x00003f80, 0x3f353f35, 0x3f80248d, 0x3f35bf35, 0x250dbf80, 0xbf6dbec4, 0xbf353f35, 0x3ec43f6d
.long 0x00003f80, 0x3f80248d, 0x250dbf80, 0xbf80a554, 0x250dbf80, 0xbf6d3ec4, 0x3f353f35, 0x3ec4bf6d
.long 0x00003f80, 0x3f35bf35, 0xbf80a554, 0x3f353f35, 0x250dbf80, 0xbec43f6d, 0x3f35bf35, 0xbf6d3ec4
.long 0x00003f80, 0x250dbf80, 0x00003f80, 0x250dbf80, 0x250dbf80, 0x3ec43f6d, 0xbf35bf35, 0x3f6d3ec4
.long 0x00003f80, 0xbf35bf35, 0x3f80248d, 0xbf353f35, 0x250dbf80, 0x3f6d3ec4, 0xbf353f35, 0xbec4bf6d
.long 0x00003f80, 0xbf80a554, 0x250dbf80, 0x3f80248d, 0x250dbf80, 0x3f6dbec4, 0x3f353f35, 0xbec43f6d
.long 0x00003f80, 0xbf353f35, 0xbf80a554, 0xbf35bf35, 0x250dbf80, 0x3ec4bf6d, 0x3f35bf35, 0x3f6dbec4
.long 0x00003f80, 0x00003f80, 0x00003f80, 0x00003f80, 0xbf80a554, 0xbf6d3ec4, 0xbf353f35, 0xbec43f6d
.long 0x250dbf80, 0xbf35bf35, 0xbf80a554, 0xbf353f35, 0x3f80248d, 0x3ec4bf6d, 0xbf35bf35, 0xbf6d3ec4
.long 0x00003f80, 0x3f80248d, 0x250dbf80, 0xbf80a554, 0xbf80a554, 0x3ec43f6d, 0x3f35bf35, 0xbf6dbec4
.long 0x250dbf80, 0xbf353f35, 0x3f80248d, 0xbf35bf35, 0x3f80248d, 0xbf6dbec4, 0x3f353f35, 0xbec4bf6d
.long 0x00003f80, 0x250dbf80, 0x00003f80, 0x250dbf80, 0xbf80a554, 0x3f6dbec4, 0xbf353f35, 0x3ec4bf6d
.long 0x250dbf80, 0x3f353f35, 0xbf80a554, 0x3f35bf35, 0x3f80248d, 0xbec43f6d, 0xbf35bf35, 0x3f6dbec4
.long 0x00003f80, 0xbf80a554, 0x250dbf80, 0x3f80248d, 0xbf80a554, 0xbec4bf6d, 0x3f35bf35, 0x3f6d3ec4
.long 0x250dbf80, 0x3f35bf35, 0x3f80248d, 0x3f353f35, 0x3f80248d, 0x3f6d3ec4, 0x3f353f35, 0x3ec43f6d
.long 0x3f808000, 0x3f808000, 0x3f808000, 0x3f808000, 0x3f808000, 0x3f6dbec4, 0x3f35bf35, 0x3ec4bf6d
.long 0x3f808000, 0x3f35bf35, 0x248dbf80, 0xbf35bf35, 0x3f808000, 0x3ec4bf6d, 0xbf35bf35, 0xbf6d3ec4
.long 0x3f808000, 0x248dbf80, 0xbf80a50d, 0xa5543f80, 0x3f808000, 0xbec4bf6d, 0xbf353f35, 0x3f6d3ec4
.long 0x3f808000, 0xbf35bf35, 0xa5543f80, 0x3f35bf35, 0x3f808000, 0xbf6dbec4, 0x3f353f35, 0xbec4bf6d
.long 0x3f808000, 0xbf80a50d, 0x3f808000, 0xbf80a50d, 0x3f808000, 0xbf6d3ec4, 0x3f35bf35, 0xbec43f6d
.long 0x3f808000, 0xbf353f35, 0x248dbf80, 0x3f353f35, 0x3f808000, 0xbec43f6d, 0xbf35bf35, 0x3f6dbec4
.long 0x3f808000, 0xa5543f80, 0xbf80a50d, 0x248dbf80, 0x3f808000, 0x3ec43f6d, 0xbf353f35, 0xbf6dbec4
.long 0x3f808000, 0x3f353f35, 0xa5543f80, 0xbf353f35, 0x3f808000, 0x3f6d3ec4, 0x3f353f35, 0x3ec43f6d
.long 0x3f808000, 0x3f808000, 0x3f808000, 0x3f808000, 0x248dbf80, 0xbec4bf6d, 0xbf35bf35, 0xbf6dbec4
.long 0xbf80a50d, 0xbf353f35, 0xa5543f80, 0x3f353f35, 0xa5543f80, 0x3f6d3ec4, 0x3f35bf35, 0xbec4bf6d
.long 0x3f808000, 0x248dbf80, 0xbf80a50d, 0xa5543f80, 0x248dbf80, 0xbf6d3ec4, 0x3f353f35, 0x3ec4bf6d
.long 0xbf80a50d, 0x3f353f35, 0x248dbf80, 0xbf353f35, 0xa5543f80, 0x3ec4bf6d, 0xbf353f35, 0x3f6dbec4
.long 0x3f808000, 0xbf80a50d, 0x3f808000, 0xbf80a50d, 0x248dbf80, 0x3ec43f6d, 0xbf35bf35, 0x3f6d3ec4
.long 0xbf80a50d, 0x3f35bf35, 0xa5543f80, 0xbf35bf35, 0xa5543f80, 0xbf6dbec4, 0x3f35bf35, 0x3ec43f6d
.long 0x3f808000, 0xa5543f80, 0xbf80a50d, 0x248dbf80, 0x248dbf80, 0x3f6dbec4, 0x3f353f35, 0xbec43f6d
.long 0xbf80a50d, 0xbf35bf35, 0x248dbf80, 0x3f35bf35, 0xa5543f80, 0xbec43f6d, 0xbf353f35, 0xbf6d3ec4
.long 0x3f808000, 0x3f808000, 0x3f808000, 0x3f808000, 0xbf80a50d, 0xbf6d3ec4, 0xbf353f35, 0xbec43f6d
.long 0x3f808000, 0x3f35bf35, 0x248dbf80, 0xbf35bf35, 0xbf80a50d, 0xbec43f6d, 0x3f353f35, 0x3f6dbec4
.long 0x3f808000, 0x248dbf80, 0xbf80a50d, 0xa5543f80, 0xbf80a50d, 0x3ec43f6d, 0x3f35bf35, 0xbf6dbec4
.long 0x3f808000, 0xbf35bf35, 0xa5543f80, 0x3f35bf35, 0xbf80a50d, 0x3f6d3ec4, 0xbf35bf35, 0x3ec43f6d
.long 0x3f808000, 0xbf80a50d, 0x3f808000, 0xbf80a50d, 0xbf80a50d, 0x3f6dbec4, 0xbf353f35, 0x3ec4bf6d
.long 0x3f808000, 0xbf353f35, 0x248dbf80, 0x3f353f35, 0xbf80a50d, 0x3ec4bf6d, 0x3f353f35, 0xbf6d3ec4
.long 0x3f808000, 0xa5543f80, 0xbf80a50d, 0x248dbf80, 0xbf80a50d, 0xbec4bf6d, 0x3f35bf35, 0x3f6d3ec4
.long 0x3f808000, 0x3f353f35, 0xa5543f80, 0xbf353f35, 0xbf80a50d, 0xbf6dbec4, 0xbf35bf35, 0xbec4bf6d
.long 0x3f808000, 0x3f808000, 0x3f808000, 0x3f808000, 0xa5543f80, 0x3ec43f6d, 0x3f353f35, 0x3f6d3ec4
.long 0xbf80a50d, 0xbf353f35, 0xa5543f80, 0x3f353f35, 0x248dbf80, 0xbf6dbec4, 0xbf353f35, 0x3ec43f6d
.long 0x3f808000, 0x248dbf80, 0xbf80a50d, 0xa5543f80, 0xa5543f80, 0x3f6dbec4, 0xbf35bf35, 0xbec43f6d
.long 0xbf80a50d, 0x3f353f35, 0x248dbf80, 0xbf353f35, 0x248dbf80, 0xbec43f6d, 0x3f35bf35, 0xbf6d3ec4
.long 0x3f808000, 0xbf80a50d, 0x3f808000, 0xbf80a50d, 0xa5543f80, 0xbec4bf6d, 0x3f353f35, 0xbf6dbec4
.long 0xbf80a50d, 0x3f35bf35, 0xa5543f80, 0xbf35bf35, 0x248dbf80, 0x3f6d3ec4, 0xbf353f35, 0xbec4bf6d
.long 0x3f808000, 0xa5543f80, 0xbf80a50d, 0x248dbf80, 0xa5543f80, 0xbf6d3ec4, 0xbf35bf35, 0x3ec4bf6d
.long 0xbf80a50d, 0xbf35bf35, 0x248dbf80, 0x3f35bf35, 0x248dbf80, 0x3ec4bf6d, 0x3f35bf35, 0x3f6dbec4
.long 0x3f800000, 0x3f800000, 0x3f800000, 0x3f800000, 0x3f800000, 0x3f7ffcd7, 0x3f7ff35e, 0x3f7fe394
.long 0x3f800000, 0x3f7ff35e, 0x3f7fcd79, 0x3f7f8e56, 0x3f800000, 0x3f7fe394, 0x3f7f8e56, 0x3f7f0059
.long 0x3f800000, 0x3f7fcd79, 0x3f7f35f9, 0x3f7e39bc, 0x3f800000, 0x3f7fb10f, 0x3f7ec46d, 0x3f7d3aac
.long 0x3f800000, 0x3f7f8e56, 0x3f7e39bc, 0x3f7c0361, 0x3f800000, 0x3f7f654e, 0x3f7d95f4, 0x3f7a9421
.long 0x3f800000, 0x3f7f35f9, 0x3f7cd925, 0x3f78ed3c, 0x3f800000, 0x3f7f0059, 0x3f7c0361, 0x3f770f11
.long 0x3f800000, 0x3f7ec46d, 0x3f7b14be, 0x3f74fa0b, 0x3f800000, 0x3f7e8238, 0x3f7a0d54, 0x3f72ae9e
.long 0x3f800000, 0x3f7e39bc, 0x3f78ed3c, 0x3f702d4f, 0x3f800000, 0x3f7deafa, 0x3f77b493, 0x3f6d76aa
.long 0x3f800000, 0x3f7d95f4, 0x3f766377, 0x3f6a8b4b, 0x3f800000, 0x3f7d3aac, 0x3f74fa0b, 0x3f676bd8
.long 0x3f800000, 0x3f800000, 0x3f800000, 0x3f800000, 0x3f7fcd79, 0x3f7fb10f, 0x3f7f8e56, 0x3f7f654e
.long 0x3f7f35f9, 0x3f7ec46d, 0x3f7e39bc, 0x3f7d95f4, 0x3f7e39bc, 0x3f7d3aac, 0x3f7c0361, 0x3f7a9421
.long 0x3f7cd925, 0x3f7b14be, 0x3f78ed3c, 0x3f766377, 0x3f7b14be, 0x3f7853f8, 0x3f74fa0b, 0x3f710908
.long 0x3f78ed3c, 0x3f74fa0b, 0x3f702d4f, 0x3f6a8b4b, 0x3f766377, 0x3f710908, 0x3f6a8b4b, 0x3f62f219
.long 0x3f737871, 0x3f6c835e, 0x3f641901, 0x3f5a46a0, 0x3f702d4f, 0x3f676bd8, 0x3f5cdc29, 0x3f50935b
.long 0x3f6c835e, 0x3f61c598, 0x3f54db31, 0x3f45e403, 0x3f687c12, 0x3f5b941a, 0x3f4c1d35, 0x3f3a4582
.long 0x3f641901, 0x3f54db31, 0x3f42a9f7, 0x3f2dc5e3, 0x3f5f5be6, 0x3f4d9f02, 0x3f3889dc, 0x3f207440
.long 0x3f5a46a0, 0x3f45e403, 0x3f2dc5e3, 0x3f1260b2, 0x3f54db31, 0x3f3daef9, 0x3f226799, 0x3f039c3d
.long 0x3f800000, 0x3f800000, 0x3f800000, 0x3f800000, 0x3f7f35f9, 0x3f7f0059, 0x3f7ec46d, 0x3f7e8238
.long 0x3f7cd925, 0x3f7c0361, 0x3f7b14be, 0x3f7a0d54, 0x3f78ed3c, 0x3f770f11, 0x3f74fa0b, 0x3f72ae9e
.long 0x3f737871, 0x3f702d4f, 0x3f6c835e, 0x3f687c12, 0x3f6c835e, 0x3f676bd8, 0x3f61c598, 0x3f5b941a
.long 0x3f641901, 0x3f5cdc29, 0x3f54db31, 0x3f4c1d35, 0x3f5a46a0, 0x3f50935b, 0x3f45e403, 0x3f3a4582
.long 0x3f4f1bbd, 0x3f42a9f7, 0x3f3504f3, 0x3f26423a, 0x3f42a9f7, 0x3f333bc6, 0x3f226799, 0x3f104f0e
.long 0x3f3504f3, 0x3f226799, 0x3f0e39da, 0x3ef15aea, 0x3f26423a, 0x3f104f0e, 0x3ef15aea, 0x3ebf47d7
.long 0x3f167918, 0x3efa2c90, 0x3ec3ef15, 0x3e8afa3e, 0x3f05c277, 0x3ed1c759, 0x3e94a031, 0x3e2a1c3f
.long 0x3ee87171, 0x3ea7bf25, 0x3e47c5c2, 0x3d712283, 0x3ec3ef15, 0x3e78cfcc, 0x3dc8bd36, 0xbd48fb30
.long 0x3f800000, 0x3f800000, 0x3f800000, 0x3f800000, 0x3f7e39bc, 0x3f7deafa, 0x3f7d95f4, 0x3f7d3aac
.long 0x3f78ed3c, 0x3f77b493, 0x3f766377, 0x3f74fa0b, 0x3f702d4f, 0x3f6d76aa, 0x3f6a8b4b, 0x3f676bd8
.long 0x3f641901, 0x3f5f5be6, 0x3f5a46a0, 0x3f54db31, 0x3f54db31, 0x3f4d9f02, 0x3f45e403, 0x3f3daef9
.long 0x3f42a9f7, 0x3f3889dc, 0x3f2dc5e3, 0x3f226799, 0x3f2dc5e3, 0x3f207440, 0x3f1260b2, 0x3f039c3d
.long 0x3f167918, 0x3f05c277, 0x3ee87171, 0x3ec3ef15, 0x3efa2c90, 0x3ed1c759, 0x3ea7bf25, 0x3e78cfcc
.long 0x3ec3ef15, 0x3e94a031, 0x3e47c5c2, 0x3dc8bd36, 0x3e8afa3e, 0x3e2a1c3f, 0x3d712283, 0xbd48fb30
.long 0x3e20305b, 0x3d20cee7, 0xbda0af2a, 0xbe47c5c2, 0x3d20cee7, 0xbdb4b86a, 0xbe5b73dc, 0xbeac7cd4
.long 0xbda0af2a, 0xbe5b73dc, 0xbeb13641, 0xbef15aea, 0xbe47c5c2, 0xbeac7cd4, 0xbef15aea, 0xbf187fc0
.long 0x00000000, 0x00000000, 0x00000000, 0x00000000, 0x00000000, 0x3c20d8d2, 0x3ca0d6d6, 0x3cf13d4c
.long 0x00000000, 0x3ca0d6d6, 0x3d20cee7, 0x3d712283, 0x00000000, 0x3cf13d4c, 0x3d712283, 0x3db4b86a
.long 0x00000000, 0x3d20cee7, 0x3da0af2a, 0x3df0b772, 0x00000000, 0x3d48fb30, 0x3dc8bd36, 0x3e164083
.long 0x00000000, 0x3d712283, 0x3df0b772, 0x3e3403f1, 0x00000000, 0x3d8ca1f2, 0x3e0c4cf7, 0x3e519f65
.long 0x00000000, 0x3da0af2a, 0x3e20305b, 0x3e6f0c4d, 0x00000000, 0x3db4b86a, 0x3e3403f1, 0x3e862210
.long 0x00000000, 0x3dc8bd36, 0x3e47c5c2, 0x3e94a031, 0x00000000, 0x3ddcbd0d, 0x3e5b73dc, 0x3ea2fd52
.long 0x00000000, 0x3df0b772, 0x3e6f0c4d, 0x3eb13641, 0x00000000, 0x3e0255f4, 0x3e814693, 0x3ebf47d7
.long 0x00000000, 0x3e0c4cf7, 0x3e8afa3e, 0x3ecd2ef3, 0x00000000, 0x3e164083, 0x3e94a031, 0x3edae880
.long 0x00000000, 0x00000000, 0x00000000, 0x00000000, 0x3d20cee7, 0x3d48fb30, 0x3d712283, 0x3d8ca1f2
.long 0x3da0af2a, 0x3dc8bd36, 0x3df0b772, 0x3e0c4cf7, 0x3df0b772, 0x3e164083, 0x3e3403f1, 0x3e519f65
.long 0x3e20305b, 0x3e47c5c2, 0x3e6f0c4d, 0x3e8afa3e, 0x3e47c5c2, 0x3e78cfcc, 0x3e94a031, 0x3eac7cd4
.long 0x3e6f0c4d, 0x3e94a031, 0x3eb13641, 0x3ecd2ef3, 0x3e8afa3e, 0x3eac7cd4, 0x3ecd2ef3, 0x3eece91a
.long 0x3e9e377a, 0x3ec3ef15, 0x3ee87171, 0x3f05c277, 0x3eb13641, 0x3edae880, 0x3f0172c3, 0x3f146eba
.long 0x3ec3ef15, 0x3ef15aea, 0x3f0e39da, 0x3f226799, 0x3ed65a92, 0x3f039c3d, 0x3f1a82a4, 0x3f2f9c32
.long 0x3ee87171, 0x3f0e39da, 0x3f26423a, 0x3f3bfc8f, 0x3efa2c90, 0x3f187fc0, 0x3f316e2c, 0x3f4779bc
.long 0x3f05c277, 0x3f226799, 0x3f3bfc8f, 0x3f5205d4, 0x3f0e39da, 0x3f2beb4a, 0x3f45e403, 0x3f5b941a
.long 0x00000000, 0x00000000, 0x00000000, 0x00000000, 0x3da0af2a, 0x3db4b86a, 0x3dc8bd36, 0x3ddcbd0d
.long 0x3e20305b, 0x3e3403f1, 0x3e47c5c2, 0x3e5b73dc, 0x3e6f0c4d, 0x3e862210, 0x3e94a031, 0x3ea2fd52
.long 0x3e9e377a, 0x3eb13641, 0x3ec3ef15, 0x3ed65a92, 0x3ec3ef15, 0x3edae880, 0x3ef15aea, 0x3f039c3d
.long 0x3ee87171, 0x3f0172c3, 0x3f0e39da, 0x3f1a82a4, 0x3f05c277, 0x3f146eba, 0x3f226799, 0x3f2f9c32
.long 0x3f167918, 0x3f26423a, 0x3f3504f3, 0x3f42a9f7, 0x3f26423a, 0x3f36c9a9, 0x3f45e403, 0x3f53731f
.long 0x3f3504f3, 0x3f45e403, 0x3f54db31, 0x3f61c598, 0x3f42a9f7, 0x3f53731f, 0x3f61c598, 0x3f6d76aa
.long 0x3f4f1bbd, 0x3f5f5be6, 0x3f6c835e, 0x3f766377, 0x3f5a46a0, 0x3f698690, 0x3f74fa0b, 0x3f7c7160
.long 0x3f641901, 0x3f71decf, 0x3f7b14be, 0x3f7f8e56, 0x3f6c835e, 0x3f7853f8, 0x3f7ec46d, 0x3f7fb10f
.long 0x00000000, 0x00000000, 0x00000000, 0x00000000, 0x3df0b772, 0x3e0255f4, 0x3e0c4cf7, 0x3e164083
.long 0x3e6f0c4d, 0x3e814693, 0x3e8afa3e, 0x3e94a031, 0x3eb13641, 0x3ebf47d7, 0x3ecd2ef3, 0x3edae880
.long 0x3ee87171, 0x3efa2c90, 0x3f05c277, 0x3f0e39da, 0x3f0e39da, 0x3f187fc0, 0x3f226799, 0x3f2beb4a
.long 0x3f26423a, 0x3f316e2c, 0x3f3bfc8f, 0x3f45e403, 0x3f3bfc8f, 0x3f4779bc, 0x3f5205d4, 0x3f5b941a
.long 0x3f4f1bbd, 0x3f5a46a0, 0x3f641901, 0x3f6c835e, 0x3f5f5be6, 0x3f698690, 0x3f71decf, 0x3f7853f8
.long 0x3f6c835e, 0x3f74fa0b, 0x3f7b14be, 0x3f7ec46d, 0x3f766377, 0x3f7c7160, 0x3f7f8e56, 0x3f7fb10f
.long 0x3f7cd925, 0x3f7fcd79, 0x3f7f35f9, 0x3f7b14be, 0x3f7fcd79, 0x3f7f0059, 0x3f7a0d54, 0x3f710908
.long 0x3f7f35f9, 0x3f7a0d54, 0x3f702d4f, 0x3f61c598, 0x3f7b14be, 0x3f710908, 0x3f61c598, 0x3f4d9f02
.long 0x3f800000, 0x3f800000, 0x3f800000, 0x3f800000, 0x3f7cd925, 0x3f7c7160, 0x3f7c0361, 0x3f7b8f2a
.long 0x3f737871, 0x3f71decf, 0x3f702d4f, 0x3f6e641a, 0x3f641901, 0x3f609384, 0x3f5cdc29, 0x3f58f3c4
.long 0x3f4f1bbd, 0x3f490a88, 0x3f42a9f7, 0x3f3bfc8f, 0x3f3504f3, 0x3f2beb4a, 0x3f226799, 0x3f187fc0
.long 0x3f167918, 0x3f0a04f8, 0x3efa2c90, 0x3edf7108, 0x3ee87171, 0x3ec8917e, 0x3ea7bf25, 0x3e862210
.long 0x3e9e377a, 0x3e6f0c4d, 0x3e20305b, 0x3da0af2a, 0x3e20305b, 0x3d8ca1f2, 0xbca0d6d6, 0xbddcbd0d
.long 0x248d3132, 0xbdc8bd36, 0xbe47c5c2, 0xbe94a031, 0xbe20305b, 0xbe862210, 0xbeba9be1, 0xbeece91a
.long 0xbe9e377a, 0xbed65a92, 0xbf05c277, 0xbf1e7cf1, 0xbee87171, 0xbf104f0e, 0xbf2a0c73, 0xbf4105b8
.long 0xbf167918, 0xbf316e2c, 0xbf490a88, 0xbf5cdc29, 0xbf3504f3, 0xbf4d9f02, 0xbf61c598, 0xbf710908
.long 0x3f800000, 0x3f800000, 0x3f800000, 0x3f800000, 0x3f7b14be, 0x3f7a9421, 0x3f7a0d54, 0x3f79805c
.long 0x3f6c835e, 0x3f6a8b4b, 0x3f687c12, 0x3f6655e7, 0x3f54db31, 0x3f50935b, 0x3f4c1d35, 0x3f4779bc
.long 0x3f3504f3, 0x3f2dc5e3, 0x3f26423a, 0x3f1e7cf1, 0x3f0e39da, 0x3f039c3d, 0x3ef15aea, 0x3edae880
.long 0x3ec3ef15, 0x3ea7bf25, 0x3e8afa3e, 0x3e5b73dc, 0x3e47c5c2, 0x3e0255f4, 0x3d712283, 0xbc20d8d2
.long 0x248d3132, 0xbda0af2a, 0xbe20305b, 0xbe6f0c4d, 0xbe47c5c2, 0xbe8fcefe, 0xbeba9be1, 0xbee3f40d
.long 0xbec3ef15, 0xbef15aea, 0xbf0e39da, 0xbf226799, 0xbf0e39da, 0xbf2456f1, 0xbf3889dc, 0xbf4a965e
.long 0xbf3504f3, 0xbf490a88, 0xbf5a46a0, 0xbf687c12, 0xbf54db31, 0xbf653a48, 0xbf71decf, 0xbf7a9421
.long 0xbf6c835e, 0xbf77b493, 0xbf7e39bc, 0xbf7ff35e, 0xbf7b14be, 0xbf7fb10f, 0xbf7ec46d, 0xbf7853f8
.long 0x3f800000, 0x3f800000, 0x3f800000, 0x3f800000, 0x3f78ed3c, 0x3f7853f8, 0x3f77b493, 0x3f770f11
.long 0x3f641901, 0x3f61c598, 0x3f5f5be6, 0x3f5cdc29, 0x3f42a9f7, 0x3f3daef9, 0x3f3889dc, 0x3f333bc6
.long 0x3f167918, 0x3f0e39da, 0x3f05c277, 0x3efa2c90, 0x3ec3ef15, 0x3eac7cd4, 0x3e94a031, 0x3e78cfcc
.long 0x3e20305b, 0x3dc8bd36, 0x3d20cee7, 0xbca0d6d6, 0xbda0af2a, 0xbe164083, 0xbe5b73dc, 0xbe8fcefe
.long 0xbe9e377a, 0xbec3ef15, 0xbee87171, 0xbf05c277, 0xbf05c277, 0xbf187fc0, 0xbf2a0c73, 0xbf3a4582
.long 0xbf3504f3, 0xbf45e403, 0xbf54db31, 0xbf61c598, 0xbf5a46a0, 0xbf676bd8, 0xbf71decf, 0xbf79805c
.long 0xbf737871, 0xbf7b14be, 0xbf7f35f9, 0xbf7fcd79, 0xbf7f35f9, 0xbf7fb10f, 0xbf7c0361, 0xbf743c41
.long 0xbf7cd925, 0xbf74fa0b, 0xbf687c12, 0xbf579b8c, 0xbf6c835e, 0xbf5b941a, 0xbf45e403, 0xbf2beb4a
.long 0x3f800000, 0x3f800000, 0x3f800000, 0x3f800000, 0x3f766377, 0x3f75b1c9, 0x3f74fa0b, 0x3f743c41
.long 0x3f5a46a0, 0x3f579b8c, 0x3f54db31, 0x3f5205d4, 0x3f2dc5e3, 0x3f28296a, 0x3f226799, 0x3f1c81b9
.long 0x3ee87171, 0x3ed65a92, 0x3ec3ef15, 0x3eb13641, 0x3e47c5c2, 0x3e164083, 0x3dc8bd36, 0x3d48fb30
.long 0xbda0af2a, 0xbe0c4cf7, 0xbe47c5c2, 0xbe814693, 0xbeb13641, 0xbed1c759, 0xbef15aea, 0xbf07e565
.long 0xbf167918, 0xbf26423a, 0xbf3504f3, 0xbf42a9f7, 0xbf490a88, 0xbf563e03, 0xbf61c598, 0xbf6b8a3d
.long 0xbf6c835e, 0xbf74fa0b, 0xbf7b14be, 0xbf7ec46d, 0xbf7e39bc, 0xbf7ffcd7, 0xbf7ec46d, 0xbf7a9421
.long 0xbf7cd925, 0xbf766377, 0xbf6c835e, 0xbf5f5be6, 0xbf687c12, 0xbf58f3c4, 0xbf45e403, 0xbf2f9c32
.long 0xbf42a9f7, 0xbf2a0c73, 0xbf0e39da, 0xbedf7108, 0xbf0e39da, 0xbedae880, 0xbe94a031, 0xbe164083
.long 0x00000000, 0x00000000, 0x00000000, 0x00000000, 0x3e20305b, 0x3e2a1c3f, 0x3e3403f1, 0x3e3de731
.long 0x3e9e377a, 0x3ea7bf25, 0x3eb13641, 0x3eba9be1, 0x3ee87171, 0x3ef5c6c5, 0x3f0172c3, 0x3f07e565
.long 0x3f167918, 0x3f1e7cf1, 0x3f26423a, 0x3f2dc5e3, 0x3f3504f3, 0x3f3daef9, 0x3f45e403, 0x3f4d9f02
.long 0x3f4f1bbd, 0x3f579b8c, 0x3f5f5be6, 0x3f6655e7, 0x3f641901, 0x3f6b8a3d, 0x3f71decf, 0x3f770f11
.long 0x3f737871, 0x3f78ed3c, 0x3f7cd925, 0x3f7f35f9, 0x3f7cd925, 0x3f7f654e, 0x3f7ff35e, 0x3f7e8238
.long 0x3f800000, 0x3f7ec46d, 0x3f7b14be, 0x3f74fa0b, 0x3f7cd925, 0x3f770f11, 0x3f6e641a, 0x3f62f219
.long 0x3f737871, 0x3f687c12, 0x3f5a46a0, 0x3f490a88, 0x3f641901, 0x3f53731f, 0x3f3f5cb5, 0x3f28296a
.long 0x3f4f1bbd, 0x3f3889dc, 0x3f1e7cf1, 0x3f0172c3, 0x3f3504f3, 0x3f187fc0, 0x3ef15aea, 0x3eac7cd4
.long 0x00000000, 0x00000000, 0x00000000, 0x00000000, 0x3e47c5c2, 0x3e519f65, 0x3e5b73dc, 0x3e6542e9
.long 0x3ec3ef15, 0x3ecd2ef3, 0x3ed65a92, 0x3edf7108, 0x3f0e39da, 0x3f146eba, 0x3f1a82a4, 0x3f207440
.long 0x3f3504f3, 0x3f3bfc8f, 0x3f42a9f7, 0x3f490a88, 0x3f54db31, 0x3f5b941a, 0x3f61c598, 0x3f676bd8
.long 0x3f6c835e, 0x3f71decf, 0x3f766377, 0x3f7a0d54, 0x3f7b14be, 0x3f7deafa, 0x3f7f8e56, 0x3f7ffcd7
.long 0x3f800000, 0x3f7f35f9, 0x3f7cd925, 0x3f78ed3c, 0x3f7b14be, 0x3f75b1c9, 0x3f6e641a, 0x3f653a48
.long 0x3f6c835e, 0x3f61c598, 0x3f54db31, 0x3f45e403, 0x3f54db31, 0x3f444969, 0x3f316e2c, 0x3f1c81b9
.long 0x3f3504f3, 0x3f1e7cf1, 0x3f05c277, 0x3ed65a92, 0x3f0e39da, 0x3ee3f40d, 0x3ea7bf25, 0x3e519f65
.long 0x3ec3ef15, 0x3e814693, 0x3df0b772, 0xbca0d6d6, 0x3e47c5c2, 0x3d48fb30, 0xbdc8bd36, 0xbe78cfcc
.long 0x00000000, 0x00000000, 0x00000000, 0x00000000, 0x3e6f0c4d, 0x3e78cfcc, 0x3e814693, 0x3e862210
.long 0x3ee87171, 0x3ef15aea, 0x3efa2c90, 0x3f0172c3, 0x3f26423a, 0x3f2beb4a, 0x3f316e2c, 0x3f36c9a9
.long 0x3f4f1bbd, 0x3f54db31, 0x3f5a46a0, 0x3f5f5be6, 0x3f6c835e, 0x3f710908, 0x3f74fa0b, 0x3f7853f8
.long 0x3f7cd925, 0x3f7ec46d, 0x3f7fcd79, 0x3f7ff35e, 0x3f7f35f9, 0x3f7d3aac, 0x3f7a0d54, 0x3f75b1c9
.long 0x3f737871, 0x3f6c835e, 0x3f641901, 0x3f5a46a0, 0x3f5a46a0, 0x3f4d9f02, 0x3f3f5cb5, 0x3f2f9c32
.long 0x3f3504f3, 0x3f226799, 0x3f0e39da, 0x3ef15aea, 0x3f05c277, 0x3edae880, 0x3ea7bf25, 0x3e6542e9
.long 0x3e9e377a, 0x3e47c5c2, 0x3da0af2a, 0xbd20cee7, 0x3da0af2a, 0xbd48fb30, 0xbe3403f1, 0xbe996dba
.long 0xbe20305b, 0xbe94a031, 0xbed65a92, 0xbf0a04f8, 0xbec3ef15, 0xbf039c3d, 0xbf226799, 0xbf3daef9
.long 0x00000000, 0x00000000, 0x00000000, 0x00000000, 0x3e8afa3e, 0x3e8fcefe, 0x3e94a031, 0x3e996dba
.long 0x3f05c277, 0x3f0a04f8, 0x3f0e39da, 0x3f1260b2, 0x3f3bfc8f, 0x3f4105b8, 0x3f45e403, 0x3f4a965e
.long 0x3f641901, 0x3f687c12, 0x3f6c835e, 0x3f702d4f, 0x3f7b14be, 0x3f7d3aac, 0x3f7ec46d, 0x3f7fb10f
.long 0x3f7f35f9, 0x3f7d95f4, 0x3f7b14be, 0x3f77b493, 0x3f702d4f, 0x3f698690, 0x3f61c598, 0x3f58f3c4
.long 0x3f4f1bbd, 0x3f42a9f7, 0x3f3504f3, 0x3f26423a, 0x3f1e7cf1, 0x3f0c2124, 0x3ef15aea, 0x3ec8917e
.long 0x3ec3ef15, 0x3e94a031, 0x3e47c5c2, 0x3dc8bd36, 0x3df0b772, 0x3c20d8d2, 0xbdc8bd36, 0xbe519f65
.long 0xbe20305b, 0xbe8afa3e, 0xbec3ef15, 0xbefa2c90, 0xbed65a92, 0xbf07e565, 0xbf226799, 0xbf3a4582
.long 0xbf26423a, 0xbf3f5cb5, 0xbf54db31, 0xbf6655e7, 0xbf54db31, 0xbf676bd8, 0xbf74fa0b, 0xbf7d3aac
.long 0x3f800000, 0x3f800000, 0x3f800000, 0x3f800000, 0x3f78ed3c, 0x3f7853f8, 0x3f77b493, 0x3f770f11
.long 0x3f641901, 0x3f61c598, 0x3f5f5be6, 0x3f5cdc29, 0x3f42a9f7, 0x3f3daef9, 0x3f3889dc, 0x3f333bc6
.long 0x3f167918, 0x3f0e39da, 0x3f05c277, 0x3efa2c90, 0x3ec3ef15, 0x3eac7cd4, 0x3e94a031, 0x3e78cfcc
.long 0x3e20305b, 0x3dc8bd36, 0x3d20cee7, 0xbca0d6d6, 0xbda0af2a, 0xbe164083, 0xbe5b73dc, 0xbe8fcefe
.long 0xbe9e377a, 0xbec3ef15, 0xbee87171, 0xbf05c277, 0xbf05c277, 0xbf187fc0, 0xbf2a0c73, 0xbf3a4582
.long 0xbf3504f3, 0xbf45e403, 0xbf54db31, 0xbf61c598, 0xbf5a46a0, 0xbf676bd8, 0xbf71decf, 0xbf79805c
.long 0xbf737871, 0xbf7b14be, 0xbf7f35f9, 0xbf7fcd79, 0xbf7f35f9, 0xbf7fb10f, 0xbf7c0361, 0xbf743c41
.long 0xbf7cd925, 0xbf74fa0b, 0xbf687c12, 0xbf579b8c, 0xbf6c835e, 0xbf5b941a, 0xbf45e403, 0xbf2beb4a
.long 0x3f800000, 0x3f800000, 0x3f800000, 0x3f800000, 0x3f766377, 0x3f75b1c9, 0x3f74fa0b, 0x3f743c41
.long 0x3f5a46a0, 0x3f579b8c, 0x3f54db31, 0x3f5205d4, 0x3f2dc5e3, 0x3f28296a, 0x3f226799, 0x3f1c81b9
.long 0x3ee87171, 0x3ed65a92, 0x3ec3ef15, 0x3eb13641, 0x3e47c5c2, 0x3e164083, 0x3dc8bd36, 0x3d48fb30
.long 0xbda0af2a, 0xbe0c4cf7, 0xbe47c5c2, 0xbe814693, 0xbeb13641, 0xbed1c759, 0xbef15aea, 0xbf07e565
.long 0xbf167918, 0xbf26423a, 0xbf3504f3, 0xbf42a9f7, 0xbf490a88, 0xbf563e03, 0xbf61c598, 0xbf6b8a3d
.long 0xbf6c835e, 0xbf74fa0b, 0xbf7b14be, 0xbf7ec46d, 0xbf7e39bc, 0xbf7ffcd7, 0xbf7ec46d, 0xbf7a9421
.long 0xbf7cd925, 0xbf766377, 0xbf6c835e, 0xbf5f5be6, 0xbf687c12, 0xbf58f3c4, 0xbf45e403, 0xbf2f9c32
.long 0xbf42a9f7, 0xbf2a0c73, 0xbf0e39da, 0xbedf7108, 0xbf0e39da, 0xbedae880, 0xbe94a031, 0xbe164083
.long 0x3f800000, 0x3f800000, 0x3f800000, 0x3f800000, 0x3f737871, 0x3f72ae9e, 0x3f71decf, 0x3f710908
.long 0x3f4f1bbd, 0x3f4c1d35, 0x3f490a88, 0x3f45e403, 0x3f167918, 0x3f104f0e, 0x3f0a04f8, 0x3f039c3d
.long 0x3e9e377a, 0x3e8afa3e, 0x3e6f0c4d, 0x3e47c5c2, 0x248d3132, 0xbd48fb30, 0xbdc8bd36, 0xbe164083
.long 0xbe9e377a, 0xbeba9be1, 0xbed65a92, 0xbef15aea, 0xbf167918, 0xbf2456f1, 0xbf316e2c, 0xbf3daef9
.long 0xbf4f1bbd, 0xbf5a46a0, 0xbf641901, 0xbf6c835e, 0xbf737871, 0xbf79805c, 0xbf7d95f4, 0xbf7fb10f
.long 0xbf800000, 0xbf7ec46d, 0xbf7b14be, 0xbf74fa0b, 0xbf737871, 0xbf698690, 0xbf5cdc29, 0xbf4d9f02
.long 0xbf4f1bbd, 0xbf3bfc8f, 0xbf26423a, 0xbf0e39da, 0xbf167918, 0xbef5c6c5, 0xbeba9be1, 0xbe78cfcc
.long 0xbe9e377a, 0xbe3403f1, 0xbd20cee7, 0x3dc8bd36, 0xa553c9ca, 0x3e164083, 0x3e94a031, 0x3edae880
.long 0x3f800000, 0x3f800000, 0x3f800000, 0x3f800000, 0x3f702d4f, 0x3f6f4ba8, 0x3f6e641a, 0x3f6d76aa
.long 0x3f42a9f7, 0x3f3f5cb5, 0x3f3bfc8f, 0x3f3889dc, 0x3efa2c90, 0x3eece91a, 0x3edf7108, 0x3ed1c759
.long 0x3e20305b, 0x3df0b772, 0x3da0af2a, 0x3d20cee7, 0xbe47c5c2, 0xbe78cfcc, 0xbe94a031, 0xbeac7cd4
.long 0xbf05c277, 0xbf1260b2, 0xbf1e7cf1, 0xbf2a0c73, 0xbf490a88, 0xbf53731f, 0xbf5cdc29, 0xbf653a48
.long 0xbf737871, 0xbf78ed3c, 0xbf7cd925, 0xbf7f35f9, 0xbf7fcd79, 0xbf7deafa, 0xbf7a0d54, 0xbf743c41
.long 0xbf6c835e, 0xbf61c598, 0xbf54db31, 0xbf45e403, 0xbf3bfc8f, 0xbf28296a, 0xbf1260b2, 0xbef5c6c5
.long 0xbee87171, 0xbeb13641, 0xbe6f0c4d, 0xbdf0b772, 0xbdf0b772, 0x3c20d8d2, 0x3e0c4cf7, 0x3e862210
.long 0x3e6f0c4d, 0x3eba9be1, 0x3efa2c90, 0x3f1a82a4, 0x3f0e39da, 0x3f2beb4a, 0x3f45e403, 0x3f5b941a
.long 0x00000000, 0x00000000, 0x00000000, 0x00000000, 0x3e6f0c4d, 0x3e78cfcc, 0x3e814693, 0x3e862210
.long 0x3ee87171, 0x3ef15aea, 0x3efa2c90, 0x3f0172c3, 0x3f26423a, 0x3f2beb4a, 0x3f316e2c, 0x3f36c9a9
.long 0x3f4f1bbd, 0x3f54db31, 0x3f5a46a0, 0x3f5f5be6, 0x3f6c835e, 0x3f710908, 0x3f74fa0b, 0x3f7853f8
.long 0x3f7cd925, 0x3f7ec46d, 0x3f7fcd79, 0x3f7ff35e, 0x3f7f35f9, 0x3f7d3aac, 0x3f7a0d54, 0x3f75b1c9
.long 0x3f737871, 0x3f6c835e, 0x3f641901, 0x3f5a46a0, 0x3f5a46a0, 0x3f4d9f02, 0x3f3f5cb5, 0x3f2f9c32
.long 0x3f3504f3, 0x3f226799, 0x3f0e39da, 0x3ef15aea, 0x3f05c277, 0x3edae880, 0x3ea7bf25, 0x3e6542e9
.long 0x3e9e377a, 0x3e47c5c2, 0x3da0af2a, 0xbd20cee7, 0x3da0af2a, 0xbd48fb30, 0xbe3403f1, 0xbe996dba
.long 0xbe20305b, 0xbe94a031, 0xbed65a92, 0xbf0a04f8, 0xbec3ef15, 0xbf039c3d, 0xbf226799, 0xbf3daef9
.long 0x00000000, 0x00000000, 0x00000000, 0x00000000, 0x3e8afa3e, 0x3e8fcefe, 0x3e94a031, 0x3e996dba
.long 0x3f05c277, 0x3f0a04f8, 0x3f0e39da, 0x3f1260b2, 0x3f3bfc8f, 0x3f4105b8, 0x3f45e403, 0x3f4a965e
.long 0x3f641901, 0x3f687c12, 0x3f6c835e, 0x3f702d4f, 0x3f7b14be, 0x3f7d3aac, 0x3f7ec46d, 0x3f7fb10f
.long 0x3f7f35f9, 0x3f7d95f4, 0x3f7b14be, 0x3f77b493, 0x3f702d4f, 0x3f698690, 0x3f61c598, 0x3f58f3c4
.long 0x3f4f1bbd, 0x3f42a9f7, 0x3f3504f3, 0x3f26423a, 0x3f1e7cf1, 0x3f0c2124, 0x3ef15aea, 0x3ec8917e
.long 0x3ec3ef15, 0x3e94a031, 0x3e47c5c2, 0x3dc8bd36, 0x3df0b772, 0x3c20d8d2, 0xbdc8bd36, 0xbe519f65
.long 0xbe20305b, 0xbe8afa3e, 0xbec3ef15, 0xbefa2c90, 0xbed65a92, 0xbf07e565, 0xbf226799, 0xbf3a4582
.long 0xbf26423a, 0xbf3f5cb5, 0xbf54db31, 0xbf6655e7, 0xbf54db31, 0xbf676bd8, 0xbf74fa0b, 0xbf7d3aac
.long 0x00000000, 0x00000000, 0x00000000, 0x00000000, 0x3e9e377a, 0x3ea2fd52, 0x3ea7bf25, 0x3eac7cd4
.long 0x3f167918, 0x3f1a82a4, 0x3f1e7cf1, 0x3f226799, 0x3f4f1bbd, 0x3f53731f, 0x3f579b8c, 0x3f5b941a
.long 0x3f737871, 0x3f766377, 0x3f78ed3c, 0x3f7b14be, 0x3f800000, 0x3f7fb10f, 0x3f7ec46d, 0x3f7d3aac
.long 0x3f737871, 0x3f6e641a, 0x3f687c12, 0x3f61c598, 0x3f4f1bbd, 0x3f444969, 0x3f3889dc, 0x3f2beb4a
.long 0x3f167918, 0x3f05c277, 0x3ee87171, 0x3ec3ef15, 0x3e9e377a, 0x3e6542e9, 0x3e0c4cf7, 0x3d48fb30
.long 0x250d3132, 0xbdc8bd36, 0xbe47c5c2, 0xbe94a031, 0xbe9e377a, 0xbed1c759, 0xbf0172c3, 0xbf187fc0
.long 0xbf167918, 0xbf2dc5e3, 0xbf42a9f7, 0xbf54db31, 0xbf4f1bbd, 0xbf609384, 0xbf6e641a, 0xbf7853f8
.long 0xbf737871, 0xbf7c0361, 0xbf7fcd79, 0xbf7ec46d, 0xbf800000, 0xbf7d3aac, 0xbf74fa0b, 0xbf676bd8
.long 0x00000000, 0x00000000, 0x00000000, 0x00000000, 0x3eb13641, 0x3eb5eb4f, 0x3eba9be1, 0x3ebf47d7
.long 0x3f26423a, 0x3f2a0c73, 0x3f2dc5e3, 0x3f316e2c, 0x3f5f5be6, 0x3f62f219, 0x3f6655e7, 0x3f698690
.long 0x3f7cd925, 0x3f7e39bc, 0x3f7f35f9, 0x3f7fcd79, 0x3f7b14be, 0x3f7853f8, 0x3f74fa0b, 0x3f710908
.long 0x3f5a46a0, 0x3f5205d4, 0x3f490a88, 0x3f3f5cb5, 0x3f1e7cf1, 0x3f104f0e, 0x3f0172c3, 0x3ee3f40d
.long 0x3e9e377a, 0x3e6f0c4d, 0x3e20305b, 0x3da0af2a, 0xbd20cee7, 0xbe0255f4, 0xbe5b73dc, 0xbe996dba
.long 0xbec3ef15, 0xbef15aea, 0xbf0e39da, 0xbf226799, 0xbf2dc5e3, 0xbf4105b8, 0xbf5205d4, 0xbf609384
.long 0xbf641901, 0xbf702d4f, 0xbf78ed3c, 0xbf7e39bc, 0xbf7e39bc, 0xbf7ffcd7, 0xbf7d95f4, 0xbf770f11
.long 0xbf78ed3c, 0xbf6e641a, 0xbf5f5be6, 0xbf4c1d35, 0xbf54db31, 0xbf3daef9, 0xbf226799, 0xbf039c3d
.long 0x00003f80, 0x00003f80, 0x00003f80, 0x00003f80, 0x00003f80, 0x3e203f7d, 0x3e9e3f73, 0x3ee83f64
.long 0x00003f80, 0x3e9e3f73, 0x3f163f4f, 0x3f4f3f16, 0x00003f80, 0x3ee83f64, 0x3f4f3f16, 0x3f7d3e20
.long 0x00003f80, 0x3f733e9e, 0x3f16bf4f, 0xbf16bf4f, 0x00003f80, 0x3f7d3e20, 0x3e9ebf73, 0xbf64bee8
.long 0x00003f80, 0x3f80248d, 0x250dbf80, 0xbf80a554, 0x00003f80, 0x3f7dbe20, 0xbe9ebf73, 0xbf643ee8
.long 0x00003f80, 0x3f16bf4f, 0xbf733e9e, 0x3f733e9e, 0x00003f80, 0x3ee8bf64, 0xbf4f3f16, 0x3f7dbe20
.long 0x00003f80, 0x3e9ebf73, 0xbf163f4f, 0x3f4fbf16, 0x00003f80, 0x3e20bf7d, 0xbe9e3f73, 0x3ee8bf64
.long 0x00003f80, 0xbf16bf4f, 0x3f733e9e, 0xbf733e9e, 0x00003f80, 0xbf35bf35, 0x3f80248d, 0xbf353f35
.long 0x00003f80, 0xbf4fbf16, 0x3f73be9e, 0xbe9e3f73, 0x00003f80, 0xbf64bee8, 0x3f4fbf16, 0x3e203f7d
.long 0x00003f80, 0x00003f80, 0x00003f80, 0x00003f80, 0x3f163f4f, 0x3f353f35, 0x3f4f3f16, 0x3f643ee8
.long 0x3f733e9e, 0x3f80248d, 0x3f73be9e, 0x3f4fbf16, 0x3f73be9e, 0x3f35bf35, 0x3e9ebf73, 0xbe20bf7d
.long 0xbf733e9e, 0x00003f80, 0x3f733e9e, 0x3f16bf4f, 0xbf163f4f, 0x3f353f35, 0x3f4fbf16, 0xbee8bf64
.long 0x00003f80, 0x3f80248d, 0x250dbf80, 0xbf80a554, 0x3f163f4f, 0x3f35bf35, 0xbf4fbf16, 0xbee83f64
.long 0xbf16bf4f, 0x00003f80, 0x3f16bf4f, 0xbf733e9e, 0xbf73be9e, 0x3f353f35, 0xbe9ebf73, 0xbe203f7d
.long 0xbf733e9e, 0x3f80248d, 0xbf73be9e, 0x3f4f3f16, 0xbf163f4f, 0x3f35bf35, 0xbf4f3f16, 0x3f64bee8
.long 0x3f16bf4f, 0x00003f80, 0xbf16bf4f, 0x3f733e9e, 0x250dbf80, 0x3f353f35, 0xbf80a554, 0x3f35bf35
.long 0xbf16bf4f, 0x3f80248d, 0xbf163f4f, 0xbe9ebf73, 0xbf73be9e, 0x3f35bf35, 0x3e9e3f73, 0xbf7dbe20
.long 0x00003f80, 0x00003f80, 0x00003f80, 0x00003f80, 0x3f733e9e, 0x3f7d3e20, 0x3f80248d, 0x3f7dbe20
.long 0x3f16bf4f, 0x3e9ebf73, 0x250dbf80, 0xbe9ebf73, 0xbf16bf4f, 0xbf64bee8, 0xbf80a554, 0xbf643ee8
.long 0xbf16bf4f, 0xbf733e9e, 0x00003f80, 0x3f733e9e, 0xbf733e9e, 0x3e203f7d, 0x3f80248d, 0x3e20bf7d
.long 0x00003f80, 0x3f80248d, 0x250dbf80, 0xbf80a554, 0x3f733e9e, 0x3e20bf7d, 0xbf80a554, 0x3e203f7d
.long 0x3f733e9e, 0xbf16bf4f, 0x00003f80, 0x3f16bf4f, 0x3f16bf4f, 0xbf643ee8, 0x3f80248d, 0xbf64bee8
.long 0xbf16bf4f, 0x3e9e3f73, 0x250dbf80, 0xbe9e3f73, 0xbf733e9e, 0x3f7dbe20, 0xbf80a554, 0x3f7d3e20
.long 0xbf733e9e, 0x3f16bf4f, 0x00003f80, 0xbf16bf4f, 0x00003f80, 0xbf35bf35, 0x3f80248d, 0xbf353f35
.long 0x3f733e9e, 0xbf4f3f16, 0x250dbf80, 0x3f4f3f16, 0x3f16bf4f, 0x3ee83f64, 0xbf80a554, 0x3ee8bf64
.long 0x00003f80, 0x00003f80, 0x00003f80, 0x00003f80, 0x3f73be9e, 0x3f64bee8, 0x3f4fbf16, 0x3f35bf35
.long 0xbf16bf4f, 0xbf4fbf16, 0xbf73be9e, 0xbf80a554, 0xbf163f4f, 0xbe203f7d, 0x3e9e3f73, 0x3f353f35
.long 0x3f16bf4f, 0xbf16bf4f, 0xbf733e9e, 0x00003f80, 0xbf73be9e, 0xbee83f64, 0x3f4f3f16, 0x3f35bf35
.long 0x00003f80, 0x3f80248d, 0x250dbf80, 0xbf80a554, 0x3f73be9e, 0xbee8bf64, 0xbf4f3f16, 0x3f353f35
.long 0xbf733e9e, 0x3f733e9e, 0xbf16bf4f, 0x00003f80, 0x3f163f4f, 0xbe20bf7d, 0xbe9e3f73, 0x3f35bf35
.long 0x3f16bf4f, 0xbf4f3f16, 0x3f73be9e, 0xbf80a554, 0xbf73be9e, 0x3f643ee8, 0xbf4fbf16, 0x3f353f35
.long 0x3f733e9e, 0xbf733e9e, 0x3f16bf4f, 0x00003f80, 0x250dbf80, 0x3f353f35, 0xbf80a554, 0x3f35bf35
.long 0xbf733e9e, 0x3e9ebf73, 0x3f163f4f, 0xbf80a554, 0x3f163f4f, 0xbf7d3e20, 0x3e9ebf73, 0x3f353f35
.long 0x00003f80, 0x00003f80, 0x00003f80, 0x00003f80, 0x3f16bf4f, 0x3ee8bf64, 0x3e9ebf73, 0x3e20bf7d
.long 0xbf733e9e, 0xbf4f3f16, 0xbf163f4f, 0xbe9e3f73, 0x3f733e9e, 0x3f7dbe20, 0x3f4fbf16, 0x3ee8bf64
.long 0x3f733e9e, 0x3f16bf4f, 0xbf16bf4f, 0xbf733e9e, 0xbf16bf4f, 0xbf643ee8, 0x3e9e3f73, 0x3f7dbe20
.long 0x00003f80, 0x3f80248d, 0x250dbf80, 0xbf80a554, 0x3f16bf4f, 0xbf64bee8, 0xbe9e3f73, 0x3f7d3e20
.long 0x3f16bf4f, 0xbf733e9e, 0x3f733e9e, 0xbf16bf4f, 0xbf733e9e, 0x3f7d3e20, 0xbf4fbf16, 0x3ee83f64
.long 0x3f733e9e, 0xbf4fbf16, 0x3f163f4f, 0xbe9ebf73, 0xbf16bf4f, 0x3ee83f64, 0xbe9ebf73, 0x3e203f7d
.long 0xbf16bf4f, 0x3f733e9e, 0xbf733e9e, 0x3f16bf4f, 0x00003f80, 0xbf35bf35, 0x3f80248d, 0xbf353f35
.long 0x3f16bf4f, 0x3e9e3f73, 0xbf73be9e, 0x3f4fbf16, 0xbf733e9e, 0x3e20bf7d, 0x3f4f3f16, 0xbf643ee8
.long 0x00003f80, 0x00003f80, 0x00003f80, 0x00003f80, 0x250dbf80, 0xbe20bf7d, 0xbe9ebf73, 0xbee8bf64
.long 0x00003f80, 0x3e9e3f73, 0x3f163f4f, 0x3f4f3f16, 0x250dbf80, 0xbee8bf64, 0xbf4fbf16, 0xbf7dbe20
.long 0x00003f80, 0x3f733e9e, 0x3f16bf4f, 0xbf16bf4f, 0x250dbf80, 0xbf7dbe20, 0xbe9e3f73, 0x3f643ee8
.long 0x00003f80, 0x3f80248d, 0x250dbf80, 0xbf80a554, 0x250dbf80, 0xbf7d3e20, 0x3e9e3f73, 0x3f64bee8
.long 0x00003f80, 0x3f16bf4f, 0xbf733e9e, 0x3f733e9e, 0x250dbf80, 0xbee83f64, 0x3f4fbf16, 0xbf7d3e20
.long 0x00003f80, 0x3e9ebf73, 0xbf163f4f, 0x3f4fbf16, 0x250dbf80, 0xbe203f7d, 0x3e9ebf73, 0xbee83f64
.long 0x00003f80, 0xbf16bf4f, 0x3f733e9e, 0xbf733e9e, 0x250dbf80, 0x3f353f35, 0xbf80a554, 0x3f35bf35
.long 0x00003f80, 0xbf4fbf16, 0x3f73be9e, 0xbe9e3f73, 0x250dbf80, 0x3f643ee8, 0xbf4f3f16, 0xbe20bf7d
.long 0x00003f80, 0x00003f80, 0x00003f80, 0x00003f80, 0xbf16bf4f, 0xbf35bf35, 0xbf4fbf16, 0xbf64bee8
.long 0x3f733e9e, 0x3f80248d, 0x3f73be9e, 0x3f4fbf16, 0xbf733e9e, 0xbf353f35, 0xbe9e3f73, 0x3e203f7d
.long 0xbf733e9e, 0x00003f80, 0x3f733e9e, 0x3f16bf4f, 0x3f16bf4f, 0xbf35bf35, 0xbf4f3f16, 0x3ee83f64
.long 0x00003f80, 0x3f80248d, 0x250dbf80, 0xbf80a554, 0xbf16bf4f, 0xbf353f35, 0x3f4f3f16, 0x3ee8bf64
.long 0xbf16bf4f, 0x00003f80, 0x3f16bf4f, 0xbf733e9e, 0x3f733e9e, 0xbf35bf35, 0x3e9e3f73, 0x3e20bf7d
.long 0xbf733e9e, 0x3f80248d, 0xbf73be9e, 0x3f4f3f16, 0x3f16bf4f, 0xbf353f35, 0x3f4fbf16, 0xbf643ee8
.long 0x3f16bf4f, 0x00003f80, 0xbf16bf4f, 0x3f733e9e, 0x00003f80, 0xbf35bf35, 0x3f80248d, 0xbf353f35
.long 0xbf16bf4f, 0x3f80248d, 0xbf163f4f, 0xbe9ebf73, 0x3f733e9e, 0xbf353f35, 0xbe9ebf73, 0x3f7d3e20
.long 0x00003f80, 0x00003f80, 0x00003f80, 0x00003f80, 0xbf73be9e, 0xbf7dbe20, 0xbf80a554, 0xbf7d3e20
.long 0x3f16bf4f, 0x3e9ebf73, 0x250dbf80, 0xbe9ebf73, 0x3f163f4f, 0x3f643ee8, 0x3f80248d, 0x3f64bee8
.long 0xbf16bf4f, 0xbf733e9e, 0x00003f80, 0x3f733e9e, 0x3f73be9e, 0xbe20bf7d, 0xbf80a554, 0xbe203f7d
.long 0x00003f80, 0x3f80248d, 0x250dbf80, 0xbf80a554, 0xbf73be9e, 0xbe203f7d, 0x3f80248d, 0xbe20bf7d
.long 0x3f733e9e, 0xbf16bf4f, 0x00003f80, 0x3f16bf4f, 0xbf163f4f, 0x3f64bee8, 0xbf80a554, 0x3f643ee8
.long 0xbf16bf4f, 0x3e9e3f73, 0x250dbf80, 0xbe9e3f73, 0x3f73be9e, 0xbf7d3e20, 0x3f80248d, 0xbf7dbe20
.long 0xbf733e9e, 0x3f16bf4f, 0x00003f80, 0xbf16bf4f, 0x250dbf80, 0x3f353f35, 0xbf80a554, 0x3f35bf35
.long 0x3f733e9e, 0xbf4f3f16, 0x250dbf80, 0x3f4f3f16, 0xbf163f4f, 0xbee8bf64, 0x3f80248d, 0xbee83f64
.long 0x00000000, 0x00000000, 0x00000000, 0x00000000, 0x00000000, 0x00000000, 0x00000000, 0x00000000
.long 0x00000000, 0x00000000, 0x00000000, 0x00000000, 0x00000000, 0x00000000, 0x00000000, 0x00000000
.long 0x00000000, 0x00000000, 0x00000000, 0x00000000, 0x00000000, 0x00000000, 0x00000000, 0x00000000
.long 0x00000000, 0x00000000, 0x00000000, 0x00000000, 0x00000000, 0x00000000, 0x00000000, 0x00000000
.long 0x00000000, 0x00000000, 0x00000000, 0x00000000, 0x00000000, 0x00000000, 0x00000000, 0x00000000
.long 0x00000000, 0x00000000, 0x00000000, 0x00000000, 0x00000000, 0x00000000, 0x00000000, 0x00000000
.long 0x00000000, 0x00000000, 0x00000000, 0x00000000, 0x00000000, 0x00000000, 0x00000000, 0x00000000
.long 0x00000000, 0x00000000, 0x00000000, 0x00000000, 0x00000000, 0x00000000, 0x00000000, 0x00000000
.long 0x00000000, 0x00000000, 0x00000000, 0x00000000, 0x00000000, 0x00000000, 0x00000000, 0x00000000
.long 0x00000000, 0x00000000, 0x00000000, 0x00000000, 0x00000000, 0x00000000, 0x00000000, 0x00000000
.long 0x00000000, 0x00000000, 0x00000000, 0x00000000, 0x00000000, 0x00000000, 0x00000000, 0x00000000
.long 0x00000000, 0x00000000, 0x00000000, 0x00000000, 0x00000000, 0x00000000, 0x00000000, 0x00000000
.long 0x00000000, 0x00000000, 0x00000000, 0x00000000, 0x00000000, 0x00000000, 0x00000000, 0x00000000
.long 0x00000000, 0x00000000, 0x00000000, 0x00000000, 0x00000000, 0x00000000, 0x00000000, 0x00000000
.long 0x00000000, 0x00000000, 0x00000000, 0x00000000, 0x00000000, 0x00000000, 0x00000000, 0x00000000
.long 0x00000000, 0x00000000, 0x00000000, 0x00000000, 0x00000000, 0x00000000, 0x00000000, 0x00000000
.long 0x00003f80, 0x00003f80, 0x00003f80, 0x00003f80, 0xbf733e9e, 0xbf643ee8, 0xbf4f3f16, 0xbf353f35
.long 0xbf16bf4f, 0xbf4fbf16, 0xbf73be9e, 0xbf80a554, 0x3f16bf4f, 0x3e20bf7d, 0xbe9ebf73, 0xbf35bf35
.long 0x3f16bf4f, 0xbf16bf4f, 0xbf733e9e, 0x00003f80, 0x3f733e9e, 0x3ee8bf64, 0xbf4fbf16, 0xbf353f35
.long 0x00003f80, 0x3f80248d, 0x250dbf80, 0xbf80a554, 0xbf733e9e, 0x3ee83f64, 0x3f4fbf16, 0xbf35bf35
.long 0xbf733e9e, 0x3f733e9e, 0xbf16bf4f, 0x00003f80, 0xbf16bf4f, 0x3e203f7d, 0x3e9ebf73, 0xbf353f35
.long 0x3f16bf4f, 0xbf4f3f16, 0x3f73be9e, 0xbf80a554, 0x3f733e9e, 0xbf64bee8, 0x3f4f3f16, 0xbf35bf35
.long 0x3f733e9e, 0xbf733e9e, 0x3f16bf4f, 0x00003f80, 0x00003f80, 0xbf35bf35, 0x3f80248d, 0xbf353f35
.long 0xbf733e9e, 0x3e9ebf73, 0x3f163f4f, 0xbf80a554, 0xbf16bf4f, 0x3f7dbe20, 0xbe9e3f73, 0xbf35bf35
.long 0x00003f80, 0x00003f80, 0x00003f80, 0x00003f80, 0xbf163f4f, 0xbee83f64, 0xbe9e3f73, 0xbe203f7d
.long 0xbf733e9e, 0xbf4f3f16, 0xbf163f4f, 0xbe9e3f73, 0xbf73be9e, 0xbf7d3e20, 0xbf4f3f16, 0xbee83f64
.long 0x3f733e9e, 0x3f16bf4f, 0xbf16bf4f, 0xbf733e9e, 0x3f163f4f, 0x3f64bee8, 0xbe9ebf73, 0xbf7d3e20
.long 0x00003f80, 0x3f80248d, 0x250dbf80, 0xbf80a554, 0xbf163f4f, 0x3f643ee8, 0x3e9ebf73, 0xbf7dbe20
.long 0x3f16bf4f, 0xbf733e9e, 0x3f733e9e, 0xbf16bf4f, 0x3f73be9e, 0xbf7dbe20, 0x3f4f3f16, 0xbee8bf64
.long 0x3f733e9e, 0xbf4fbf16, 0x3f163f4f, 0xbe9ebf73, 0x3f163f4f, 0xbee8bf64, 0x3e9e3f73, 0xbe20bf7d
.long 0xbf16bf4f, 0x3f733e9e, 0xbf733e9e, 0x3f16bf4f, 0x250dbf80, 0x3f353f35, 0xbf80a554, 0x3f35bf35
.long 0x3f16bf4f, 0x3e9e3f73, 0xbf73be9e, 0x3f4fbf16, 0x3f73be9e, 0xbe203f7d, 0xbf4fbf16, 0x3f64bee8
.long 0x00003f80, 0x3f163f4f, 0x3f733e9e, 0x3f73be9e, 0x00003f80, 0x3f353f35, 0x3f80248d, 0x3f35bf35
.long 0x00003f80, 0x3f4f3f16, 0x3f73be9e, 0x3e9ebf73, 0x00003f80, 0x3f643ee8, 0x3f4fbf16, 0xbe20bf7d
.long 0x00003f80, 0x3f73be9e, 0xbf16bf4f, 0xbf163f4f, 0x00003f80, 0x3f64bee8, 0xbf4fbf16, 0xbe203f7d
.long 0x00003f80, 0x3f4fbf16, 0xbf73be9e, 0x3e9e3f73, 0x00003f80, 0x3f35bf35, 0xbf80a554, 0x3f353f35
.long 0x00003f80, 0x250dbf80, 0x00003f80, 0x250dbf80, 0x00003f80, 0xbe20bf7d, 0x3e9e3f73, 0xbee8bf64
.long 0x00003f80, 0xbe9ebf73, 0x3f163f4f, 0xbf4fbf16, 0x00003f80, 0xbee8bf64, 0x3f4f3f16, 0xbf7dbe20
.long 0x00003f80, 0xbf73be9e, 0x3f16bf4f, 0x3f163f4f, 0x00003f80, 0xbf7dbe20, 0x3e9ebf73, 0x3f643ee8
.long 0x00003f80, 0xbf80a554, 0x250dbf80, 0x3f80248d, 0x00003f80, 0xbf7d3e20, 0xbe9ebf73, 0x3f64bee8
.long 0x3f16bf4f, 0x250dbf80, 0xbf16bf4f, 0xbf73be9e, 0x250dbf80, 0xbf35bf35, 0xbf80a554, 0xbf353f35
.long 0xbf16bf4f, 0xbf80a554, 0xbf163f4f, 0x3e9e3f73, 0xbf73be9e, 0xbf353f35, 0x3e9e3f73, 0x3f7d3e20
.long 0x3f733e9e, 0x250dbf80, 0xbf733e9e, 0x3f163f4f, 0x3f73be9e, 0xbf35bf35, 0xbe9e3f73, 0x3f7dbe20
.long 0x3f16bf4f, 0xbf80a554, 0x3f163f4f, 0x3e9ebf73, 0x250dbf80, 0xbf353f35, 0x3f80248d, 0xbf35bf35
.long 0x00003f80, 0x250dbf80, 0x00003f80, 0x250dbf80, 0x3f163f4f, 0xbf35bf35, 0x3f4f3f16, 0xbf64bee8
.long 0x3f733e9e, 0xbf80a554, 0x3f73be9e, 0xbf4f3f16, 0x3f73be9e, 0xbf353f35, 0x3e9ebf73, 0x3e203f7d
.long 0xbf733e9e, 0x250dbf80, 0x3f733e9e, 0xbf163f4f, 0xbf163f4f, 0xbf35bf35, 0x3f4fbf16, 0x3ee83f64
.long 0x00003f80, 0xbf80a554, 0x250dbf80, 0x3f80248d, 0x3f163f4f, 0xbf353f35, 0xbf4fbf16, 0x3ee8bf64
.long 0xbf733e9e, 0xbf163f4f, 0x00003f80, 0x3f163f4f, 0x00003f80, 0x3f353f35, 0x3f80248d, 0x3f35bf35
.long 0x3f733e9e, 0x3f4fbf16, 0x250dbf80, 0xbf4fbf16, 0x3f16bf4f, 0xbee8bf64, 0xbf80a554, 0xbee83f64
.long 0x3f16bf4f, 0xbf73be9e, 0x00003f80, 0x3f73be9e, 0xbf16bf4f, 0xbee83f64, 0x3f80248d, 0xbee8bf64
.long 0xbf733e9e, 0x3f4f3f16, 0x250dbf80, 0xbf4f3f16, 0x00003f80, 0x3f35bf35, 0xbf80a554, 0x3f353f35
.long 0x00003f80, 0x250dbf80, 0x00003f80, 0x250dbf80, 0x3f733e9e, 0xbf7dbe20, 0x3f80248d, 0xbf7d3e20
.long 0x3f16bf4f, 0xbe9e3f73, 0x250dbf80, 0x3e9e3f73, 0xbf16bf4f, 0x3f643ee8, 0xbf80a554, 0x3f64bee8
.long 0xbf16bf4f, 0x3f73be9e, 0x00003f80, 0xbf73be9e, 0xbf733e9e, 0xbe20bf7d, 0x3f80248d, 0xbe203f7d
.long 0x00003f80, 0xbf80a554, 0x250dbf80, 0x3f80248d, 0x3f733e9e, 0xbe203f7d, 0xbf80a554, 0xbe20bf7d
.long 0x3f733e9e, 0x3f73be9e, 0x3f16bf4f, 0x250dbf80, 0x250dbf80, 0xbf35bf35, 0xbf80a554, 0xbf353f35
.long 0xbf733e9e, 0xbe9e3f73, 0x3f163f4f, 0x3f80248d, 0x3f163f4f, 0x3f7dbe20, 0x3e9ebf73, 0xbf35bf35
.long 0xbf16bf4f, 0xbf163f4f, 0x3f733e9e, 0x250dbf80, 0xbf163f4f, 0x3f7d3e20, 0xbe9ebf73, 0xbf353f35
.long 0x3f733e9e, 0xbe9ebf73, 0xbf163f4f, 0x3f80248d, 0x250dbf80, 0xbf353f35, 0x3f80248d, 0xbf35bf35
.long 0x00003f80, 0x250dbf80, 0x00003f80, 0x250dbf80, 0x3f73be9e, 0xbf643ee8, 0x3f4fbf16, 0xbf353f35
.long 0xbf16bf4f, 0x3f4f3f16, 0xbf73be9e, 0x3f80248d, 0xbf163f4f, 0x3e20bf7d, 0x3e9e3f73, 0xbf35bf35
.long 0x3f16bf4f, 0x3f163f4f, 0xbf733e9e, 0x250dbf80, 0xbf73be9e, 0x3ee8bf64, 0x3f4f3f16, 0xbf353f35
.long 0x00003f80, 0xbf80a554, 0x250dbf80, 0x3f80248d, 0x3f73be9e, 0x3ee83f64, 0xbf4f3f16, 0xbf35bf35
.long 0xbf16bf4f, 0xbf73be9e, 0xbf733e9e, 0xbf163f4f, 0x00003f80, 0x3f353f35, 0x3f80248d, 0x3f35bf35
.long 0x3f16bf4f, 0xbe9ebf73, 0xbf73be9e, 0xbf4f3f16, 0xbf733e9e, 0xbe203f7d, 0x3f4f3f16, 0x3f64bee8
.long 0xbf733e9e, 0x3f163f4f, 0x3f16bf4f, 0xbf73be9e, 0x3f733e9e, 0xbe20bf7d, 0xbf4f3f16, 0x3f643ee8
.long 0xbf16bf4f, 0xbe9e3f73, 0x3f73be9e, 0xbf4fbf16, 0x00003f80, 0x3f35bf35, 0xbf80a554, 0x3f353f35
.long 0x00003f80, 0x250dbf80, 0x00003f80, 0x250dbf80, 0x3f16bf4f, 0xbee83f64, 0x3e9ebf73, 0xbe203f7d
.long 0xbf733e9e, 0x3f4fbf16, 0xbf163f4f, 0x3e9ebf73, 0x3f733e9e, 0xbf7d3e20, 0x3f4fbf16, 0xbee83f64
.long 0x3f733e9e, 0xbf163f4f, 0xbf16bf4f, 0x3f73be9e, 0xbf16bf4f, 0x3f64bee8, 0x3e9e3f73, 0xbf7d3e20
.long 0x00003f80, 0xbf80a554, 0x250dbf80, 0x3f80248d, 0x3f16bf4f, 0x3f643ee8, 0xbe9e3f73, 0xbf7dbe20
.long 0x00003f80, 0x3f163f4f, 0x3f733e9e, 0x3f73be9e, 0x250dbf80, 0xbf35bf35, 0xbf80a554, 0xbf353f35
.long 0x00003f80, 0x3f4f3f16, 0x3f73be9e, 0x3e9ebf73, 0x250dbf80, 0xbf64bee8, 0xbf4f3f16, 0x3e203f7d
.long 0x00003f80, 0x3f73be9e, 0xbf16bf4f, 0xbf163f4f, 0x250dbf80, 0xbf643ee8, 0x3f4f3f16, 0x3e20bf7d
.long 0x00003f80, 0x3f4fbf16, 0xbf73be9e, 0x3e9e3f73, 0x250dbf80, 0xbf353f35, 0x3f80248d, 0xbf35bf35
.long 0x00003f80, 0x250dbf80, 0x00003f80, 0x250dbf80, 0x250dbf80, 0x3e203f7d, 0xbe9ebf73, 0x3ee83f64
.long 0x00003f80, 0xbe9ebf73, 0x3f163f4f, 0xbf4fbf16, 0x250dbf80, 0x3ee83f64, 0xbf4fbf16, 0x3f7d3e20
.long 0x00003f80, 0xbf73be9e, 0x3f16bf4f, 0x3f163f4f, 0x250dbf80, 0x3f7d3e20, 0xbe9e3f73, 0xbf64bee8
.long 0x00003f80, 0xbf80a554, 0x250dbf80, 0x3f80248d, 0x250dbf80, 0x3f7dbe20, 0x3e9e3f73, 0xbf643ee8
.long 0x3f16bf4f, 0x250dbf80, 0xbf16bf4f, 0xbf73be9e, 0x00003f80, 0x3f353f35, 0x3f80248d, 0x3f35bf35
.long 0xbf16bf4f, 0xbf80a554, 0xbf163f4f, 0x3e9e3f73, 0x3f733e9e, 0x3f35bf35, 0xbe9ebf73, 0xbf7dbe20
.long 0x3f733e9e, 0x250dbf80, 0xbf733e9e, 0x3f163f4f, 0xbf733e9e, 0x3f353f35, 0x3e9ebf73, 0xbf7d3e20
.long 0x3f16bf4f, 0xbf80a554, 0x3f163f4f, 0x3e9ebf73, 0x00003f80, 0x3f35bf35, 0xbf80a554, 0x3f353f35
.long 0x00003f80, 0x250dbf80, 0x00003f80, 0x250dbf80, 0xbf16bf4f, 0x3f353f35, 0xbf4fbf16, 0x3f643ee8
.long 0x3f733e9e, 0xbf80a554, 0x3f73be9e, 0xbf4f3f16, 0xbf733e9e, 0x3f35bf35, 0xbe9e3f73, 0xbe20bf7d
.long 0xbf733e9e, 0x250dbf80, 0x3f733e9e, 0xbf163f4f, 0x3f16bf4f, 0x3f353f35, 0xbf4f3f16, 0xbee8bf64
.long 0x00003f80, 0xbf80a554, 0x250dbf80, 0x3f80248d, 0xbf16bf4f, 0x3f35bf35, 0x3f4f3f16, 0xbee83f64
.long 0xbf733e9e, 0xbf163f4f, 0x00003f80, 0x3f163f4f, 0x250dbf80, 0xbf35bf35, 0xbf80a554, 0xbf353f35
.long 0x3f733e9e, 0x3f4fbf16, 0x250dbf80, 0xbf4fbf16, 0xbf163f4f, 0x3ee83f64, 0x3f80248d, 0x3ee8bf64
.long 0x3f16bf4f, 0xbf73be9e, 0x00003f80, 0x3f73be9e, 0x3f163f4f, 0x3ee8bf64, 0xbf80a554, 0x3ee83f64
.long 0xbf733e9e, 0x3f4f3f16, 0x250dbf80, 0xbf4f3f16, 0x250dbf80, 0xbf353f35, 0x3f80248d, 0xbf35bf35
.long 0x00003f80, 0x250dbf80, 0x00003f80, 0x250dbf80, 0xbf73be9e, 0x3f7d3e20, 0xbf80a554, 0x3f7dbe20
.long 0x3f16bf4f, 0xbe9e3f73, 0x250dbf80, 0x3e9e3f73, 0x3f163f4f, 0xbf64bee8, 0x3f80248d, 0xbf643ee8
.long 0xbf16bf4f, 0x3f73be9e, 0x00003f80, 0xbf73be9e, 0x3f73be9e, 0x3e203f7d, 0xbf80a554, 0x3e20bf7d
.long 0x00003f80, 0xbf80a554, 0x250dbf80, 0x3f80248d, 0xbf73be9e, 0x3e20bf7d, 0x3f80248d, 0x3e203f7d
.long 0x00000000, 0x00000000, 0x00000000, 0x00000000, 0x00000000, 0x00000000, 0x00000000, 0x00000000
.long 0x00000000, 0x00000000, 0x00000000, 0x00000000, 0x00000000, 0x00000000, 0x00000000, 0x00000000
.long 0x00000000, 0x00000000, 0x00000000, 0x00000000, 0x00000000, 0x00000000, 0x00000000, 0x00000000
.long 0x00000000, 0x00000000, 0x00000000, 0x00000000, 0x00000000, 0x00000000, 0x00000000, 0x00000000
.long 0x00000000, 0x00000000, 0x00000000, 0x00000000, 0x00000000, 0x00000000, 0x00000000, 0x00000000
.long 0x00000000, 0x00000000, 0x00000000, 0x00000000, 0x00000000, 0x00000000, 0x00000000, 0x00000000
.long 0x00000000, 0x00000000, 0x00000000, 0x00000000, 0x00000000, 0x00000000, 0x00000000, 0x00000000
.long 0x00000000, 0x00000000, 0x00000000, 0x00000000, 0x00000000, 0x00000000, 0x00000000, 0x00000000
.long 0x00000000, 0x00000000, 0x00000000, 0x00000000, 0x00000000, 0x00000000, 0x00000000, 0x00000000
.long 0x00000000, 0x00000000, 0x00000000, 0x00000000, 0x00000000, 0x00000000, 0x00000000, 0x00000000
.long 0x00000000, 0x00000000, 0x00000000, 0x00000000, 0x00000000, 0x00000000, 0x00000000, 0x00000000
.long 0x00000000, 0x00000000, 0x00000000, 0x00000000, 0x00000000, 0x00000000, 0x00000000, 0x00000000
.long 0x00000000, 0x00000000, 0x00000000, 0x00000000, 0x00000000, 0x00000000, 0x00000000, 0x00000000
.long 0x00000000, 0x00000000, 0x00000000, 0x00000000, 0x00000000, 0x00000000, 0x00000000, 0x00000000
.long 0x00000000, 0x00000000, 0x00000000, 0x00000000, 0x00000000, 0x00000000, 0x00000000, 0x00000000
.long 0x00000000, 0x00000000, 0x00000000, 0x00000000, 0x00000000, 0x00000000, 0x00000000, 0x00000000
.long 0x3f733e9e, 0x3f73be9e, 0x3f16bf4f, 0x250dbf80, 0x00003f80, 0x3f353f35, 0x3f80248d, 0x3f35bf35
.long 0xbf733e9e, 0xbe9e3f73, 0x3f163f4f, 0x3f80248d, 0xbf16bf4f, 0xbf7d3e20, 0xbe9e3f73, 0x3f353f35
.long 0xbf16bf4f, 0xbf163f4f, 0x3f733e9e, 0x250dbf80, 0x3f16bf4f, 0xbf7dbe20, 0x3e9e3f73, 0x3f35bf35
.long 0x3f733e9e, 0xbe9ebf73, 0xbf163f4f, 0x3f80248d, 0x00003f80, 0x3f35bf35, 0xbf80a554, 0x3f353f35
.long 0x00003f80, 0x250dbf80, 0x00003f80, 0x250dbf80, 0xbf733e9e, 0x3f64bee8, 0xbf4f3f16, 0x3f35bf35
.long 0xbf16bf4f, 0x3f4f3f16, 0xbf73be9e, 0x3f80248d, 0x3f16bf4f, 0xbe203f7d, 0xbe9ebf73, 0x3f353f35
.long 0x3f16bf4f, 0x3f163f4f, 0xbf733e9e, 0x250dbf80, 0x3f733e9e, 0xbee83f64, 0xbf4fbf16, 0x3f35bf35
.long 0x00003f80, 0xbf80a554, 0x250dbf80, 0x3f80248d, 0xbf733e9e, 0xbee8bf64, 0x3f4fbf16, 0x3f353f35
.long 0xbf16bf4f, 0xbf73be9e, 0xbf733e9e, 0xbf163f4f, 0x250dbf80, 0xbf35bf35, 0xbf80a554, 0xbf353f35
.long 0x3f16bf4f, 0xbe9ebf73, 0xbf73be9e, 0xbf4f3f16, 0x3f73be9e, 0x3e20bf7d, 0xbf4fbf16, 0xbf643ee8
.long 0xbf733e9e, 0x3f163f4f, 0x3f16bf4f, 0xbf73be9e, 0xbf73be9e, 0x3e203f7d, 0x3f4fbf16, 0xbf64bee8
.long 0xbf16bf4f, 0xbe9e3f73, 0x3f73be9e, 0xbf4fbf16, 0x250dbf80, 0xbf353f35, 0x3f80248d, 0xbf35bf35
.long 0x00003f80, 0x250dbf80, 0x00003f80, 0x250dbf80, 0xbf163f4f, 0x3ee8bf64, 0xbe9e3f73, 0x3e20bf7d
.long 0xbf733e9e, 0x3f4fbf16, 0xbf163f4f, 0x3e9ebf73, 0xbf73be9e, 0x3f7dbe20, 0xbf4f3f16, 0x3ee8bf64
.long 0x3f733e9e, 0xbf163f4f, 0xbf16bf4f, 0x3f73be9e, 0x3f163f4f, 0xbf643ee8, 0xbe9ebf73, 0x3f7dbe20
.long 0x00003f80, 0xbf80a554, 0x250dbf80, 0x3f80248d, 0xbf163f4f, 0xbf64bee8, 0x3e9ebf73, 0x3f7d3e20
.long 0x00003f80, 0xbf733e9e, 0xbf16bf4f, 0x3f16bf4f, 0x00003f80, 0xbf643ee8, 0xbf4fbf16, 0x3e20bf7d
.long 0x00000000, 0x00000000, 0x00000000, 0x00000000, 0x00000000, 0x00000000, 0x00000000, 0x00000000
.long 0x00003f80, 0xbf4f3f16, 0xbf73be9e, 0xbe9ebf73, 0x00003f80, 0xbf353f35, 0xbf80a554, 0xbf35bf35
.long 0x00000000, 0x00000000, 0x00000000, 0x00000000, 0x00000000, 0x00000000, 0x00000000, 0x00000000
.long 0x00003f80, 0xbf163f4f, 0xbf733e9e, 0xbf73be9e, 0x00003f80, 0xbee83f64, 0xbf4f3f16, 0xbf7d3e20
.long 0x00000000, 0x00000000, 0x00000000, 0x00000000, 0x00000000, 0x00000000, 0x00000000, 0x00000000
.long 0x00003f80, 0xbe9e3f73, 0xbf163f4f, 0xbf4f3f16, 0x00003f80, 0xbe203f7d, 0xbe9e3f73, 0xbee83f64
.long 0x00000000, 0x00000000, 0x00000000, 0x00000000, 0x00000000, 0x00000000, 0x00000000, 0x00000000
.long 0x3f733e9e, 0x00003f80, 0xbf733e9e, 0xbf16bf4f, 0x3f73be9e, 0x3f353f35, 0xbe9e3f73, 0xbf7d3e20
.long 0x00000000, 0x00000000, 0x00000000, 0x00000000, 0x00000000, 0x00000000, 0x00000000, 0x00000000
.long 0x3f16bf4f, 0x3f80248d, 0x3f163f4f, 0xbe9e3f73, 0x250dbf80, 0x3f35bf35, 0x3f80248d, 0x3f353f35
.long 0x00000000, 0x00000000, 0x00000000, 0x00000000, 0x00000000, 0x00000000, 0x00000000, 0x00000000
.long 0xbf16bf4f, 0x250dbf80, 0x3f16bf4f, 0x3f73be9e, 0xbf73be9e, 0xbf35bf35, 0xbe9ebf73, 0x3e20bf7d
.long 0x00000000, 0x00000000, 0x00000000, 0x00000000, 0x00000000, 0x00000000, 0x00000000, 0x00000000
.long 0xbf733e9e, 0xbf80a554, 0xbf73be9e, 0xbf4fbf16, 0xbf163f4f, 0xbf353f35, 0xbf4f3f16, 0xbf643ee8
.long 0x00000000, 0x00000000, 0x00000000, 0x00000000, 0x00000000, 0x00000000, 0x00000000, 0x00000000
.long 0x3f16bf4f, 0x3f733e9e, 0x00003f80, 0xbf733e9e, 0xbf16bf4f, 0x3ee8bf64, 0x3f80248d, 0x3ee83f64
.long 0x00000000, 0x00000000, 0x00000000, 0x00000000, 0x00000000, 0x00000000, 0x00000000, 0x00000000
.long 0xbf733e9e, 0xbf4fbf16, 0x250dbf80, 0x3f4fbf16, 0x00003f80, 0xbf353f35, 0xbf80a554, 0xbf35bf35
.long 0x00000000, 0x00000000, 0x00000000, 0x00000000, 0x00000000, 0x00000000, 0x00000000, 0x00000000
.long 0x3f733e9e, 0x3f163f4f, 0x00003f80, 0xbf163f4f, 0x3f16bf4f, 0x3f64bee8, 0x3f80248d, 0x3f643ee8
.long 0x00000000, 0x00000000, 0x00000000, 0x00000000, 0x00000000, 0x00000000, 0x00000000, 0x00000000
.long 0xbf16bf4f, 0xbe9ebf73, 0x250dbf80, 0x3e9ebf73, 0xbf733e9e, 0xbf7d3e20, 0xbf80a554, 0xbf7dbe20
.long 0x00000000, 0x00000000, 0x00000000, 0x00000000, 0x00000000, 0x00000000, 0x00000000, 0x00000000
.long 0xbf16bf4f, 0x3f16bf4f, 0x3f733e9e, 0x00003f80, 0xbf163f4f, 0xbf7dbe20, 0xbe9ebf73, 0x3f35bf35
.long 0x00000000, 0x00000000, 0x00000000, 0x00000000, 0x00000000, 0x00000000, 0x00000000, 0x00000000
.long 0x3f733e9e, 0x3e9e3f73, 0xbf163f4f, 0xbf80a554, 0x250dbf80, 0x3f35bf35, 0x3f80248d, 0x3f353f35
.long 0x00000000, 0x00000000, 0x00000000, 0x00000000, 0x00000000, 0x00000000, 0x00000000, 0x00000000
.long 0xbf733e9e, 0xbf73be9e, 0xbf16bf4f, 0x250dbf80, 0x3f163f4f, 0x3e203f7d, 0xbe9e3f73, 0xbf353f35
.long 0x00000000, 0x00000000, 0x00000000, 0x00000000, 0x00000000, 0x00000000, 0x00000000, 0x00000000
.long 0x3f16bf4f, 0x3f4fbf16, 0x3f73be9e, 0x3f80248d, 0xbf73be9e, 0xbf64bee8, 0xbf4fbf16, 0xbf35bf35
.long 0x00000000, 0x00000000, 0x00000000, 0x00000000, 0x00000000, 0x00000000, 0x00000000, 0x00000000
.long 0xbf733e9e, 0xbf16bf4f, 0x3f16bf4f, 0x3f733e9e, 0x3f733e9e, 0x3e203f7d, 0xbf4f3f16, 0xbf64bee8
.long 0x00000000, 0x00000000, 0x00000000, 0x00000000, 0x00000000, 0x00000000, 0x00000000, 0x00000000
.long 0xbf16bf4f, 0x3e9ebf73, 0x3f73be9e, 0x3f4f3f16, 0x00003f80, 0xbf353f35, 0xbf80a554, 0xbf35bf35
.long 0x00000000, 0x00000000, 0x00000000, 0x00000000, 0x00000000, 0x00000000, 0x00000000, 0x00000000
.long 0x3f16bf4f, 0x3f73be9e, 0x3f733e9e, 0x3f163f4f, 0xbf733e9e, 0xbf7dbe20, 0xbf4fbf16, 0xbee8bf64
.long 0x00000000, 0x00000000, 0x00000000, 0x00000000, 0x00000000, 0x00000000, 0x00000000, 0x00000000
.long 0x3f733e9e, 0x3f4f3f16, 0x3f163f4f, 0x3e9e3f73, 0xbf16bf4f, 0xbee8bf64, 0xbe9ebf73, 0xbe20bf7d
.long 0x00000000, 0x00000000, 0x00000000, 0x00000000, 0x00000000, 0x00000000, 0x00000000, 0x00000000
.long 0x00003f80, 0xbf733e9e, 0xbf16bf4f, 0x3f16bf4f, 0x250dbf80, 0x3f64bee8, 0x3f4f3f16, 0xbe203f7d
.long 0x00000000, 0x00000000, 0x00000000, 0x00000000, 0x00000000, 0x00000000, 0x00000000, 0x00000000
.long 0x00003f80, 0xbf4f3f16, 0xbf73be9e, 0xbe9ebf73, 0x250dbf80, 0x3f35bf35, 0x3f80248d, 0x3f353f35
.long 0x00000000, 0x00000000, 0x00000000, 0x00000000, 0x00000000, 0x00000000, 0x00000000, 0x00000000
.long 0x00003f80, 0xbf163f4f, 0xbf733e9e, 0xbf73be9e, 0x250dbf80, 0x3ee8bf64, 0x3f4fbf16, 0x3f7dbe20
.long 0x00000000, 0x00000000, 0x00000000, 0x00000000, 0x00000000, 0x00000000, 0x00000000, 0x00000000
.long 0x00003f80, 0xbe9e3f73, 0xbf163f4f, 0xbf4f3f16, 0x250dbf80, 0x3e20bf7d, 0x3e9ebf73, 0x3ee8bf64
.long 0x00000000, 0x00000000, 0x00000000, 0x00000000, 0x00000000, 0x00000000, 0x00000000, 0x00000000
.long 0x3f733e9e, 0x00003f80, 0xbf733e9e, 0xbf16bf4f, 0xbf733e9e, 0xbf35bf35, 0x3e9ebf73, 0x3f7dbe20
.long 0x00000000, 0x00000000, 0x00000000, 0x00000000, 0x00000000, 0x00000000, 0x00000000, 0x00000000
.long 0x3f16bf4f, 0x3f80248d, 0x3f163f4f, 0xbe9e3f73, 0x00003f80, 0xbf353f35, 0xbf80a554, 0xbf35bf35
.long 0x00000000, 0x00000000, 0x00000000, 0x00000000, 0x00000000, 0x00000000, 0x00000000, 0x00000000
.long 0xbf16bf4f, 0x250dbf80, 0x3f16bf4f, 0x3f73be9e, 0x3f733e9e, 0x3f353f35, 0x3e9e3f73, 0xbe203f7d
.long 0x00000000, 0x00000000, 0x00000000, 0x00000000, 0x00000000, 0x00000000, 0x00000000, 0x00000000
.long 0xbf733e9e, 0xbf80a554, 0xbf73be9e, 0xbf4fbf16, 0x3f16bf4f, 0x3f35bf35, 0x3f4fbf16, 0x3f64bee8
.long 0x00000000, 0x00000000, 0x00000000, 0x00000000, 0x00000000, 0x00000000, 0x00000000, 0x00000000
.long 0x3f16bf4f, 0x3f733e9e, 0x00003f80, 0xbf733e9e, 0x3f163f4f, 0xbee83f64, 0xbf80a554, 0xbee8bf64
.long 0x00000000, 0x00000000, 0x00000000, 0x00000000, 0x00000000, 0x00000000, 0x00000000, 0x00000000
.long 0xbf733e9e, 0xbf4fbf16, 0x250dbf80, 0x3f4fbf16, 0x250dbf80, 0x3f35bf35, 0x3f80248d, 0x3f353f35
.long 0x00000000, 0x00000000, 0x00000000, 0x00000000, 0x00000000, 0x00000000, 0x00000000, 0x00000000
.long 0x3f733e9e, 0x3f163f4f, 0x00003f80, 0xbf163f4f, 0xbf163f4f, 0xbf643ee8, 0xbf80a554, 0xbf64bee8
.long 0x00000000, 0x00000000, 0x00000000, 0x00000000, 0x00000000, 0x00000000, 0x00000000, 0x00000000
.long 0xbf16bf4f, 0xbe9ebf73, 0x250dbf80, 0x3e9ebf73, 0x3f73be9e, 0x3f7dbe20, 0x3f80248d, 0x3f7d3e20
.long 0x00000000, 0x00000000, 0x00000000, 0x00000000, 0x00000000, 0x00000000, 0x00000000, 0x00000000
.long 0x00000000, 0x00000000, 0x00000000, 0x00000000, 0x00000000, 0x00000000, 0x00000000, 0x00000000
.long 0x00000000, 0x00000000, 0x00000000, 0x00000000, 0x00000000, 0x00000000, 0x00000000, 0x00000000
.long 0x00000000, 0x00000000, 0x00000000, 0x00000000, 0x00000000, 0x00000000, 0x00000000, 0x00000000
.long 0x00000000, 0x00000000, 0x00000000, 0x00000000, 0x00000000, 0x00000000, 0x00000000, 0x00000000
.long 0x00000000, 0x00000000, 0x00000000, 0x00000000, 0x00000000, 0x00000000, 0x00000000, 0x00000000
.long 0x00000000, 0x00000000, 0x00000000, 0x00000000, 0x00000000, 0x00000000, 0x00000000, 0x00000000
.long 0x00000000, 0x00000000, 0x00000000, 0x00000000, 0x00000000, 0x00000000, 0x00000000, 0x00000000
.long 0x00000000, 0x00000000, 0x00000000, 0x00000000, 0x00000000, 0x00000000, 0x00000000, 0x00000000
.long 0x00000000, 0x00000000, 0x00000000, 0x00000000, 0x00000000, 0x00000000, 0x00000000, 0x00000000
.long 0x00000000, 0x00000000, 0x00000000, 0x00000000, 0x00000000, 0x00000000, 0x00000000, 0x00000000
.long 0x00000000, 0x00000000, 0x00000000, 0x00000000, 0x00000000, 0x00000000, 0x00000000, 0x00000000
.long 0x00000000, 0x00000000, 0x00000000, 0x00000000, 0x00000000, 0x00000000, 0x00000000, 0x00000000
.long 0x00000000, 0x00000000, 0x00000000, 0x00000000, 0x00000000, 0x00000000, 0x00000000, 0x00000000
.long 0x00000000, 0x00000000, 0x00000000, 0x00000000, 0x00000000, 0x00000000, 0x00000000, 0x00000000
.long 0x00000000, 0x00000000, 0x00000000, 0x00000000, 0x00000000, 0x00000000, 0x00000000, 0x00000000
.long 0x00000000, 0x00000000, 0x00000000, 0x00000000, 0x00000000, 0x00000000, 0x00000000, 0x00000000
.long 0xbf16bf4f, 0x3f16bf4f, 0x3f733e9e, 0x00003f80, 0x3f16bf4f, 0x3f7d3e20, 0x3e9e3f73, 0xbf353f35
.long 0x00000000, 0x00000000, 0x00000000, 0x00000000, 0x00000000, 0x00000000, 0x00000000, 0x00000000
.long 0x3f733e9e, 0x3e9e3f73, 0xbf163f4f, 0xbf80a554, 0x00003f80, 0xbf353f35, 0xbf80a554, 0xbf35bf35
.long 0x00000000, 0x00000000, 0x00000000, 0x00000000, 0x00000000, 0x00000000, 0x00000000, 0x00000000
.long 0xbf733e9e, 0xbf73be9e, 0xbf16bf4f, 0x250dbf80, 0xbf16bf4f, 0xbe20bf7d, 0x3e9ebf73, 0x3f35bf35
.long 0x00000000, 0x00000000, 0x00000000, 0x00000000, 0x00000000, 0x00000000, 0x00000000, 0x00000000
.long 0x3f16bf4f, 0x3f4fbf16, 0x3f73be9e, 0x3f80248d, 0x3f733e9e, 0x3f643ee8, 0x3f4f3f16, 0x3f353f35
.long 0x00000000, 0x00000000, 0x00000000, 0x00000000, 0x00000000, 0x00000000, 0x00000000, 0x00000000
.long 0xbf733e9e, 0xbf16bf4f, 0x3f16bf4f, 0x3f733e9e, 0xbf73be9e, 0xbe20bf7d, 0x3f4fbf16, 0x3f643ee8
.long 0x00000000, 0x00000000, 0x00000000, 0x00000000, 0x00000000, 0x00000000, 0x00000000, 0x00000000
.long 0xbf16bf4f, 0x3e9ebf73, 0x3f73be9e, 0x3f4f3f16, 0x250dbf80, 0x3f35bf35, 0x3f80248d, 0x3f353f35
.long 0x00000000, 0x00000000, 0x00000000, 0x00000000, 0x00000000, 0x00000000, 0x00000000, 0x00000000
.long 0x3f16bf4f, 0x3f73be9e, 0x3f733e9e, 0x3f163f4f, 0x3f73be9e, 0x3f7d3e20, 0x3f4f3f16, 0x3ee83f64
.long 0x00000000, 0x00000000, 0x00000000, 0x00000000, 0x00000000, 0x00000000, 0x00000000, 0x00000000
.long 0x3f733e9e, 0x3f4f3f16, 0x3f163f4f, 0x3e9e3f73, 0x3f163f4f, 0x3ee83f64, 0x3e9e3f73, 0x3e203f7d
.long 0x00000000, 0x00000000, 0x00000000, 0x00000000, 0x00000000, 0x00000000, 0x00000000, 0x00000000

.section .rodata,"a"
.p2align 6
.amdhsa_kernel adaLN_cond__spectral_fnet__geglu_ffn__prompt_kernel
  .amdhsa_next_free_vgpr 512
  .amdhsa_next_free_sgpr 89
  .amdhsa_accum_offset 256
  .amdhsa_group_segment_fixed_size 0
  .amdhsa_kernarg_size 112
  .amdhsa_user_sgpr_count 2
  .amdhsa_user_sgpr_kernarg_segment_ptr 1
  .amdhsa_system_sgpr_workgroup_id_x 1
  .amdhsa_float_denorm_mode_32 3
.end_amdhsa_kernel
```
